```python
import torch

def _softmax(x, axis=-1):
    return torch.softmax(x, dim=axis)
def _gelu(x):
    return torch.nn.functional.gelu(x, approximate="tanh")
def _silu(x):
    return torch.nn.functional.silu(x)
def _sigmoid(x):
    return torch.sigmoid(x)
def _layernorm(x, axis=-1, eps=1e-5):
    m = x.mean(dim=axis, keepdim=True)
    v = x.var(dim=axis, keepdim=True, unbiased=False)
    return (x - m) / torch.sqrt(v + eps)
def _scatter_add(tgt, idx, src, axis=0):
    return tgt.clone().index_add_(axis, idx, src)
def _segment_sum(src, seg, n):
    out = torch.zeros((n,) + src.shape[1:], dtype=src.dtype)
    return out.index_add_(0, seg, src)
def _pad(x, pw):
    flat = tuple(v for pair in reversed(pw) for v in pair)
    return torch.nn.functional.pad(x, flat)

kernel_name = 'concat_heads__linear_kernel_hedgehog__ssm_conv_h3__prompt'

def setup_inputs():

    _w = (lambda a: (lambda t: t.to(torch.bfloat16) if t.is_floating_point() else t)(torch.as_tensor(a)))
    def _A_setup():
        B, S, D, H = 1, 2048, 640, 32
        Dh = D // H
        return {
            "x": _w((lambda *s: torch.randn(*s, dtype=torch.bfloat16) * 0.4)(B, S, D)),
            "wqkv": _w((lambda *s: torch.randn(*s, dtype=torch.bfloat16) * 0.4)(D, 3 * D)),
            "w_phi": _w((lambda *s: torch.randn(*s, dtype=torch.bfloat16) * 0.4)(H, Dh, Dh) * (Dh ** -0.5)),
            "wo": _w((lambda *s: torch.randn(*s, dtype=torch.bfloat16) * 0.05)(D, D)),
        }
    _A_in = _A_setup()

    def _B_setup():
        B, S, D = 1, 2048, 640
        ks = 4
        return {
            "q": _w((lambda *s: torch.randn(*s, dtype=torch.bfloat16) * 0.05)(B, S, D)),
            "k": _w((lambda *s: torch.randn(*s, dtype=torch.bfloat16) * 0.8)(B, S, D)),
            "v": _w((lambda *s: torch.randn(*s, dtype=torch.bfloat16) * 0.8)(B, S, D)),
            "shift_k": _w((lambda *s: torch.randn(*s, dtype=torch.bfloat16) * 0.8)(D, ks) * 0.5),
            "ssm_k": _w((lambda *s: torch.randn(*s, dtype=torch.bfloat16) * 0.8)(D, S) * (1.0 / S ** 0.5)),
            "ssm_D": _w((lambda *s: torch.randn(*s, dtype=torch.bfloat16) * 0.8)(D)),
        }
    _B_in = _B_setup()

    return {
        "A_x": _A_in["x"],
        "A_wqkv": _A_in["wqkv"],
        "A_w_phi": _A_in["w_phi"],
        "A_wo": _A_in["wo"],
        "B_q": _B_in["q"],
        "B_k": _B_in["k"],
        "B_v": _B_in["v"],
        "B_shift_k": _B_in["shift_k"],
        "B_ssm_k": _B_in["ssm_k"],
        "B_ssm_D": _B_in["ssm_D"],
    }

def reference(A_x, A_wqkv, A_w_phi, A_wo, B_q, B_k, B_v, B_shift_k, B_ssm_k, B_ssm_D):
    def _A_ref(x, wqkv, w_phi, wo):
        B, S, D = x.shape
        H = 32; Dh = D // H
        qkv = (lambda x, *d: x.permute(*d))((x @ wqkv).reshape(B, S, 3, H, Dh), 2, 0, 3, 1, 4)
        q, k, v = qkv[0], qkv[1], qkv[2]
        pq = torch.einsum("bhsd,hdf->bhsf", q, w_phi)
        pk = torch.einsum("bhsd,hdf->bhsf", k, w_phi)
        phi_q = torch.concatenate([_softmax(pq, axis=-1), _softmax(-pq, axis=-1)], axis=-1)
        phi_k = torch.concatenate([_softmax(pk, axis=-1), _softmax(-pk, axis=-1)], axis=-1)
        kv = torch.einsum("bhsf,bhsd->bhfd", phi_k, v)
        z  = torch.einsum("bhsf->bhf", phi_k)
        num = torch.einsum("bhqf,bhfd->bhqd", phi_q, kv)
        den = torch.einsum("bhqf,bhf->bhq", phi_q, z)[..., None] + 1e-6
        o = num / den
        return (lambda x, *d: x.permute(*d))(o, 0, 2, 1, 3).reshape(B, S, D) @ wo

    def _B_ref(q, k, v, shift_k, ssm_k, ssm_D):
        B, S, D = q.shape
        ks = shift_k.shape[-1]
        k_pad = _pad(k, ((0, 0), (ks - 1, 0), (0, 0)))
        k_shift = torch.zeros_like(k)
        for t in range(ks):
            k_shift = k_shift + k_pad[:, t:t + S, :] * shift_k[:, ks - 1 - t][None, None, :]
        kv = k_shift * v
        L = 2 * S
        kv_pad = _pad(kv, ((0, 0), (0, S), (0, 0)))
        kf_pad = _pad(ssm_k, ((0, 0), (0, S)))
        kv_f = (lambda x, axes=(-2,-1): torch.fft.rfft2(x.float(), dim=axes))(kv_pad[:, None, :, :], axes=(1, 2))
        kf_f = (lambda x, axes=(-2,-1): torch.fft.rfft2(x.float(), dim=axes))(kf_pad[:, None, :], axes=(1, 2))
        kf_f = (lambda x, *d: x.permute(*d))(kf_f, 1, 2, 0)
        y_f = kv_f * kf_f[None, :, :, :]
        y = (lambda x, s, axes=(-2,-1): torch.fft.irfft2(x, s=s, dim=axes).to(torch.bfloat16))(y_f, (1, L), axes=(1, 2))[:, 0, :S, :]
        y = y + kv * ssm_D[None, None, :]
        return q * y

    a = _A_ref(A_x, A_wqkv, A_w_phi, A_wo)
    b = _B_ref(B_q, B_k, B_v, B_shift_k, B_ssm_k, B_ssm_D)
    return torch.concatenate([a, b], axis=-1)
```

```asm
; @launch grid=(256,1,1) block=(512,1,1) lds=163840
.amdgcn_target "amdgcn-amd-amdhsa--gfx950"
.text
.globl concat_heads__linear_kernel_hedgehog__ssm_conv_h3__prompt_kernel
.p2align 8
.type concat_heads__linear_kernel_hedgehog__ssm_conv_h3__prompt_kernel,@function
concat_heads__linear_kernel_hedgehog__ssm_conv_h3__prompt_kernel:
    s_load_dwordx16 s[16:31], s[0:1], 0
    s_load_dwordx8 s[32:39], s[0:1], 64
    s_load_dwordx2 s[40:41], s[0:1], 96
    v_lshrrev_b32 v2, 6, v0
    v_and_b32 v1, 63, v0
    v_readfirstlane_b32 s3, v2
    s_cmp_ge_u32 s2, 256
    s_cbranch_scc1 L_exit
    s_and_b32 s42, s2, 7
    s_lshr_b32 s43, s2, 3
    s_mov_b32 s91, 0x200000
    s_cmp_ge_u32 s43, 16
    s_cbranch_scc0 L_g
    s_sub_u32 s5, s43, 24
    s_cmp_ge_u32 s5, 6
    s_cbranch_scc1 L_b
    s_cmp_lg_u32 s3, 7
    s_cbranch_scc1 L_b
    s_getpc_b64 s[6:7]
    s_lshl_b32 s5, s5, 13
    v_lshl_add_u32 v3, v1, 7, s5
    global_load_dword v255, v3, s[6:7]
    s_branch L_b
L_g:
    s_lshl_b32 s68, s3, 8
    s_add_u32 s68, s68, s2
    s_sub_u32 s68, s68, 768
    s_cmp_ge_u32 s68, 8
    s_cbranch_scc1 L_noinit
    v_lshlrev_b32 v2, 8, v1
    v_mov_b32 v3, 0
    s_lshl_b32 s4, s68, 14
    s_add_u32 s4, s4, 0xbc0000
    s_waitcnt lgkmcnt(0)
    s_mov_b32 s44, s40
    s_and_b32 s45, s41, 0xffff
    s_mov_b32 s46, 0xbe0000
    s_mov_b32 s47, 0x20000
    buffer_store_dword v3, v2, s[44:47], s4 offen sc1
L_noinit:
    s_xor_b32 s4, s3, 4
    s_lshl4_add_u32 s4, s4, s43
    s_waitcnt lgkmcnt(0)
    s_cmp_ge_u32 s3, 4
    s_cbranch_scc1 Lpf1
    s_mov_b32 s56, s20
    s_and_b32 s57, s21, 0xffff
    s_mov_b32 s58, 0x6400
    s_mov_b32 s59, 0x20000
    s_and_b32 s5, s42, 4
    s_lshr_b32 s7, s43, 2
    s_add_u32 s5, s5, s7
    s_mul_i32 s5, s5, 3200
    s_lshl_b32 s7, s3, 12
    s_add_u32 m0, s7, 147456
    v_lshlrev_b32 v3, 4, v1
    buffer_load_dwordx4 v3, s[56:59], s5 offen offset:0 lds
    buffer_load_dwordx4 v3, s[56:59], s5 offen offset:1024 lds
    buffer_load_dwordx4 v3, s[56:59], s5 offen offset:2048 lds
    buffer_load_dwordx4 v3, s[56:59], s5 offen offset:3072 lds
Lpf1:
    s_mov_b32 s48, s16
    s_and_b32 s49, s17, 0xffff
    s_mov_b32 s50, 0x280000
    s_mov_b32 s51, 0x20000
    s_mov_b32 s52, s18
    s_and_b32 s53, s19, 0xffff
    s_mov_b32 s54, 0x258000
    s_mov_b32 s55, 0x20000
    s_cmp_lt_u32 s4, 48
    s_cselect_b32 s4, s4, 240
    s_mul_i32 s7, s4, 713
    s_lshr_b32 s7, s7, 14
    s_mul_i32 s5, s7, 23
    s_sub_u32 s5, s4, s5
    s_cmp_ge_u32 s5, 8
    s_cbranch_scc1 Lpw3
    s_and_b32 s13, s42, 3
    s_lshl3_add_u32 s5, s13, s5
    s_mul_i32 s5, s5, 81920
    s_lshl_b32 s7, s7, 7
    s_add_u32 s5, s5, s7
    s_cmp_ge_u32 s4, 230
    s_cselect_b32 s5, 0x10000000, s5
    v_mul_u32_u24 v2, 1280, v1
    buffer_load_dword v255, v2, s[48:51], s5 offen
    s_branch Lpn4
Lpw3:
    s_sub_u32 s5, s5, 8
    s_mul_i32 s13, s5, 52
    s_lshr_b32 s13, s13, 8
    s_mul_i32 s15, s13, 5
    s_sub_u32 s5, s5, s15
    s_mul_i32 s7, s7, 192
    s_add_u32 s7, s7, s13
    s_lshr_b32 s13, s42, 2
    s_lshl1_add_u32 s7, s7, s13
    s_mul_i32 s7, s7, 640
    s_lshl_b32 s5, s5, 6
    s_movk_i32 s13, 3200
    v_add_u32 v2, s5, v1
    v_mul_u32_u24 v3, 13108, v2
    v_lshrrev_b32 v3, 16, v3
    v_lshlrev_b32 v2, 7, v2
    v_mad_u32_u24 v2, v3, s13, v2
    buffer_load_dword v255, v2, s[52:55], s7 offen
Lpn4:
    s_and_b32 s6, s42, 3
    s_and_b32 s7, s43, 3
    s_lshl2_add_u32 s64, s6, s7
    s_and_b32 s6, s42, 4
    s_lshr_b32 s7, s43, 2
    s_add_u32 s67, s6, s7
    s_mov_b32 s69, 0
    s_mov_b32 s70, 0x3fb8aa3b
    s_mov_b32 s71, 0x3fb8aa3b
    s_cmp_ge_u32 s3, 4
    s_cbranch_scc1 L_ld
    s_mov_b32 s44, s40
    s_and_b32 s45, s41, 0xffff
    s_mov_b32 s46, 0xbe0000
    s_mov_b32 s47, 0x20000
    s_lshl_b32 s6, s3, 12
    s_add_u32 s6, s6, 147456
    v_lshrrev_b32 v12, 5, v1
    v_bfe_u32 v13, v1, 2, 2
    v_and_b32_e64 v14, 3, v1
    v_bfe_u32 v15, v1, 4, 1
    v_lshl_add_u32 v16, v12, 3, v13
    v_lshl_add_u32 v17, v15, 2, v14
    v_mul_u32_u24 v18, 320, v16
    v_and_b32 v19, 31, v1
    v_lshlrev_b32 v249, 4, v1
    v_lshlrev_b32_e64 v250, 3, v19
    v_lshl_add_u32 v250, v12, 14, v250
    v_mov_b32 v251, 0
    v_mov_b32 v252, 1
    s_lshl_b32 s4, s3, 5
    v_add_u32 v19, s4, v19
    v_bfe_u32 v224, v19, 1, 3
    v_xor_b32 v224, v224, v12
    v_lshlrev_b32 v225, 7, v19
    v_lshl_add_u32 v2, v224, 4, v225
    v_xor_b32 v3, 32, v2
    v_xor_b32 v4, 64, v2
    v_xor_b32 v5, 96, v2
    v_add_u32 v2, 94208, v2
    v_add_u32 v3, 94208, v3
    v_add_u32 v4, 94208, v4
    v_add_u32 v5, 94208, v5
    v_add_u32_e64 v224, v16, v13
    v_mul_u32_u24 v225, 480, v224
    v_lshl_add_u32 v6, v17, 3, v225
    v_add_u32 v6, 110592, v6
    v_lshrrev_b32_e64 v224, 4, v1
    v_lshl_add_u32 v224, v224, 2, v13
    v_lshlrev_b32_e64 v224, 1, v224
    v_mul_u32_u24 v224, 480, v224
    v_and_b32_e64 v225, 1, v1
    v_lshl_add_u32 v224, v225, 4, v224
    v_bfe_u32 v225, v1, 1, 1
    v_lshl_add_u32 v224, v225, 3, v224
    v_add_u32 v7, 111040, v224
    s_lshl2_add_u32 s4, s64, s3
    s_lshl_b32 s11, s67, 18
    s_lshl_b32 s4, s4, 10
    s_add_u32 s11, s11, s4
    s_lshr_b32 s12, s11, 2
    s_add_u32 s12, s12, 0x200000
    s_lshl4_add_u32 s13, s67, s64
    s_lshl_b32 s13, s13, 8
    s_nop 0
    s_add_u32 s13, s13, 0xbd8000
    v_mul_u32_u24 v232, 200, v19
    v_add_u32 v232, 40960, v232
    v_lshl_add_u32 v233, v12, 3, v232
    v_mov_b32 v242, 0x3f803f80
    v_mov_b32 v243, 0x3f803f80
    v_mul_u32_u24 v224, 320, v19
    v_add_u32_e64 v224, 0, v224
    v_bfe_u32 v225, v19, 1, 2
    v_lshlrev_b32 v226, 1, v12
    v_xor_b32 v225, v225, v226
    v_lshl_add_u32 v234, v225, 4, v224
    v_xor_b32_e64 v225, 1, v225
    v_lshl_add_u32 v235, v225, 4, v224
    v_and_b32 v225, 1, v17
    v_lshlrev_b32 v225, 1, v225
    v_lshrrev_b32 v226, 1, v13
    v_xor_b32 v225, v225, v226
    s_lshr_b32 s4, s3, 1
    v_xor_b32 v227, s4, v225
    s_and_b32 s4, s3, 1
    s_lshl_b32 s4, s4, 3
    s_add_u32 s4, s4, 256
    v_add_u32_e64 v224, s4, v18
    v_lshl_add_u32 v236, v227, 4, v224
    v_xor_b32_e64 v227, 2, v227
    v_lshl_add_u32 v237, v227, 4, v224
    s_lshl_b32 s4, s3, 6
    s_add_u32 s4, s4, 0
    v_add_u32 v224, s4, v18
    v_xor_b32 v225, v225, v15
    v_bfe_u32 v226, v17, 1, 1
    v_lshl_add_u32 v224, v226, 3, v224
    v_lshl_add_u32 v238, v225, 4, v224
    v_xor_b32_e64 v225, 2, v225
    v_lshl_add_u32 v239, v225, 4, v224
    s_mul_i32 s4, s3, 40
    v_lshl_add_u32 v225, v17, 3, s4
    v_cmp_lt_u32 vcc, 4, v17
    v_mov_b32 v226, 160
    v_mul_u32_u24 v224, 200, v16
    v_cndmask_b32_e64 v225, v225, v226, vcc
    v_add_u32 v224, 40960, v224
    v_add_u32 v240, v224, v225
    v_and_b32 v224, 31, v1
    v_mul_u32_u24 v225, 24, v12
    v_add_u32 v225, v224, v225
    v_cmp_lt_u32_e64 vcc, 23, v224
    v_mov_b32 v226, 0x80000000
    v_lshlrev_b32 v227, 4, v225
    v_lshlrev_b32 v225, 3, v225
    v_cndmask_b32 v241, v227, v226, vcc
    v_cndmask_b32 v244, v225, v226, vcc
    v_cmp_lt_u32 vcc, 119, v19
    v_mul_u32_u24 v225, 15360, v12
    v_lshl_add_u32 v225, v19, 4, v225
    v_cndmask_b32 v245, v225, v226, vcc
    v_lshlrev_b32 v225, 4, v19
    v_lshl_add_u32 v225, v12, 3, v225
    v_add_u32 v246, 0, v225
    s_lshl_b32 s9, s67, 2
    s_add_u32 s9, s9, s3
    s_lshl_b32 s10, s9, 2
    s_add_u32 s10, s10, 64
    v_mov_b32 v247, 41128
    s_lshl_b32 s9, s9, 4
    s_add_u32 s9, s9, s64
    s_mul_i32 s9, s9, 1920
    s_add_u32 s9, s9, 0x500000
    v_lshl_add_u32 v224, v12, 2, v13
    v_mul_u32_u24 v224, 40, v224
    v_add_u32 v224, s6, v224
    v_lshrrev_b32 v225, 1, v17
    v_lshl_add_u32 v226, v225, 3, v224
    v_add_u32_e64 v227, 32, v224
    v_bfe_u32 v228, v1, 2, 1
    v_mul_u32_u24 v228, 0x8000, v228
    v_lshl_or_b32 v228, v228, 16, v228
    s_mul_i32 s4, s3, 3072
    s_add_u32 s4, s4, 151552
    v_add_u32 v253, s4, v249
    s_waitcnt vmcnt(1)
    s_cmp_ge_u32 s68, 8
    s_cbranch_scc1 L_noini2
    s_lshl_b32 s68, 1, s68
    s_waitcnt vmcnt(0)
    s_atomic_or s68, s[38:39], 0
L_noini2:
    ds_read_b64_tr_b16 v[148:149], v227 offset:0
    ds_read_b64_tr_b16 v[150:151], v227 offset:320
    ds_read_b64_tr_b16 v[152:153], v227 offset:640
    ds_read_b64_tr_b16 v[154:155], v227 offset:960
    ds_read_b64_tr_b16 v[156:157], v226 offset:0
    ds_read_b64_tr_b16 v[158:159], v226 offset:320
    ds_read_b64_tr_b16 v[160:161], v226 offset:640
    v_mov_b32 v162, 0
    v_mov_b32 v163, 0
    ds_read_b64_tr_b16 v[164:165], v227 offset:1280
    ds_read_b64_tr_b16 v[166:167], v227 offset:1600
    ds_read_b64_tr_b16 v[168:169], v226 offset:640
    ds_read_b64_tr_b16 v[170:171], v226 offset:960
    ds_read_b64_tr_b16 v[172:173], v226 offset:1280
    v_mov_b32 v174, 0
    v_mov_b32 v175, 0
    s_waitcnt lgkmcnt(11)
    v_xor_b32 v148, v148, v228
    v_xor_b32_e64 v149, v149, v228
    s_mov_b32 s4, 0xff
    s_mov_b32 s5, 0xff
    v_cndmask_b32 v148, 0, v148, s[4:5]
    v_cndmask_b32 v149, 0, v149, s[4:5]
    s_waitcnt lgkmcnt(10)
    v_xor_b32 v150, v150, v228
    v_xor_b32_e64 v151, v151, v228
    s_mov_b32 s4, 0xff
    s_mov_b32 s5, 0xff
    v_cndmask_b32 v150, 0, v150, s[4:5]
    v_cndmask_b32 v151, 0, v151, s[4:5]
    s_waitcnt lgkmcnt(9)
    v_xor_b32 v152, v152, v228
    v_xor_b32_e64 v153, v153, v228
    s_mov_b32 s4, 0xff
    s_mov_b32 s5, 0xff00
    v_cndmask_b32 v152, 0, v152, s[4:5]
    v_cndmask_b32 v153, 0, v153, s[4:5]
    s_waitcnt lgkmcnt(8)
    v_xor_b32 v154, v154, v228
    v_xor_b32_e64 v155, v155, v228
    s_mov_b32 s4, 0xff00
    s_mov_b32 s5, 0xff00
    v_cndmask_b32 v154, 0, v154, s[4:5]
    v_cndmask_b32 v155, 0, v155, s[4:5]
    s_waitcnt lgkmcnt(7)
    v_xor_b32 v156, v156, v228
    v_xor_b32 v157, v157, v228
    s_waitcnt lgkmcnt(6)
    v_xor_b32 v158, v158, v228
    v_xor_b32 v159, v159, v228
    s_waitcnt lgkmcnt(5)
    v_xor_b32 v160, v160, v228
    v_xor_b32 v161, v161, v228
    s_mov_b32 s4, 0xffffffff
    s_mov_b32 s5, 0x0
    v_cndmask_b32 v160, 0, v160, s[4:5]
    v_cndmask_b32 v161, 0, v161, s[4:5]
    s_waitcnt lgkmcnt(4)
    v_xor_b32 v164, v164, v228
    v_xor_b32 v165, v165, v228
    s_mov_b32 s4, 0xff00
    s_mov_b32 s5, 0xff00
    v_cndmask_b32 v164, 0, v164, s[4:5]
    v_cndmask_b32 v165, 0, v165, s[4:5]
    s_waitcnt lgkmcnt(3)
    v_xor_b32 v166, v166, v228
    v_xor_b32_e64 v167, v167, v228
    s_mov_b32 s4, 0xff0000
    s_mov_b32 s5, 0xff0000
    v_cndmask_b32 v166, 0, v166, s[4:5]
    v_cndmask_b32 v167, 0, v167, s[4:5]
    s_waitcnt lgkmcnt(2)
    v_xor_b32 v168, v168, v228
    v_xor_b32 v169, v169, v228
    s_mov_b32 s4, 0x0
    s_mov_b32 s5, 0xffffffff
    v_cndmask_b32 v168, 0, v168, s[4:5]
    v_cndmask_b32 v169, 0, v169, s[4:5]
    s_waitcnt lgkmcnt(1)
    v_xor_b32 v170, v170, v228
    v_xor_b32 v171, v171, v228
    s_waitcnt lgkmcnt(0)
    v_xor_b32 v172, v172, v228
    v_xor_b32 v173, v173, v228
    v_and_b32 v13, 15, v1
    s_lshl_b32 s4, s3, 12
    s_add_u32 s4, s4, 94208
    v_lshrrev_b32 v14, 1, v13
    v_lshrrev_b32 v16, 4, v1
    v_xor_b32 v14, v14, v16
    v_lshlrev_b32_e64 v14, 4, v14
    v_lshl_add_u32 v13, v13, 7, v14
    v_xor_b32 v14, 64, v13
    v_add_u32 v13, s4, v13
    v_add_u32 v14, s4, v14
    v_lshlrev_b32 v16, 6, v15
    v_sub_u32 v16, 32, v16
    v_add_u32 v16, v16, v6
    s_barrier
    s_nop 0
    ds_read_b128 v[124:127], v2
    ds_read_b64_tr_b16 v[100:101], v6 offset:0
    ds_read_b64_tr_b16 v[102:103], v16 offset:480
    ds_read_b64_tr_b16 v[104:105], v6 offset:64
    ds_read_b64_tr_b16 v[106:107], v6 offset:544
    ds_read_b64_tr_b16 v[108:109], v6 offset:128
    ds_read_b64_tr_b16 v[110:111], v6 offset:608
    ds_read_b64_tr_b16 v[112:113], v6 offset:192
    ds_read_b64_tr_b16 v[114:115], v6 offset:672
    ds_read_b64_tr_b16 v[116:117], v6 offset:256
    ds_read_b64_tr_b16 v[118:119], v6 offset:736
    s_waitcnt lgkmcnt(8)
    v_mfma_f32_32x32x16_bf16 v[20:35], v[100:103], v[124:127], 0
    ds_read_b64_tr_b16 v[8:9], v7 offset:0
    ds_read_b64_tr_b16 v[120:121], v6 offset:320
    ds_read_b64_tr_b16 v[122:123], v16 offset:800
    s_waitcnt lgkmcnt(9)
    v_mfma_f32_32x32x16_bf16 v[36:51], v[104:107], v[124:127], 0
    ds_read_b64_tr_b16 v[10:11], v7 offset:480
    ds_read_b64_tr_b16 v[100:101], v6 offset:384
    ds_read_b64_tr_b16 v[102:103], v6 offset:864
    s_waitcnt lgkmcnt(10)
    v_mfma_f32_32x32x16_bf16 v[52:67], v[108:111], v[124:127], 0
    ds_read_b128 v[128:131], v3
    ds_read_b64_tr_b16 v[104:105], v6 offset:7680
    ds_read_b64_tr_b16 v[106:107], v16 offset:8160
    s_waitcnt lgkmcnt(11)
    v_mfma_f32_32x32x16_bf16 v[68:83], v[112:115], v[124:127], 0
    ds_read_b128 v[132:135], v13 offset:0
    ds_read_b64_tr_b16 v[108:109], v6 offset:7744
    ds_read_b64_tr_b16 v[110:111], v6 offset:8224
    s_waitcnt lgkmcnt(12)
    v_mfma_f32_32x32x16_bf16 v[84:99], v[116:119], v[124:127], 0
    ds_read_b128 v[136:139], v13 offset:2048
    ds_read_b64_tr_b16 v[112:113], v6 offset:7808
    ds_read_b64_tr_b16 v[114:115], v6 offset:8288
    s_waitcnt lgkmcnt(12)
    v_mfma_f32_32x32x16_bf16 v[200:215], v[120:123], v[124:127], 0
    ds_read_b64_tr_b16 v[116:117], v6 offset:7872
    ds_read_b64_tr_b16 v[118:119], v6 offset:8352
    s_waitcnt lgkmcnt(11)
    v_mfma_f32_32x32x16_bf16 v[216:231], v[100:103], v[124:127], 0
    ds_read_b64_tr_b16 v[120:121], v6 offset:7936
    ds_read_b64_tr_b16 v[122:123], v6 offset:8416
    s_waitcnt lgkmcnt(10)
    v_mfma_f32_32x32x16_bf16 v[20:35], v[104:107], v[128:131], v[20:35]
    ds_read_b64_tr_b16 v[100:101], v6 offset:8000
    ds_read_b64_tr_b16 v[102:103], v16 offset:8480
    s_waitcnt lgkmcnt(9)
    v_mfma_f32_32x32x16_bf16 v[36:51], v[108:111], v[128:131], v[36:51]
    s_waitcnt lgkmcnt(8)
    v_mfma_f32_16x16x32_bf16 v[140:143], v[8:11], v[132:135], 0
    v_mfma_f32_16x16x32_bf16 v[144:147], v[8:11], v[136:139], 0
    ds_read_b64_tr_b16 v[104:105], v6 offset:8064
    ds_read_b64_tr_b16 v[106:107], v6 offset:8544
    s_waitcnt lgkmcnt(8)
    v_mfma_f32_32x32x16_bf16 v[52:67], v[112:115], v[128:131], v[52:67]
    ds_read_b128 v[124:127], v4
    ds_read_b64_tr_b16 v[108:109], v6 offset:15360
    ds_read_b64_tr_b16 v[110:111], v16 offset:15840
    s_waitcnt lgkmcnt(9)
    v_mfma_f32_32x32x16_bf16 v[68:83], v[116:119], v[128:131], v[68:83]
    v_add_u32 v3, 0xfffe9000, v3
    ds_read_b64_tr_b16 v[112:113], v6 offset:15424
    ds_read_b64_tr_b16 v[114:115], v6 offset:15904
    s_waitcnt lgkmcnt(9)
    v_mfma_f32_32x32x16_bf16 v[84:99], v[120:123], v[128:131], v[84:99]
    v_add_u32 v4, 0xfffe9000, v4
    ds_read_b64_tr_b16 v[116:117], v6 offset:15488
    ds_read_b64_tr_b16 v[118:119], v6 offset:15968
    s_waitcnt lgkmcnt(9)
    v_mfma_f32_32x32x16_bf16 v[200:215], v[100:103], v[128:131], v[200:215]
    v_add_u32 v2, 0xfffe9000, v2
    ds_read_b64_tr_b16 v[120:121], v6 offset:15552
    ds_read_b64_tr_b16 v[122:123], v6 offset:16032
    s_waitcnt lgkmcnt(9)
    v_mfma_f32_32x32x16_bf16 v[216:231], v[104:107], v[128:131], v[216:231]
    v_add_u32 v13, 0xfffe9000, v13
    ds_read_b64_tr_b16 v[100:101], v6 offset:15616
    ds_read_b64_tr_b16 v[102:103], v6 offset:16096
    s_waitcnt lgkmcnt(8)
    v_mfma_f32_32x32x16_bf16 v[20:35], v[108:111], v[124:127], v[20:35]
    ds_read_b64_tr_b16 v[8:9], v7 offset:15360
    ds_read_b64_tr_b16 v[104:105], v6 offset:15680
    ds_read_b64_tr_b16 v[106:107], v16 offset:16160
    s_waitcnt lgkmcnt(9)
    v_mfma_f32_32x32x16_bf16 v[36:51], v[112:115], v[124:127], v[36:51]
    ds_read_b64_tr_b16 v[10:11], v7 offset:15840
    ds_read_b64_tr_b16 v[108:109], v6 offset:15744
    ds_read_b64_tr_b16 v[110:111], v6 offset:16224
    s_waitcnt lgkmcnt(10)
    v_mfma_f32_32x32x16_bf16 v[52:67], v[116:119], v[124:127], v[52:67]
    ds_read_b128 v[128:131], v5
    ds_read_b64_tr_b16 v[112:113], v6 offset:23040
    ds_read_b64_tr_b16 v[114:115], v16 offset:23520
    s_waitcnt lgkmcnt(11)
    v_mfma_f32_32x32x16_bf16 v[68:83], v[120:123], v[124:127], v[68:83]
    ds_read_b128 v[132:135], v14 offset:0
    ds_read_b64_tr_b16 v[116:117], v6 offset:23104
    ds_read_b64_tr_b16 v[118:119], v6 offset:23584
    s_waitcnt lgkmcnt(12)
    v_mfma_f32_32x32x16_bf16 v[84:99], v[100:103], v[124:127], v[84:99]
    ds_read_b128 v[136:139], v14 offset:2048
    ds_read_b64_tr_b16 v[120:121], v6 offset:23168
    ds_read_b64_tr_b16 v[122:123], v6 offset:23648
    s_waitcnt lgkmcnt(12)
    v_mfma_f32_32x32x16_bf16 v[200:215], v[104:107], v[124:127], v[200:215]
    v_add_u32 v5, 0xfffe9000, v5
    ds_read_b64_tr_b16 v[100:101], v6 offset:23232
    ds_read_b64_tr_b16 v[102:103], v6 offset:23712
    s_waitcnt lgkmcnt(11)
    v_mfma_f32_32x32x16_bf16 v[216:231], v[108:111], v[124:127], v[216:231]
    v_add_u32 v14, 0xfffe9000, v14
    ds_read_b64_tr_b16 v[104:105], v6 offset:23296
    ds_read_b64_tr_b16 v[106:107], v6 offset:23776
    s_waitcnt lgkmcnt(10)
    v_mfma_f32_32x32x16_bf16 v[20:35], v[112:115], v[128:131], v[20:35]
    v_add_u32 v7, 0xfffe9000, v7
    ds_read_b64_tr_b16 v[108:109], v6 offset:23360
    ds_read_b64_tr_b16 v[110:111], v16 offset:23840
    s_waitcnt lgkmcnt(9)
    v_mfma_f32_32x32x16_bf16 v[36:51], v[116:119], v[128:131], v[36:51]
    s_waitcnt lgkmcnt(8)
    v_mfma_f32_16x16x32_bf16 v[140:143], v[8:11], v[132:135], v[140:143]
    v_mfma_f32_16x16x32_bf16 v[144:147], v[8:11], v[136:139], v[144:147]
    v_add_u32 v16, 0xfffe9000, v16
    ds_read_b64_tr_b16 v[112:113], v6 offset:23424
    ds_read_b64_tr_b16 v[114:115], v6 offset:23904
    s_waitcnt lgkmcnt(8)
    v_mfma_f32_32x32x16_bf16 v[52:67], v[120:123], v[128:131], v[52:67]
    v_add_u32 v6, 0xfffe9000, v6
    s_barrier
    ds_read_b128 v[124:127], v2
    ds_read_b64_tr_b16 v[116:117], v6 offset:0
    ds_read_b64_tr_b16 v[118:119], v16 offset:480
    s_waitcnt lgkmcnt(9)
    v_mfma_f32_32x32x16_bf16 v[68:83], v[100:103], v[128:131], v[68:83]
    ds_read_b64_tr_b16 v[120:121], v6 offset:64
    ds_read_b64_tr_b16 v[122:123], v6 offset:544
    s_waitcnt lgkmcnt(9)
    v_mfma_f32_32x32x16_bf16 v[84:99], v[104:107], v[128:131], v[84:99]
    ds_read_b64_tr_b16 v[100:101], v6 offset:128
    ds_read_b64_tr_b16 v[102:103], v6 offset:608
    s_waitcnt lgkmcnt(9)
    v_mfma_f32_32x32x16_bf16 v[200:215], v[108:111], v[128:131], v[200:215]
    ds_read_b64_tr_b16 v[104:105], v6 offset:192
    ds_read_b64_tr_b16 v[106:107], v6 offset:672
    s_waitcnt lgkmcnt(9)
    v_mfma_f32_32x32x16_bf16 v[216:231], v[112:115], v[128:131], v[216:231]
    ds_read_b64_tr_b16 v[108:109], v6 offset:256
    ds_read_b64_tr_b16 v[110:111], v6 offset:736
    s_waitcnt lgkmcnt(8)
    v_mfma_f32_32x32x16_bf16 v[20:35], v[116:119], v[124:127], v[20:35]
    ds_read_b64_tr_b16 v[8:9], v7 offset:0
    ds_read_b64_tr_b16 v[112:113], v6 offset:320
    ds_read_b64_tr_b16 v[114:115], v16 offset:800
    s_waitcnt lgkmcnt(9)
    v_mfma_f32_32x32x16_bf16 v[36:51], v[120:123], v[124:127], v[36:51]
    ds_read_b64_tr_b16 v[10:11], v7 offset:480
    ds_read_b64_tr_b16 v[116:117], v6 offset:384
    ds_read_b64_tr_b16 v[118:119], v6 offset:864
    s_waitcnt lgkmcnt(10)
    v_mfma_f32_32x32x16_bf16 v[52:67], v[100:103], v[124:127], v[52:67]
    ds_read_b128 v[128:131], v3
    ds_read_b64_tr_b16 v[120:121], v6 offset:7680
    ds_read_b64_tr_b16 v[122:123], v16 offset:8160
    s_waitcnt lgkmcnt(11)
    v_mfma_f32_32x32x16_bf16 v[68:83], v[104:107], v[124:127], v[68:83]
    ds_read_b128 v[132:135], v13 offset:0
    ds_read_b64_tr_b16 v[100:101], v6 offset:7744
    ds_read_b64_tr_b16 v[102:103], v6 offset:8224
    s_waitcnt lgkmcnt(12)
    v_mfma_f32_32x32x16_bf16 v[84:99], v[108:111], v[124:127], v[84:99]
    ds_read_b128 v[136:139], v13 offset:2048
    ds_read_b64_tr_b16 v[104:105], v6 offset:7808
    ds_read_b64_tr_b16 v[106:107], v6 offset:8288
    s_waitcnt lgkmcnt(12)
    v_mfma_f32_32x32x16_bf16 v[200:215], v[112:115], v[124:127], v[200:215]
    ds_read_b64_tr_b16 v[108:109], v6 offset:7872
    ds_read_b64_tr_b16 v[110:111], v6 offset:8352
    s_waitcnt lgkmcnt(11)
    v_mfma_f32_32x32x16_bf16 v[216:231], v[116:119], v[124:127], v[216:231]
    ds_read_b64_tr_b16 v[112:113], v6 offset:7936
    ds_read_b64_tr_b16 v[114:115], v6 offset:8416
    s_waitcnt lgkmcnt(10)
    v_mfma_f32_32x32x16_bf16 v[20:35], v[120:123], v[128:131], v[20:35]
    ds_read_b64_tr_b16 v[116:117], v6 offset:8000
    ds_read_b64_tr_b16 v[118:119], v16 offset:8480
    s_waitcnt lgkmcnt(9)
    v_mfma_f32_32x32x16_bf16 v[36:51], v[100:103], v[128:131], v[36:51]
    s_waitcnt lgkmcnt(8)
    v_mfma_f32_16x16x32_bf16 v[140:143], v[8:11], v[132:135], v[140:143]
    v_mfma_f32_16x16x32_bf16 v[144:147], v[8:11], v[136:139], v[144:147]
    ds_read_b64_tr_b16 v[120:121], v6 offset:8064
    ds_read_b64_tr_b16 v[122:123], v6 offset:8544
    s_waitcnt lgkmcnt(8)
    v_mfma_f32_32x32x16_bf16 v[52:67], v[104:107], v[128:131], v[52:67]
    ds_read_b128 v[124:127], v4
    ds_read_b64_tr_b16 v[100:101], v6 offset:15360
    ds_read_b64_tr_b16 v[102:103], v16 offset:15840
    s_waitcnt lgkmcnt(9)
    v_mfma_f32_32x32x16_bf16 v[68:83], v[108:111], v[128:131], v[68:83]
    v_add_u32 v3, 0xb800, v3
    ds_read_b64_tr_b16 v[104:105], v6 offset:15424
    ds_read_b64_tr_b16 v[106:107], v6 offset:15904
    s_waitcnt lgkmcnt(9)
    v_mfma_f32_32x32x16_bf16 v[84:99], v[112:115], v[128:131], v[84:99]
    v_add_u32 v4, 0xb800, v4
    ds_read_b64_tr_b16 v[108:109], v6 offset:15488
    ds_read_b64_tr_b16 v[110:111], v6 offset:15968
    s_waitcnt lgkmcnt(9)
    v_mfma_f32_32x32x16_bf16 v[200:215], v[116:119], v[128:131], v[200:215]
    v_add_u32 v2, 0xb800, v2
    ds_read_b64_tr_b16 v[112:113], v6 offset:15552
    ds_read_b64_tr_b16 v[114:115], v6 offset:16032
    s_waitcnt lgkmcnt(9)
    v_mfma_f32_32x32x16_bf16 v[216:231], v[120:123], v[128:131], v[216:231]
    v_add_u32 v13, 0xb800, v13
    ds_read_b64_tr_b16 v[116:117], v6 offset:15616
    ds_read_b64_tr_b16 v[118:119], v6 offset:16096
    s_waitcnt lgkmcnt(8)
    v_mfma_f32_32x32x16_bf16 v[20:35], v[100:103], v[124:127], v[20:35]
    ds_read_b64_tr_b16 v[8:9], v7 offset:15360
    ds_read_b64_tr_b16 v[120:121], v6 offset:15680
    ds_read_b64_tr_b16 v[122:123], v16 offset:16160
    s_waitcnt lgkmcnt(9)
    v_mfma_f32_32x32x16_bf16 v[36:51], v[104:107], v[124:127], v[36:51]
    ds_read_b64_tr_b16 v[10:11], v7 offset:15840
    ds_read_b64_tr_b16 v[100:101], v6 offset:15744
    ds_read_b64_tr_b16 v[102:103], v6 offset:16224
    s_waitcnt lgkmcnt(10)
    v_mfma_f32_32x32x16_bf16 v[52:67], v[108:111], v[124:127], v[52:67]
    ds_read_b128 v[128:131], v5
    ds_read_b64_tr_b16 v[104:105], v6 offset:23040
    ds_read_b64_tr_b16 v[106:107], v16 offset:23520
    s_waitcnt lgkmcnt(11)
    v_mfma_f32_32x32x16_bf16 v[68:83], v[112:115], v[124:127], v[68:83]
    ds_read_b128 v[132:135], v14 offset:0
    ds_read_b64_tr_b16 v[108:109], v6 offset:23104
    ds_read_b64_tr_b16 v[110:111], v6 offset:23584
    s_waitcnt lgkmcnt(12)
    v_mfma_f32_32x32x16_bf16 v[84:99], v[116:119], v[124:127], v[84:99]
    ds_read_b128 v[136:139], v14 offset:2048
    ds_read_b64_tr_b16 v[112:113], v6 offset:23168
    ds_read_b64_tr_b16 v[114:115], v6 offset:23648
    s_waitcnt lgkmcnt(12)
    v_mfma_f32_32x32x16_bf16 v[200:215], v[120:123], v[124:127], v[200:215]
    v_add_u32 v5, 0xb800, v5
    ds_read_b64_tr_b16 v[116:117], v6 offset:23232
    ds_read_b64_tr_b16 v[118:119], v6 offset:23712
    s_waitcnt lgkmcnt(11)
    v_mfma_f32_32x32x16_bf16 v[216:231], v[100:103], v[124:127], v[216:231]
    v_add_u32 v14, 0xb800, v14
    ds_read_b64_tr_b16 v[120:121], v6 offset:23296
    ds_read_b64_tr_b16 v[122:123], v6 offset:23776
    s_waitcnt lgkmcnt(10)
    v_mfma_f32_32x32x16_bf16 v[20:35], v[104:107], v[128:131], v[20:35]
    v_add_u32 v7, 0xb800, v7
    ds_read_b64_tr_b16 v[100:101], v6 offset:23360
    ds_read_b64_tr_b16 v[102:103], v16 offset:23840
    s_waitcnt lgkmcnt(9)
    v_mfma_f32_32x32x16_bf16 v[36:51], v[108:111], v[128:131], v[36:51]
    s_waitcnt lgkmcnt(8)
    v_mfma_f32_16x16x32_bf16 v[140:143], v[8:11], v[132:135], v[140:143]
    v_mfma_f32_16x16x32_bf16 v[144:147], v[8:11], v[136:139], v[144:147]
    v_add_u32 v16, 0xb800, v16
    ds_read_b64_tr_b16 v[104:105], v6 offset:23424
    ds_read_b64_tr_b16 v[106:107], v6 offset:23904
    s_waitcnt lgkmcnt(8)
    v_mfma_f32_32x32x16_bf16 v[52:67], v[112:115], v[128:131], v[52:67]
    v_add_u32 v6, 0xb800, v6
    s_barrier
    ds_read_b128 v[124:127], v2
    ds_read_b64_tr_b16 v[108:109], v6 offset:0
    ds_read_b64_tr_b16 v[110:111], v16 offset:480
    s_waitcnt lgkmcnt(9)
    v_mfma_f32_32x32x16_bf16 v[68:83], v[116:119], v[128:131], v[68:83]
    ds_read_b64_tr_b16 v[112:113], v6 offset:64
    ds_read_b64_tr_b16 v[114:115], v6 offset:544
    s_waitcnt lgkmcnt(9)
    v_mfma_f32_32x32x16_bf16 v[84:99], v[120:123], v[128:131], v[84:99]
    ds_read_b64_tr_b16 v[116:117], v6 offset:128
    ds_read_b64_tr_b16 v[118:119], v6 offset:608
    s_waitcnt lgkmcnt(9)
    v_mfma_f32_32x32x16_bf16 v[200:215], v[100:103], v[128:131], v[200:215]
    ds_read_b64_tr_b16 v[120:121], v6 offset:192
    ds_read_b64_tr_b16 v[122:123], v6 offset:672
    s_waitcnt lgkmcnt(9)
    v_mfma_f32_32x32x16_bf16 v[216:231], v[104:107], v[128:131], v[216:231]
    ds_read_b64_tr_b16 v[100:101], v6 offset:256
    ds_read_b64_tr_b16 v[102:103], v6 offset:736
    s_waitcnt lgkmcnt(8)
    v_mfma_f32_32x32x16_bf16 v[20:35], v[108:111], v[124:127], v[20:35]
    ds_read_b64_tr_b16 v[8:9], v7 offset:0
    ds_read_b64_tr_b16 v[104:105], v6 offset:320
    ds_read_b64_tr_b16 v[106:107], v16 offset:800
    s_waitcnt lgkmcnt(9)
    v_mfma_f32_32x32x16_bf16 v[36:51], v[112:115], v[124:127], v[36:51]
    ds_read_b64_tr_b16 v[10:11], v7 offset:480
    ds_read_b64_tr_b16 v[108:109], v6 offset:384
    ds_read_b64_tr_b16 v[110:111], v6 offset:864
    s_waitcnt lgkmcnt(10)
    v_mfma_f32_32x32x16_bf16 v[52:67], v[116:119], v[124:127], v[52:67]
    ds_read_b128 v[128:131], v3
    ds_read_b64_tr_b16 v[112:113], v6 offset:7680
    ds_read_b64_tr_b16 v[114:115], v16 offset:8160
    s_waitcnt lgkmcnt(11)
    v_mfma_f32_32x32x16_bf16 v[68:83], v[120:123], v[124:127], v[68:83]
    ds_read_b128 v[132:135], v13 offset:0
    ds_read_b64_tr_b16 v[116:117], v6 offset:7744
    ds_read_b64_tr_b16 v[118:119], v6 offset:8224
    s_waitcnt lgkmcnt(12)
    v_mfma_f32_32x32x16_bf16 v[84:99], v[100:103], v[124:127], v[84:99]
    ds_read_b128 v[136:139], v13 offset:2048
    ds_read_b64_tr_b16 v[120:121], v6 offset:7808
    ds_read_b64_tr_b16 v[122:123], v6 offset:8288
    s_waitcnt lgkmcnt(12)
    v_mfma_f32_32x32x16_bf16 v[200:215], v[104:107], v[124:127], v[200:215]
    ds_read_b64_tr_b16 v[100:101], v6 offset:7872
    ds_read_b64_tr_b16 v[102:103], v6 offset:8352
    s_waitcnt lgkmcnt(11)
    v_mfma_f32_32x32x16_bf16 v[216:231], v[108:111], v[124:127], v[216:231]
    ds_read_b64_tr_b16 v[104:105], v6 offset:7936
    ds_read_b64_tr_b16 v[106:107], v6 offset:8416
    s_waitcnt lgkmcnt(10)
    v_mfma_f32_32x32x16_bf16 v[20:35], v[112:115], v[128:131], v[20:35]
    ds_read_b64_tr_b16 v[108:109], v6 offset:8000
    ds_read_b64_tr_b16 v[110:111], v16 offset:8480
    s_waitcnt lgkmcnt(9)
    v_mfma_f32_32x32x16_bf16 v[36:51], v[116:119], v[128:131], v[36:51]
    s_waitcnt lgkmcnt(8)
    v_mfma_f32_16x16x32_bf16 v[140:143], v[8:11], v[132:135], v[140:143]
    v_mfma_f32_16x16x32_bf16 v[144:147], v[8:11], v[136:139], v[144:147]
    ds_read_b64_tr_b16 v[112:113], v6 offset:8064
    ds_read_b64_tr_b16 v[114:115], v6 offset:8544
    s_waitcnt lgkmcnt(8)
    v_mfma_f32_32x32x16_bf16 v[52:67], v[120:123], v[128:131], v[52:67]
    ds_read_b128 v[124:127], v4
    ds_read_b64_tr_b16 v[116:117], v6 offset:15360
    ds_read_b64_tr_b16 v[118:119], v16 offset:15840
    s_waitcnt lgkmcnt(9)
    v_mfma_f32_32x32x16_bf16 v[68:83], v[100:103], v[128:131], v[68:83]
    v_add_u32 v3, 0xb800, v3
    ds_read_b64_tr_b16 v[120:121], v6 offset:15424
    ds_read_b64_tr_b16 v[122:123], v6 offset:15904
    s_waitcnt lgkmcnt(9)
    v_mfma_f32_32x32x16_bf16 v[84:99], v[104:107], v[128:131], v[84:99]
    v_add_u32 v4, 0xb800, v4
    ds_read_b64_tr_b16 v[100:101], v6 offset:15488
    ds_read_b64_tr_b16 v[102:103], v6 offset:15968
    s_waitcnt lgkmcnt(9)
    v_mfma_f32_32x32x16_bf16 v[200:215], v[108:111], v[128:131], v[200:215]
    v_add_u32 v2, 0xb800, v2
    ds_read_b64_tr_b16 v[104:105], v6 offset:15552
    ds_read_b64_tr_b16 v[106:107], v6 offset:16032
    s_waitcnt lgkmcnt(9)
    v_mfma_f32_32x32x16_bf16 v[216:231], v[112:115], v[128:131], v[216:231]
    v_add_u32 v13, 0xb800, v13
    ds_read_b64_tr_b16 v[108:109], v6 offset:15616
    ds_read_b64_tr_b16 v[110:111], v6 offset:16096
    s_waitcnt lgkmcnt(8)
    v_mfma_f32_32x32x16_bf16 v[20:35], v[116:119], v[124:127], v[20:35]
    ds_read_b64_tr_b16 v[8:9], v7 offset:15360
    ds_read_b64_tr_b16 v[112:113], v6 offset:15680
    ds_read_b64_tr_b16 v[114:115], v16 offset:16160
    s_waitcnt lgkmcnt(9)
    v_mfma_f32_32x32x16_bf16 v[36:51], v[120:123], v[124:127], v[36:51]
    ds_read_b64_tr_b16 v[10:11], v7 offset:15840
    ds_read_b64_tr_b16 v[116:117], v6 offset:15744
    ds_read_b64_tr_b16 v[118:119], v6 offset:16224
    s_waitcnt lgkmcnt(10)
    v_mfma_f32_32x32x16_bf16 v[52:67], v[100:103], v[124:127], v[52:67]
    ds_read_b128 v[128:131], v5
    ds_read_b64_tr_b16 v[120:121], v6 offset:23040
    ds_read_b64_tr_b16 v[122:123], v16 offset:23520
    s_waitcnt lgkmcnt(11)
    v_mfma_f32_32x32x16_bf16 v[68:83], v[104:107], v[124:127], v[68:83]
    ds_read_b128 v[132:135], v14 offset:0
    ds_read_b64_tr_b16 v[100:101], v6 offset:23104
    ds_read_b64_tr_b16 v[102:103], v6 offset:23584
    s_waitcnt lgkmcnt(12)
    v_mfma_f32_32x32x16_bf16 v[84:99], v[108:111], v[124:127], v[84:99]
    ds_read_b128 v[136:139], v14 offset:2048
    ds_read_b64_tr_b16 v[104:105], v6 offset:23168
    ds_read_b64_tr_b16 v[106:107], v6 offset:23648
    s_waitcnt lgkmcnt(12)
    v_mfma_f32_32x32x16_bf16 v[200:215], v[112:115], v[124:127], v[200:215]
    v_add_u32 v5, 0xb800, v5
    ds_read_b64_tr_b16 v[108:109], v6 offset:23232
    ds_read_b64_tr_b16 v[110:111], v6 offset:23712
    s_waitcnt lgkmcnt(11)
    v_mfma_f32_32x32x16_bf16 v[216:231], v[116:119], v[124:127], v[216:231]
    v_add_u32 v14, 0xb800, v14
    ds_read_b64_tr_b16 v[112:113], v6 offset:23296
    ds_read_b64_tr_b16 v[114:115], v6 offset:23776
    s_waitcnt lgkmcnt(10)
    v_mfma_f32_32x32x16_bf16 v[20:35], v[120:123], v[128:131], v[20:35]
    v_add_u32 v7, 0xb800, v7
    ds_read_b64_tr_b16 v[116:117], v6 offset:23360
    ds_read_b64_tr_b16 v[118:119], v16 offset:23840
    s_waitcnt lgkmcnt(9)
    v_mfma_f32_32x32x16_bf16 v[36:51], v[100:103], v[128:131], v[36:51]
    s_waitcnt lgkmcnt(8)
    v_mfma_f32_16x16x32_bf16 v[140:143], v[8:11], v[132:135], v[140:143]
    v_mfma_f32_16x16x32_bf16 v[144:147], v[8:11], v[136:139], v[144:147]
    v_add_u32 v16, 0xb800, v16
    ds_read_b64_tr_b16 v[120:121], v6 offset:23424
    ds_read_b64_tr_b16 v[122:123], v6 offset:23904
    s_waitcnt lgkmcnt(8)
    v_mfma_f32_32x32x16_bf16 v[52:67], v[104:107], v[128:131], v[52:67]
    v_add_u32 v6, 0xb800, v6
    s_barrier
    ds_read_b128 v[124:127], v2
    ds_read_b64_tr_b16 v[100:101], v6 offset:0
    ds_read_b64_tr_b16 v[102:103], v16 offset:480
    s_waitcnt lgkmcnt(9)
    v_mfma_f32_32x32x16_bf16 v[68:83], v[108:111], v[128:131], v[68:83]
    ds_read_b64_tr_b16 v[104:105], v6 offset:64
    ds_read_b64_tr_b16 v[106:107], v6 offset:544
    s_waitcnt lgkmcnt(9)
    v_mfma_f32_32x32x16_bf16 v[84:99], v[112:115], v[128:131], v[84:99]
    ds_read_b64_tr_b16 v[108:109], v6 offset:128
    ds_read_b64_tr_b16 v[110:111], v6 offset:608
    s_waitcnt lgkmcnt(9)
    v_mfma_f32_32x32x16_bf16 v[200:215], v[116:119], v[128:131], v[200:215]
    ds_read_b64_tr_b16 v[112:113], v6 offset:192
    ds_read_b64_tr_b16 v[114:115], v6 offset:672
    s_waitcnt lgkmcnt(9)
    v_mfma_f32_32x32x16_bf16 v[216:231], v[120:123], v[128:131], v[216:231]
    ds_read_b64_tr_b16 v[116:117], v6 offset:256
    ds_read_b64_tr_b16 v[118:119], v6 offset:736
    s_waitcnt lgkmcnt(8)
    v_mfma_f32_32x32x16_bf16 v[20:35], v[100:103], v[124:127], v[20:35]
    ds_read_b64_tr_b16 v[8:9], v7 offset:0
    ds_read_b64_tr_b16 v[120:121], v6 offset:320
    ds_read_b64_tr_b16 v[122:123], v16 offset:800
    s_waitcnt lgkmcnt(9)
    v_mfma_f32_32x32x16_bf16 v[36:51], v[104:107], v[124:127], v[36:51]
    ds_read_b64_tr_b16 v[10:11], v7 offset:480
    ds_read_b64_tr_b16 v[100:101], v6 offset:384
    ds_read_b64_tr_b16 v[102:103], v6 offset:864
    s_waitcnt lgkmcnt(10)
    v_mfma_f32_32x32x16_bf16 v[52:67], v[108:111], v[124:127], v[52:67]
    ds_read_b128 v[128:131], v3
    ds_read_b64_tr_b16 v[104:105], v6 offset:7680
    ds_read_b64_tr_b16 v[106:107], v16 offset:8160
    s_waitcnt lgkmcnt(11)
    v_mfma_f32_32x32x16_bf16 v[68:83], v[112:115], v[124:127], v[68:83]
    ds_read_b128 v[132:135], v13 offset:0
    ds_read_b64_tr_b16 v[108:109], v6 offset:7744
    ds_read_b64_tr_b16 v[110:111], v6 offset:8224
    s_waitcnt lgkmcnt(12)
    v_mfma_f32_32x32x16_bf16 v[84:99], v[116:119], v[124:127], v[84:99]
    ds_read_b128 v[136:139], v13 offset:2048
    ds_read_b64_tr_b16 v[112:113], v6 offset:7808
    ds_read_b64_tr_b16 v[114:115], v6 offset:8288
    s_waitcnt lgkmcnt(12)
    v_mfma_f32_32x32x16_bf16 v[200:215], v[120:123], v[124:127], v[200:215]
    ds_read_b64_tr_b16 v[116:117], v6 offset:7872
    ds_read_b64_tr_b16 v[118:119], v6 offset:8352
    s_waitcnt lgkmcnt(11)
    v_mfma_f32_32x32x16_bf16 v[216:231], v[100:103], v[124:127], v[216:231]
    ds_read_b64_tr_b16 v[120:121], v6 offset:7936
    ds_read_b64_tr_b16 v[122:123], v6 offset:8416
    s_waitcnt lgkmcnt(10)
    v_mfma_f32_32x32x16_bf16 v[20:35], v[104:107], v[128:131], v[20:35]
    ds_read_b64_tr_b16 v[100:101], v6 offset:8000
    ds_read_b64_tr_b16 v[102:103], v16 offset:8480
    s_waitcnt lgkmcnt(9)
    v_mfma_f32_32x32x16_bf16 v[36:51], v[108:111], v[128:131], v[36:51]
    s_waitcnt lgkmcnt(8)
    v_mfma_f32_16x16x32_bf16 v[140:143], v[8:11], v[132:135], v[140:143]
    v_mfma_f32_16x16x32_bf16 v[144:147], v[8:11], v[136:139], v[144:147]
    ds_read_b64_tr_b16 v[104:105], v6 offset:8064
    ds_read_b64_tr_b16 v[106:107], v6 offset:8544
    s_waitcnt lgkmcnt(8)
    v_mfma_f32_32x32x16_bf16 v[52:67], v[112:115], v[128:131], v[52:67]
    ds_read_b128 v[124:127], v4
    ds_read_b64_tr_b16 v[108:109], v6 offset:15360
    ds_read_b64_tr_b16 v[110:111], v16 offset:15840
    s_waitcnt lgkmcnt(9)
    v_mfma_f32_32x32x16_bf16 v[68:83], v[116:119], v[128:131], v[68:83]
    v_add_u32 v3, 0xfffe9000, v3
    ds_read_b64_tr_b16 v[112:113], v6 offset:15424
    ds_read_b64_tr_b16 v[114:115], v6 offset:15904
    s_waitcnt lgkmcnt(9)
    v_mfma_f32_32x32x16_bf16 v[84:99], v[120:123], v[128:131], v[84:99]
    v_add_u32 v4, 0xfffe9000, v4
    ds_read_b64_tr_b16 v[116:117], v6 offset:15488
    ds_read_b64_tr_b16 v[118:119], v6 offset:15968
    s_waitcnt lgkmcnt(9)
    v_mfma_f32_32x32x16_bf16 v[200:215], v[100:103], v[128:131], v[200:215]
    v_add_u32 v2, 0xfffe9000, v2
    ds_read_b64_tr_b16 v[120:121], v6 offset:15552
    ds_read_b64_tr_b16 v[122:123], v6 offset:16032
    s_waitcnt lgkmcnt(9)
    v_mfma_f32_32x32x16_bf16 v[216:231], v[104:107], v[128:131], v[216:231]
    v_add_u32 v13, 0xfffe9000, v13
    ds_read_b64_tr_b16 v[100:101], v6 offset:15616
    ds_read_b64_tr_b16 v[102:103], v6 offset:16096
    s_waitcnt lgkmcnt(8)
    v_mfma_f32_32x32x16_bf16 v[20:35], v[108:111], v[124:127], v[20:35]
    ds_read_b64_tr_b16 v[8:9], v7 offset:15360
    ds_read_b64_tr_b16 v[104:105], v6 offset:15680
    ds_read_b64_tr_b16 v[106:107], v16 offset:16160
    s_waitcnt lgkmcnt(9)
    v_mfma_f32_32x32x16_bf16 v[36:51], v[112:115], v[124:127], v[36:51]
    ds_read_b64_tr_b16 v[10:11], v7 offset:15840
    ds_read_b64_tr_b16 v[108:109], v6 offset:15744
    ds_read_b64_tr_b16 v[110:111], v6 offset:16224
    s_waitcnt lgkmcnt(10)
    v_mfma_f32_32x32x16_bf16 v[52:67], v[116:119], v[124:127], v[52:67]
    ds_read_b128 v[128:131], v5
    ds_read_b64_tr_b16 v[112:113], v6 offset:23040
    ds_read_b64_tr_b16 v[114:115], v16 offset:23520
    s_waitcnt lgkmcnt(11)
    v_mfma_f32_32x32x16_bf16 v[68:83], v[120:123], v[124:127], v[68:83]
    ds_read_b128 v[132:135], v14 offset:0
    ds_read_b64_tr_b16 v[116:117], v6 offset:23104
    ds_read_b64_tr_b16 v[118:119], v6 offset:23584
    s_waitcnt lgkmcnt(12)
    v_mfma_f32_32x32x16_bf16 v[84:99], v[100:103], v[124:127], v[84:99]
    ds_read_b128 v[136:139], v14 offset:2048
    ds_read_b64_tr_b16 v[120:121], v6 offset:23168
    ds_read_b64_tr_b16 v[122:123], v6 offset:23648
    s_waitcnt lgkmcnt(12)
    v_mfma_f32_32x32x16_bf16 v[200:215], v[104:107], v[124:127], v[200:215]
    v_add_u32 v5, 0xfffe9000, v5
    ds_read_b64_tr_b16 v[100:101], v6 offset:23232
    ds_read_b64_tr_b16 v[102:103], v6 offset:23712
    s_waitcnt lgkmcnt(11)
    v_mfma_f32_32x32x16_bf16 v[216:231], v[108:111], v[124:127], v[216:231]
    v_add_u32 v14, 0xfffe9000, v14
    ds_read_b64_tr_b16 v[104:105], v6 offset:23296
    ds_read_b64_tr_b16 v[106:107], v6 offset:23776
    s_waitcnt lgkmcnt(10)
    v_mfma_f32_32x32x16_bf16 v[20:35], v[112:115], v[128:131], v[20:35]
    v_add_u32 v7, 0xfffe9000, v7
    ds_read_b64_tr_b16 v[108:109], v6 offset:23360
    ds_read_b64_tr_b16 v[110:111], v16 offset:23840
    s_waitcnt lgkmcnt(9)
    v_mfma_f32_32x32x16_bf16 v[36:51], v[116:119], v[128:131], v[36:51]
    s_waitcnt lgkmcnt(8)
    v_mfma_f32_16x16x32_bf16 v[140:143], v[8:11], v[132:135], v[140:143]
    v_mfma_f32_16x16x32_bf16 v[144:147], v[8:11], v[136:139], v[144:147]
    v_add_u32 v16, 0xfffe9000, v16
    ds_read_b64_tr_b16 v[112:113], v6 offset:23424
    ds_read_b64_tr_b16 v[114:115], v6 offset:23904
    s_waitcnt lgkmcnt(8)
    v_mfma_f32_32x32x16_bf16 v[52:67], v[120:123], v[128:131], v[52:67]
    v_add_u32 v6, 0xfffe9000, v6
    s_barrier
    ds_read_b128 v[124:127], v2
    ds_read_b64_tr_b16 v[116:117], v6 offset:0
    ds_read_b64_tr_b16 v[118:119], v16 offset:480
    s_waitcnt lgkmcnt(9)
    v_mfma_f32_32x32x16_bf16 v[68:83], v[100:103], v[128:131], v[68:83]
    ds_read_b64_tr_b16 v[120:121], v6 offset:64
    ds_read_b64_tr_b16 v[122:123], v6 offset:544
    s_waitcnt lgkmcnt(9)
    v_mfma_f32_32x32x16_bf16 v[84:99], v[104:107], v[128:131], v[84:99]
    ds_read_b64_tr_b16 v[100:101], v6 offset:128
    ds_read_b64_tr_b16 v[102:103], v6 offset:608
    s_waitcnt lgkmcnt(9)
    v_mfma_f32_32x32x16_bf16 v[200:215], v[108:111], v[128:131], v[200:215]
    ds_read_b64_tr_b16 v[104:105], v6 offset:192
    ds_read_b64_tr_b16 v[106:107], v6 offset:672
    s_waitcnt lgkmcnt(9)
    v_mfma_f32_32x32x16_bf16 v[216:231], v[112:115], v[128:131], v[216:231]
    ds_read_b64_tr_b16 v[108:109], v6 offset:256
    ds_read_b64_tr_b16 v[110:111], v6 offset:736
    s_waitcnt lgkmcnt(8)
    v_mfma_f32_32x32x16_bf16 v[20:35], v[116:119], v[124:127], v[20:35]
    ds_read_b64_tr_b16 v[8:9], v7 offset:0
    ds_read_b64_tr_b16 v[112:113], v6 offset:320
    ds_read_b64_tr_b16 v[114:115], v16 offset:800
    s_waitcnt lgkmcnt(9)
    v_mfma_f32_32x32x16_bf16 v[36:51], v[120:123], v[124:127], v[36:51]
    ds_read_b64_tr_b16 v[10:11], v7 offset:480
    ds_read_b64_tr_b16 v[116:117], v6 offset:384
    ds_read_b64_tr_b16 v[118:119], v6 offset:864
    s_waitcnt lgkmcnt(10)
    v_mfma_f32_32x32x16_bf16 v[52:67], v[100:103], v[124:127], v[52:67]
    ds_read_b128 v[128:131], v3
    ds_read_b64_tr_b16 v[120:121], v6 offset:7680
    ds_read_b64_tr_b16 v[122:123], v16 offset:8160
    s_waitcnt lgkmcnt(11)
    v_mfma_f32_32x32x16_bf16 v[68:83], v[104:107], v[124:127], v[68:83]
    ds_read_b128 v[132:135], v13 offset:0
    ds_read_b64_tr_b16 v[100:101], v6 offset:7744
    ds_read_b64_tr_b16 v[102:103], v6 offset:8224
    s_waitcnt lgkmcnt(12)
    v_mfma_f32_32x32x16_bf16 v[84:99], v[108:111], v[124:127], v[84:99]
    ds_read_b128 v[136:139], v13 offset:2048
    ds_read_b64_tr_b16 v[104:105], v6 offset:7808
    ds_read_b64_tr_b16 v[106:107], v6 offset:8288
    s_waitcnt lgkmcnt(12)
    v_mfma_f32_32x32x16_bf16 v[200:215], v[112:115], v[124:127], v[200:215]
    ds_read_b64_tr_b16 v[108:109], v6 offset:7872
    ds_read_b64_tr_b16 v[110:111], v6 offset:8352
    s_waitcnt lgkmcnt(11)
    v_mfma_f32_32x32x16_bf16 v[216:231], v[116:119], v[124:127], v[216:231]
    ds_read_b64_tr_b16 v[112:113], v6 offset:7936
    ds_read_b64_tr_b16 v[114:115], v6 offset:8416
    s_waitcnt lgkmcnt(10)
    v_mfma_f32_32x32x16_bf16 v[20:35], v[120:123], v[128:131], v[20:35]
    ds_read_b64_tr_b16 v[116:117], v6 offset:8000
    ds_read_b64_tr_b16 v[118:119], v16 offset:8480
    s_waitcnt lgkmcnt(9)
    v_mfma_f32_32x32x16_bf16 v[36:51], v[100:103], v[128:131], v[36:51]
    s_waitcnt lgkmcnt(8)
    v_mfma_f32_16x16x32_bf16 v[140:143], v[8:11], v[132:135], v[140:143]
    v_mfma_f32_16x16x32_bf16 v[144:147], v[8:11], v[136:139], v[144:147]
    ds_read_b64_tr_b16 v[120:121], v6 offset:8064
    ds_read_b64_tr_b16 v[122:123], v6 offset:8544
    s_waitcnt lgkmcnt(8)
    v_mfma_f32_32x32x16_bf16 v[52:67], v[104:107], v[128:131], v[52:67]
    ds_read_b128 v[124:127], v4
    ds_read_b64_tr_b16 v[100:101], v6 offset:15360
    ds_read_b64_tr_b16 v[102:103], v16 offset:15840
    s_waitcnt lgkmcnt(9)
    v_mfma_f32_32x32x16_bf16 v[68:83], v[108:111], v[128:131], v[68:83]
    v_add_u32 v3, 0xb800, v3
    ds_read_b64_tr_b16 v[104:105], v6 offset:15424
    ds_read_b64_tr_b16 v[106:107], v6 offset:15904
    s_waitcnt lgkmcnt(9)
    v_mfma_f32_32x32x16_bf16 v[84:99], v[112:115], v[128:131], v[84:99]
    v_add_u32 v4, 0xb800, v4
    ds_read_b64_tr_b16 v[108:109], v6 offset:15488
    ds_read_b64_tr_b16 v[110:111], v6 offset:15968
    s_waitcnt lgkmcnt(9)
    v_mfma_f32_32x32x16_bf16 v[200:215], v[116:119], v[128:131], v[200:215]
    v_add_u32 v2, 0xb800, v2
    ds_read_b64_tr_b16 v[112:113], v6 offset:15552
    ds_read_b64_tr_b16 v[114:115], v6 offset:16032
    s_waitcnt lgkmcnt(9)
    v_mfma_f32_32x32x16_bf16 v[216:231], v[120:123], v[128:131], v[216:231]
    v_add_u32 v13, 0xb800, v13
    ds_read_b64_tr_b16 v[116:117], v6 offset:15616
    ds_read_b64_tr_b16 v[118:119], v6 offset:16096
    s_waitcnt lgkmcnt(8)
    v_mfma_f32_32x32x16_bf16 v[20:35], v[100:103], v[124:127], v[20:35]
    ds_read_b64_tr_b16 v[8:9], v7 offset:15360
    ds_read_b64_tr_b16 v[120:121], v6 offset:15680
    ds_read_b64_tr_b16 v[122:123], v16 offset:16160
    s_waitcnt lgkmcnt(9)
    v_mfma_f32_32x32x16_bf16 v[36:51], v[104:107], v[124:127], v[36:51]
    ds_read_b64_tr_b16 v[10:11], v7 offset:15840
    ds_read_b64_tr_b16 v[100:101], v6 offset:15744
    ds_read_b64_tr_b16 v[102:103], v6 offset:16224
    s_waitcnt lgkmcnt(10)
    v_mfma_f32_32x32x16_bf16 v[52:67], v[108:111], v[124:127], v[52:67]
    ds_read_b128 v[128:131], v5
    ds_read_b64_tr_b16 v[104:105], v6 offset:23040
    ds_read_b64_tr_b16 v[106:107], v16 offset:23520
    s_waitcnt lgkmcnt(11)
    v_mfma_f32_32x32x16_bf16 v[68:83], v[112:115], v[124:127], v[68:83]
    ds_read_b128 v[132:135], v14 offset:0
    ds_read_b64_tr_b16 v[108:109], v6 offset:23104
    ds_read_b64_tr_b16 v[110:111], v6 offset:23584
    s_waitcnt lgkmcnt(12)
    v_mfma_f32_32x32x16_bf16 v[84:99], v[116:119], v[124:127], v[84:99]
    ds_read_b128 v[136:139], v14 offset:2048
    ds_read_b64_tr_b16 v[112:113], v6 offset:23168
    ds_read_b64_tr_b16 v[114:115], v6 offset:23648
    s_waitcnt lgkmcnt(12)
    v_mfma_f32_32x32x16_bf16 v[200:215], v[120:123], v[124:127], v[200:215]
    v_add_u32 v5, 0xb800, v5
    ds_read_b64_tr_b16 v[116:117], v6 offset:23232
    ds_read_b64_tr_b16 v[118:119], v6 offset:23712
    s_waitcnt lgkmcnt(11)
    v_mfma_f32_32x32x16_bf16 v[216:231], v[100:103], v[124:127], v[216:231]
    v_add_u32 v14, 0xb800, v14
    ds_read_b64_tr_b16 v[120:121], v6 offset:23296
    ds_read_b64_tr_b16 v[122:123], v6 offset:23776
    s_waitcnt lgkmcnt(10)
    v_mfma_f32_32x32x16_bf16 v[20:35], v[104:107], v[128:131], v[20:35]
    v_add_u32 v7, 0xb800, v7
    ds_read_b64_tr_b16 v[100:101], v6 offset:23360
    ds_read_b64_tr_b16 v[102:103], v16 offset:23840
    s_waitcnt lgkmcnt(9)
    v_mfma_f32_32x32x16_bf16 v[36:51], v[108:111], v[128:131], v[36:51]
    s_waitcnt lgkmcnt(8)
    v_mfma_f32_16x16x32_bf16 v[140:143], v[8:11], v[132:135], v[140:143]
    v_mfma_f32_16x16x32_bf16 v[144:147], v[8:11], v[136:139], v[144:147]
    v_add_u32 v16, 0xb800, v16
    ds_read_b64_tr_b16 v[104:105], v6 offset:23424
    ds_read_b64_tr_b16 v[106:107], v6 offset:23904
    s_waitcnt lgkmcnt(8)
    v_mfma_f32_32x32x16_bf16 v[52:67], v[112:115], v[128:131], v[52:67]
    v_add_u32 v6, 0xb800, v6
    s_barrier
    ds_read_b128 v[124:127], v2
    ds_read_b64_tr_b16 v[108:109], v6 offset:0
    ds_read_b64_tr_b16 v[110:111], v16 offset:480
    s_waitcnt lgkmcnt(9)
    v_mfma_f32_32x32x16_bf16 v[68:83], v[116:119], v[128:131], v[68:83]
    ds_read_b64_tr_b16 v[112:113], v6 offset:64
    ds_read_b64_tr_b16 v[114:115], v6 offset:544
    s_waitcnt lgkmcnt(9)
    v_mfma_f32_32x32x16_bf16 v[84:99], v[120:123], v[128:131], v[84:99]
    ds_read_b64_tr_b16 v[116:117], v6 offset:128
    ds_read_b64_tr_b16 v[118:119], v6 offset:608
    s_waitcnt lgkmcnt(9)
    v_mfma_f32_32x32x16_bf16 v[200:215], v[100:103], v[128:131], v[200:215]
    ds_read_b64_tr_b16 v[120:121], v6 offset:192
    ds_read_b64_tr_b16 v[122:123], v6 offset:672
    s_waitcnt lgkmcnt(9)
    v_mfma_f32_32x32x16_bf16 v[216:231], v[104:107], v[128:131], v[216:231]
    ds_read_b64_tr_b16 v[100:101], v6 offset:256
    ds_read_b64_tr_b16 v[102:103], v6 offset:736
    s_waitcnt lgkmcnt(8)
    v_mfma_f32_32x32x16_bf16 v[20:35], v[108:111], v[124:127], v[20:35]
    ds_read_b64_tr_b16 v[8:9], v7 offset:0
    ds_read_b64_tr_b16 v[104:105], v6 offset:320
    ds_read_b64_tr_b16 v[106:107], v16 offset:800
    s_waitcnt lgkmcnt(9)
    v_mfma_f32_32x32x16_bf16 v[36:51], v[112:115], v[124:127], v[36:51]
    ds_read_b64_tr_b16 v[10:11], v7 offset:480
    ds_read_b64_tr_b16 v[108:109], v6 offset:384
    ds_read_b64_tr_b16 v[110:111], v6 offset:864
    s_waitcnt lgkmcnt(10)
    v_mfma_f32_32x32x16_bf16 v[52:67], v[116:119], v[124:127], v[52:67]
    ds_read_b128 v[128:131], v3
    ds_read_b64_tr_b16 v[112:113], v6 offset:7680
    ds_read_b64_tr_b16 v[114:115], v16 offset:8160
    s_waitcnt lgkmcnt(11)
    v_mfma_f32_32x32x16_bf16 v[68:83], v[120:123], v[124:127], v[68:83]
    ds_read_b128 v[132:135], v13 offset:0
    ds_read_b64_tr_b16 v[116:117], v6 offset:7744
    ds_read_b64_tr_b16 v[118:119], v6 offset:8224
    s_waitcnt lgkmcnt(12)
    v_mfma_f32_32x32x16_bf16 v[84:99], v[100:103], v[124:127], v[84:99]
    ds_read_b128 v[136:139], v13 offset:2048
    ds_read_b64_tr_b16 v[120:121], v6 offset:7808
    ds_read_b64_tr_b16 v[122:123], v6 offset:8288
    s_waitcnt lgkmcnt(12)
    v_mfma_f32_32x32x16_bf16 v[200:215], v[104:107], v[124:127], v[200:215]
    ds_read_b64_tr_b16 v[100:101], v6 offset:7872
    ds_read_b64_tr_b16 v[102:103], v6 offset:8352
    s_waitcnt lgkmcnt(11)
    v_mfma_f32_32x32x16_bf16 v[216:231], v[108:111], v[124:127], v[216:231]
    ds_read_b64_tr_b16 v[104:105], v6 offset:7936
    ds_read_b64_tr_b16 v[106:107], v6 offset:8416
    s_waitcnt lgkmcnt(10)
    v_mfma_f32_32x32x16_bf16 v[20:35], v[112:115], v[128:131], v[20:35]
    ds_read_b64_tr_b16 v[108:109], v6 offset:8000
    ds_read_b64_tr_b16 v[110:111], v16 offset:8480
    s_waitcnt lgkmcnt(9)
    v_mfma_f32_32x32x16_bf16 v[36:51], v[116:119], v[128:131], v[36:51]
    s_waitcnt lgkmcnt(8)
    v_mfma_f32_16x16x32_bf16 v[140:143], v[8:11], v[132:135], v[140:143]
    v_mfma_f32_16x16x32_bf16 v[144:147], v[8:11], v[136:139], v[144:147]
    ds_read_b64_tr_b16 v[112:113], v6 offset:8064
    ds_read_b64_tr_b16 v[114:115], v6 offset:8544
    s_waitcnt lgkmcnt(8)
    v_mfma_f32_32x32x16_bf16 v[52:67], v[120:123], v[128:131], v[52:67]
    ds_read_b128 v[124:127], v4
    ds_read_b64_tr_b16 v[116:117], v6 offset:15360
    ds_read_b64_tr_b16 v[118:119], v16 offset:15840
    s_waitcnt lgkmcnt(9)
    v_mfma_f32_32x32x16_bf16 v[68:83], v[100:103], v[128:131], v[68:83]
    v_add_u32 v3, 0xb800, v3
    ds_read_b64_tr_b16 v[120:121], v6 offset:15424
    ds_read_b64_tr_b16 v[122:123], v6 offset:15904
    s_waitcnt lgkmcnt(9)
    v_mfma_f32_32x32x16_bf16 v[84:99], v[104:107], v[128:131], v[84:99]
    v_add_u32 v4, 0xb800, v4
    ds_read_b64_tr_b16 v[100:101], v6 offset:15488
    ds_read_b64_tr_b16 v[102:103], v6 offset:15968
    s_waitcnt lgkmcnt(9)
    v_mfma_f32_32x32x16_bf16 v[200:215], v[108:111], v[128:131], v[200:215]
    v_add_u32 v2, 0xb800, v2
    ds_read_b64_tr_b16 v[104:105], v6 offset:15552
    ds_read_b64_tr_b16 v[106:107], v6 offset:16032
    s_waitcnt lgkmcnt(9)
    v_mfma_f32_32x32x16_bf16 v[216:231], v[112:115], v[128:131], v[216:231]
    v_add_u32 v13, 0xb800, v13
    ds_read_b64_tr_b16 v[108:109], v6 offset:15616
    ds_read_b64_tr_b16 v[110:111], v6 offset:16096
    s_waitcnt lgkmcnt(8)
    v_mfma_f32_32x32x16_bf16 v[20:35], v[116:119], v[124:127], v[20:35]
    ds_read_b64_tr_b16 v[8:9], v7 offset:15360
    ds_read_b64_tr_b16 v[112:113], v6 offset:15680
    ds_read_b64_tr_b16 v[114:115], v16 offset:16160
    s_waitcnt lgkmcnt(9)
    v_mfma_f32_32x32x16_bf16 v[36:51], v[120:123], v[124:127], v[36:51]
    ds_read_b64_tr_b16 v[10:11], v7 offset:15840
    ds_read_b64_tr_b16 v[116:117], v6 offset:15744
    ds_read_b64_tr_b16 v[118:119], v6 offset:16224
    s_waitcnt lgkmcnt(10)
    v_mfma_f32_32x32x16_bf16 v[52:67], v[100:103], v[124:127], v[52:67]
    ds_read_b128 v[128:131], v5
    ds_read_b64_tr_b16 v[120:121], v6 offset:23040
    ds_read_b64_tr_b16 v[122:123], v16 offset:23520
    s_waitcnt lgkmcnt(11)
    v_mfma_f32_32x32x16_bf16 v[68:83], v[104:107], v[124:127], v[68:83]
    ds_read_b128 v[132:135], v14 offset:0
    ds_read_b64_tr_b16 v[100:101], v6 offset:23104
    ds_read_b64_tr_b16 v[102:103], v6 offset:23584
    s_waitcnt lgkmcnt(12)
    v_mfma_f32_32x32x16_bf16 v[84:99], v[108:111], v[124:127], v[84:99]
    ds_read_b128 v[136:139], v14 offset:2048
    ds_read_b64_tr_b16 v[104:105], v6 offset:23168
    ds_read_b64_tr_b16 v[106:107], v6 offset:23648
    s_waitcnt lgkmcnt(12)
    v_mfma_f32_32x32x16_bf16 v[200:215], v[112:115], v[124:127], v[200:215]
    v_add_u32 v5, 0xb800, v5
    ds_read_b64_tr_b16 v[108:109], v6 offset:23232
    ds_read_b64_tr_b16 v[110:111], v6 offset:23712
    s_waitcnt lgkmcnt(11)
    v_mfma_f32_32x32x16_bf16 v[216:231], v[116:119], v[124:127], v[216:231]
    v_add_u32 v14, 0xb800, v14
    ds_read_b64_tr_b16 v[112:113], v6 offset:23296
    ds_read_b64_tr_b16 v[114:115], v6 offset:23776
    s_waitcnt lgkmcnt(10)
    v_mfma_f32_32x32x16_bf16 v[20:35], v[120:123], v[128:131], v[20:35]
    v_add_u32 v7, 0xb800, v7
    ds_read_b64_tr_b16 v[116:117], v6 offset:23360
    ds_read_b64_tr_b16 v[118:119], v16 offset:23840
    s_waitcnt lgkmcnt(9)
    v_mfma_f32_32x32x16_bf16 v[36:51], v[100:103], v[128:131], v[36:51]
    s_waitcnt lgkmcnt(8)
    v_mfma_f32_16x16x32_bf16 v[140:143], v[8:11], v[132:135], v[140:143]
    v_mfma_f32_16x16x32_bf16 v[144:147], v[8:11], v[136:139], v[144:147]
    v_add_u32 v16, 0xb800, v16
    ds_read_b64_tr_b16 v[120:121], v6 offset:23424
    ds_read_b64_tr_b16 v[122:123], v6 offset:23904
    s_waitcnt lgkmcnt(8)
    v_mfma_f32_32x32x16_bf16 v[52:67], v[104:107], v[128:131], v[52:67]
    v_add_u32 v6, 0xb800, v6
    s_barrier
    ds_read_b128 v[124:127], v2
    ds_read_b64_tr_b16 v[100:101], v6 offset:0
    ds_read_b64_tr_b16 v[102:103], v16 offset:480
    s_waitcnt lgkmcnt(9)
    v_mfma_f32_32x32x16_bf16 v[68:83], v[108:111], v[128:131], v[68:83]
    ds_read_b64_tr_b16 v[104:105], v6 offset:64
    ds_read_b64_tr_b16 v[106:107], v6 offset:544
    s_waitcnt lgkmcnt(9)
    v_mfma_f32_32x32x16_bf16 v[84:99], v[112:115], v[128:131], v[84:99]
    ds_read_b64_tr_b16 v[108:109], v6 offset:128
    ds_read_b64_tr_b16 v[110:111], v6 offset:608
    s_waitcnt lgkmcnt(9)
    v_mfma_f32_32x32x16_bf16 v[200:215], v[116:119], v[128:131], v[200:215]
    ds_read_b64_tr_b16 v[112:113], v6 offset:192
    ds_read_b64_tr_b16 v[114:115], v6 offset:672
    s_waitcnt lgkmcnt(9)
    v_mfma_f32_32x32x16_bf16 v[216:231], v[120:123], v[128:131], v[216:231]
    ds_read_b64_tr_b16 v[116:117], v6 offset:256
    ds_read_b64_tr_b16 v[118:119], v6 offset:736
    s_waitcnt lgkmcnt(8)
    v_mfma_f32_32x32x16_bf16 v[20:35], v[100:103], v[124:127], v[20:35]
    ds_read_b64_tr_b16 v[8:9], v7 offset:0
    ds_read_b64_tr_b16 v[120:121], v6 offset:320
    ds_read_b64_tr_b16 v[122:123], v16 offset:800
    s_waitcnt lgkmcnt(9)
    v_mfma_f32_32x32x16_bf16 v[36:51], v[104:107], v[124:127], v[36:51]
    ds_read_b64_tr_b16 v[10:11], v7 offset:480
    ds_read_b64_tr_b16 v[100:101], v6 offset:384
    ds_read_b64_tr_b16 v[102:103], v6 offset:864
    s_waitcnt lgkmcnt(10)
    v_mfma_f32_32x32x16_bf16 v[52:67], v[108:111], v[124:127], v[52:67]
    ds_read_b128 v[128:131], v3
    ds_read_b64_tr_b16 v[104:105], v6 offset:7680
    ds_read_b64_tr_b16 v[106:107], v16 offset:8160
    s_waitcnt lgkmcnt(11)
    v_mfma_f32_32x32x16_bf16 v[68:83], v[112:115], v[124:127], v[68:83]
    ds_read_b128 v[132:135], v13 offset:0
    ds_read_b64_tr_b16 v[108:109], v6 offset:7744
    ds_read_b64_tr_b16 v[110:111], v6 offset:8224
    s_waitcnt lgkmcnt(12)
    v_mfma_f32_32x32x16_bf16 v[84:99], v[116:119], v[124:127], v[84:99]
    ds_read_b128 v[136:139], v13 offset:2048
    ds_read_b64_tr_b16 v[112:113], v6 offset:7808
    ds_read_b64_tr_b16 v[114:115], v6 offset:8288
    s_waitcnt lgkmcnt(12)
    v_mfma_f32_32x32x16_bf16 v[200:215], v[120:123], v[124:127], v[200:215]
    ds_read_b64_tr_b16 v[116:117], v6 offset:7872
    ds_read_b64_tr_b16 v[118:119], v6 offset:8352
    s_waitcnt lgkmcnt(11)
    v_mfma_f32_32x32x16_bf16 v[216:231], v[100:103], v[124:127], v[216:231]
    ds_read_b64_tr_b16 v[120:121], v6 offset:7936
    ds_read_b64_tr_b16 v[122:123], v6 offset:8416
    s_waitcnt lgkmcnt(10)
    v_mfma_f32_32x32x16_bf16 v[20:35], v[104:107], v[128:131], v[20:35]
    ds_read_b64_tr_b16 v[100:101], v6 offset:8000
    ds_read_b64_tr_b16 v[102:103], v16 offset:8480
    s_waitcnt lgkmcnt(9)
    v_mfma_f32_32x32x16_bf16 v[36:51], v[108:111], v[128:131], v[36:51]
    s_waitcnt lgkmcnt(8)
    v_mfma_f32_16x16x32_bf16 v[140:143], v[8:11], v[132:135], v[140:143]
    v_mfma_f32_16x16x32_bf16 v[144:147], v[8:11], v[136:139], v[144:147]
    ds_read_b64_tr_b16 v[104:105], v6 offset:8064
    ds_read_b64_tr_b16 v[106:107], v6 offset:8544
    s_waitcnt lgkmcnt(8)
    v_mfma_f32_32x32x16_bf16 v[52:67], v[112:115], v[128:131], v[52:67]
    ds_read_b128 v[124:127], v4
    ds_read_b64_tr_b16 v[108:109], v6 offset:15360
    ds_read_b64_tr_b16 v[110:111], v16 offset:15840
    s_waitcnt lgkmcnt(9)
    v_mfma_f32_32x32x16_bf16 v[68:83], v[116:119], v[128:131], v[68:83]
    v_add_u32 v3, 0xfffe9000, v3
    ds_read_b64_tr_b16 v[112:113], v6 offset:15424
    ds_read_b64_tr_b16 v[114:115], v6 offset:15904
    s_waitcnt lgkmcnt(9)
    v_mfma_f32_32x32x16_bf16 v[84:99], v[120:123], v[128:131], v[84:99]
    v_add_u32 v4, 0xfffe9000, v4
    ds_read_b64_tr_b16 v[116:117], v6 offset:15488
    ds_read_b64_tr_b16 v[118:119], v6 offset:15968
    s_waitcnt lgkmcnt(9)
    v_mfma_f32_32x32x16_bf16 v[200:215], v[100:103], v[128:131], v[200:215]
    v_add_u32 v2, 0xfffe9000, v2
    ds_read_b64_tr_b16 v[120:121], v6 offset:15552
    ds_read_b64_tr_b16 v[122:123], v6 offset:16032
    s_waitcnt lgkmcnt(9)
    v_mfma_f32_32x32x16_bf16 v[216:231], v[104:107], v[128:131], v[216:231]
    v_add_u32 v13, 0xfffe9000, v13
    ds_read_b64_tr_b16 v[100:101], v6 offset:15616
    ds_read_b64_tr_b16 v[102:103], v6 offset:16096
    s_waitcnt lgkmcnt(8)
    v_mfma_f32_32x32x16_bf16 v[20:35], v[108:111], v[124:127], v[20:35]
    ds_read_b64_tr_b16 v[8:9], v7 offset:15360
    ds_read_b64_tr_b16 v[104:105], v6 offset:15680
    ds_read_b64_tr_b16 v[106:107], v16 offset:16160
    s_waitcnt lgkmcnt(9)
    v_mfma_f32_32x32x16_bf16 v[36:51], v[112:115], v[124:127], v[36:51]
    ds_read_b64_tr_b16 v[10:11], v7 offset:15840
    ds_read_b64_tr_b16 v[108:109], v6 offset:15744
    ds_read_b64_tr_b16 v[110:111], v6 offset:16224
    s_waitcnt lgkmcnt(10)
    v_mfma_f32_32x32x16_bf16 v[52:67], v[116:119], v[124:127], v[52:67]
    ds_read_b128 v[128:131], v5
    ds_read_b64_tr_b16 v[112:113], v6 offset:23040
    ds_read_b64_tr_b16 v[114:115], v16 offset:23520
    s_waitcnt lgkmcnt(11)
    v_mfma_f32_32x32x16_bf16 v[68:83], v[120:123], v[124:127], v[68:83]
    ds_read_b128 v[132:135], v14 offset:0
    ds_read_b64_tr_b16 v[116:117], v6 offset:23104
    ds_read_b64_tr_b16 v[118:119], v6 offset:23584
    s_waitcnt lgkmcnt(12)
    v_mfma_f32_32x32x16_bf16 v[84:99], v[100:103], v[124:127], v[84:99]
    ds_read_b128 v[136:139], v14 offset:2048
    ds_read_b64_tr_b16 v[120:121], v6 offset:23168
    ds_read_b64_tr_b16 v[122:123], v6 offset:23648
    s_waitcnt lgkmcnt(12)
    v_mfma_f32_32x32x16_bf16 v[200:215], v[104:107], v[124:127], v[200:215]
    v_add_u32 v5, 0xfffe9000, v5
    ds_read_b64_tr_b16 v[100:101], v6 offset:23232
    ds_read_b64_tr_b16 v[102:103], v6 offset:23712
    s_waitcnt lgkmcnt(11)
    v_mfma_f32_32x32x16_bf16 v[216:231], v[108:111], v[124:127], v[216:231]
    v_add_u32 v14, 0xfffe9000, v14
    ds_read_b64_tr_b16 v[104:105], v6 offset:23296
    ds_read_b64_tr_b16 v[106:107], v6 offset:23776
    s_waitcnt lgkmcnt(10)
    v_mfma_f32_32x32x16_bf16 v[20:35], v[112:115], v[128:131], v[20:35]
    v_add_u32 v7, 0xfffe9000, v7
    ds_read_b64_tr_b16 v[108:109], v6 offset:23360
    ds_read_b64_tr_b16 v[110:111], v16 offset:23840
    s_waitcnt lgkmcnt(9)
    v_mfma_f32_32x32x16_bf16 v[36:51], v[116:119], v[128:131], v[36:51]
    s_waitcnt lgkmcnt(8)
    v_mfma_f32_16x16x32_bf16 v[140:143], v[8:11], v[132:135], v[140:143]
    v_mfma_f32_16x16x32_bf16 v[144:147], v[8:11], v[136:139], v[144:147]
    v_add_u32 v16, 0xfffe9000, v16
    ds_read_b64_tr_b16 v[112:113], v6 offset:23424
    ds_read_b64_tr_b16 v[114:115], v6 offset:23904
    s_waitcnt lgkmcnt(8)
    v_mfma_f32_32x32x16_bf16 v[52:67], v[120:123], v[128:131], v[52:67]
    v_add_u32 v6, 0xfffe9000, v6
    s_barrier
    ds_read_b128 v[124:127], v2
    ds_read_b64_tr_b16 v[116:117], v6 offset:0
    ds_read_b64_tr_b16 v[118:119], v16 offset:480
    s_waitcnt lgkmcnt(9)
    v_mfma_f32_32x32x16_bf16 v[68:83], v[100:103], v[128:131], v[68:83]
    ds_read_b64_tr_b16 v[120:121], v6 offset:64
    ds_read_b64_tr_b16 v[122:123], v6 offset:544
    s_waitcnt lgkmcnt(9)
    v_mfma_f32_32x32x16_bf16 v[84:99], v[104:107], v[128:131], v[84:99]
    ds_read_b64_tr_b16 v[100:101], v6 offset:128
    ds_read_b64_tr_b16 v[102:103], v6 offset:608
    s_waitcnt lgkmcnt(9)
    v_mfma_f32_32x32x16_bf16 v[200:215], v[108:111], v[128:131], v[200:215]
    ds_read_b64_tr_b16 v[104:105], v6 offset:192
    ds_read_b64_tr_b16 v[106:107], v6 offset:672
    s_waitcnt lgkmcnt(9)
    v_mfma_f32_32x32x16_bf16 v[216:231], v[112:115], v[128:131], v[216:231]
    ds_read_b64_tr_b16 v[108:109], v6 offset:256
    ds_read_b64_tr_b16 v[110:111], v6 offset:736
    s_waitcnt lgkmcnt(8)
    v_mfma_f32_32x32x16_bf16 v[20:35], v[116:119], v[124:127], v[20:35]
    ds_read_b64_tr_b16 v[8:9], v7 offset:0
    ds_read_b64_tr_b16 v[112:113], v6 offset:320
    ds_read_b64_tr_b16 v[114:115], v16 offset:800
    s_waitcnt lgkmcnt(9)
    v_mfma_f32_32x32x16_bf16 v[36:51], v[120:123], v[124:127], v[36:51]
    ds_read_b64_tr_b16 v[10:11], v7 offset:480
    ds_read_b64_tr_b16 v[116:117], v6 offset:384
    ds_read_b64_tr_b16 v[118:119], v6 offset:864
    s_waitcnt lgkmcnt(10)
    v_mfma_f32_32x32x16_bf16 v[52:67], v[100:103], v[124:127], v[52:67]
    ds_read_b128 v[128:131], v3
    ds_read_b64_tr_b16 v[120:121], v6 offset:7680
    ds_read_b64_tr_b16 v[122:123], v16 offset:8160
    s_waitcnt lgkmcnt(11)
    v_mfma_f32_32x32x16_bf16 v[68:83], v[104:107], v[124:127], v[68:83]
    ds_read_b128 v[132:135], v13 offset:0
    ds_read_b64_tr_b16 v[100:101], v6 offset:7744
    ds_read_b64_tr_b16 v[102:103], v6 offset:8224
    s_waitcnt lgkmcnt(12)
    v_mfma_f32_32x32x16_bf16 v[84:99], v[108:111], v[124:127], v[84:99]
    ds_read_b128 v[136:139], v13 offset:2048
    ds_read_b64_tr_b16 v[104:105], v6 offset:7808
    ds_read_b64_tr_b16 v[106:107], v6 offset:8288
    s_waitcnt lgkmcnt(12)
    v_mfma_f32_32x32x16_bf16 v[200:215], v[112:115], v[124:127], v[200:215]
    ds_read_b64_tr_b16 v[108:109], v6 offset:7872
    ds_read_b64_tr_b16 v[110:111], v6 offset:8352
    s_waitcnt lgkmcnt(11)
    v_mfma_f32_32x32x16_bf16 v[216:231], v[116:119], v[124:127], v[216:231]
    ds_read_b64_tr_b16 v[112:113], v6 offset:7936
    ds_read_b64_tr_b16 v[114:115], v6 offset:8416
    s_waitcnt lgkmcnt(10)
    v_mfma_f32_32x32x16_bf16 v[20:35], v[120:123], v[128:131], v[20:35]
    ds_read_b64_tr_b16 v[116:117], v6 offset:8000
    ds_read_b64_tr_b16 v[118:119], v16 offset:8480
    s_waitcnt lgkmcnt(9)
    v_mfma_f32_32x32x16_bf16 v[36:51], v[100:103], v[128:131], v[36:51]
    s_waitcnt lgkmcnt(8)
    v_mfma_f32_16x16x32_bf16 v[140:143], v[8:11], v[132:135], v[140:143]
    v_mfma_f32_16x16x32_bf16 v[144:147], v[8:11], v[136:139], v[144:147]
    ds_read_b64_tr_b16 v[120:121], v6 offset:8064
    ds_read_b64_tr_b16 v[122:123], v6 offset:8544
    s_waitcnt lgkmcnt(8)
    v_mfma_f32_32x32x16_bf16 v[52:67], v[104:107], v[128:131], v[52:67]
    ds_read_b128 v[124:127], v4
    ds_read_b64_tr_b16 v[100:101], v6 offset:15360
    ds_read_b64_tr_b16 v[102:103], v16 offset:15840
    s_waitcnt lgkmcnt(9)
    v_mfma_f32_32x32x16_bf16 v[68:83], v[108:111], v[128:131], v[68:83]
    v_add_u32 v3, 0xb800, v3
    ds_read_b64_tr_b16 v[104:105], v6 offset:15424
    ds_read_b64_tr_b16 v[106:107], v6 offset:15904
    s_waitcnt lgkmcnt(9)
    v_mfma_f32_32x32x16_bf16 v[84:99], v[112:115], v[128:131], v[84:99]
    v_add_u32 v4, 0xb800, v4
    ds_read_b64_tr_b16 v[108:109], v6 offset:15488
    ds_read_b64_tr_b16 v[110:111], v6 offset:15968
    s_waitcnt lgkmcnt(9)
    v_mfma_f32_32x32x16_bf16 v[200:215], v[116:119], v[128:131], v[200:215]
    v_add_u32 v2, 0xb800, v2
    ds_read_b64_tr_b16 v[112:113], v6 offset:15552
    ds_read_b64_tr_b16 v[114:115], v6 offset:16032
    s_waitcnt lgkmcnt(9)
    v_mfma_f32_32x32x16_bf16 v[216:231], v[120:123], v[128:131], v[216:231]
    v_add_u32 v13, 0xb800, v13
    ds_read_b64_tr_b16 v[116:117], v6 offset:15616
    ds_read_b64_tr_b16 v[118:119], v6 offset:16096
    s_waitcnt lgkmcnt(8)
    v_mfma_f32_32x32x16_bf16 v[20:35], v[100:103], v[124:127], v[20:35]
    ds_read_b64_tr_b16 v[8:9], v7 offset:15360
    ds_read_b64_tr_b16 v[120:121], v6 offset:15680
    ds_read_b64_tr_b16 v[122:123], v16 offset:16160
    s_waitcnt lgkmcnt(9)
    v_mfma_f32_32x32x16_bf16 v[36:51], v[104:107], v[124:127], v[36:51]
    ds_read_b64_tr_b16 v[10:11], v7 offset:15840
    ds_read_b64_tr_b16 v[100:101], v6 offset:15744
    ds_read_b64_tr_b16 v[102:103], v6 offset:16224
    s_waitcnt lgkmcnt(10)
    v_mfma_f32_32x32x16_bf16 v[52:67], v[108:111], v[124:127], v[52:67]
    ds_read_b128 v[128:131], v5
    ds_read_b64_tr_b16 v[104:105], v6 offset:23040
    ds_read_b64_tr_b16 v[106:107], v16 offset:23520
    s_waitcnt lgkmcnt(11)
    v_mfma_f32_32x32x16_bf16 v[68:83], v[112:115], v[124:127], v[68:83]
    ds_read_b128 v[132:135], v14 offset:0
    ds_read_b64_tr_b16 v[108:109], v6 offset:23104
    ds_read_b64_tr_b16 v[110:111], v6 offset:23584
    s_waitcnt lgkmcnt(12)
    v_mfma_f32_32x32x16_bf16 v[84:99], v[116:119], v[124:127], v[84:99]
    ds_read_b128 v[136:139], v14 offset:2048
    ds_read_b64_tr_b16 v[112:113], v6 offset:23168
    ds_read_b64_tr_b16 v[114:115], v6 offset:23648
    s_waitcnt lgkmcnt(12)
    v_mfma_f32_32x32x16_bf16 v[200:215], v[120:123], v[124:127], v[200:215]
    v_add_u32 v5, 0xb800, v5
    ds_read_b64_tr_b16 v[116:117], v6 offset:23232
    ds_read_b64_tr_b16 v[118:119], v6 offset:23712
    s_waitcnt lgkmcnt(11)
    v_mfma_f32_32x32x16_bf16 v[216:231], v[100:103], v[124:127], v[216:231]
    v_add_u32 v14, 0xb800, v14
    ds_read_b64_tr_b16 v[120:121], v6 offset:23296
    ds_read_b64_tr_b16 v[122:123], v6 offset:23776
    s_waitcnt lgkmcnt(10)
    v_mfma_f32_32x32x16_bf16 v[20:35], v[104:107], v[128:131], v[20:35]
    v_add_u32 v7, 0xb800, v7
    ds_read_b64_tr_b16 v[100:101], v6 offset:23360
    ds_read_b64_tr_b16 v[102:103], v16 offset:23840
    s_waitcnt lgkmcnt(9)
    v_mfma_f32_32x32x16_bf16 v[36:51], v[108:111], v[128:131], v[36:51]
    s_waitcnt lgkmcnt(8)
    v_mfma_f32_16x16x32_bf16 v[140:143], v[8:11], v[132:135], v[140:143]
    v_mfma_f32_16x16x32_bf16 v[144:147], v[8:11], v[136:139], v[144:147]
    v_add_u32 v16, 0xb800, v16
    ds_read_b64_tr_b16 v[104:105], v6 offset:23424
    ds_read_b64_tr_b16 v[106:107], v6 offset:23904
    s_waitcnt lgkmcnt(8)
    v_mfma_f32_32x32x16_bf16 v[52:67], v[112:115], v[128:131], v[52:67]
    v_add_u32 v6, 0xb800, v6
    s_barrier
    ds_read_b128 v[124:127], v2
    ds_read_b64_tr_b16 v[108:109], v6 offset:0
    ds_read_b64_tr_b16 v[110:111], v16 offset:480
    s_waitcnt lgkmcnt(9)
    v_mfma_f32_32x32x16_bf16 v[68:83], v[116:119], v[128:131], v[68:83]
    ds_read_b64_tr_b16 v[112:113], v6 offset:64
    ds_read_b64_tr_b16 v[114:115], v6 offset:544
    s_waitcnt lgkmcnt(9)
    v_mfma_f32_32x32x16_bf16 v[84:99], v[120:123], v[128:131], v[84:99]
    ds_read_b64_tr_b16 v[116:117], v6 offset:128
    ds_read_b64_tr_b16 v[118:119], v6 offset:608
    s_waitcnt lgkmcnt(9)
    v_mfma_f32_32x32x16_bf16 v[200:215], v[100:103], v[128:131], v[200:215]
    ds_read_b64_tr_b16 v[120:121], v6 offset:192
    ds_read_b64_tr_b16 v[122:123], v6 offset:672
    s_waitcnt lgkmcnt(9)
    v_mfma_f32_32x32x16_bf16 v[216:231], v[104:107], v[128:131], v[216:231]
    ds_read_b64_tr_b16 v[100:101], v6 offset:256
    ds_read_b64_tr_b16 v[102:103], v6 offset:736
    s_waitcnt lgkmcnt(8)
    v_mfma_f32_32x32x16_bf16 v[20:35], v[108:111], v[124:127], v[20:35]
    ds_read_b64_tr_b16 v[8:9], v7 offset:0
    ds_read_b64_tr_b16 v[104:105], v6 offset:320
    ds_read_b64_tr_b16 v[106:107], v16 offset:800
    s_waitcnt lgkmcnt(9)
    v_mfma_f32_32x32x16_bf16 v[36:51], v[112:115], v[124:127], v[36:51]
    ds_read_b64_tr_b16 v[10:11], v7 offset:480
    ds_read_b64_tr_b16 v[108:109], v6 offset:384
    ds_read_b64_tr_b16 v[110:111], v6 offset:864
    s_waitcnt lgkmcnt(10)
    v_mfma_f32_32x32x16_bf16 v[52:67], v[116:119], v[124:127], v[52:67]
    ds_read_b128 v[128:131], v3
    ds_read_b64_tr_b16 v[112:113], v6 offset:7680
    ds_read_b64_tr_b16 v[114:115], v16 offset:8160
    s_waitcnt lgkmcnt(11)
    v_mfma_f32_32x32x16_bf16 v[68:83], v[120:123], v[124:127], v[68:83]
    ds_read_b128 v[132:135], v13 offset:0
    ds_read_b64_tr_b16 v[116:117], v6 offset:7744
    ds_read_b64_tr_b16 v[118:119], v6 offset:8224
    s_waitcnt lgkmcnt(12)
    v_mfma_f32_32x32x16_bf16 v[84:99], v[100:103], v[124:127], v[84:99]
    ds_read_b128 v[136:139], v13 offset:2048
    ds_read_b64_tr_b16 v[120:121], v6 offset:7808
    ds_read_b64_tr_b16 v[122:123], v6 offset:8288
    s_waitcnt lgkmcnt(12)
    v_mfma_f32_32x32x16_bf16 v[200:215], v[104:107], v[124:127], v[200:215]
    ds_read_b64_tr_b16 v[100:101], v6 offset:7872
    ds_read_b64_tr_b16 v[102:103], v6 offset:8352
    s_waitcnt lgkmcnt(11)
    v_mfma_f32_32x32x16_bf16 v[216:231], v[108:111], v[124:127], v[216:231]
    ds_read_b64_tr_b16 v[104:105], v6 offset:7936
    ds_read_b64_tr_b16 v[106:107], v6 offset:8416
    s_waitcnt lgkmcnt(10)
    v_mfma_f32_32x32x16_bf16 v[20:35], v[112:115], v[128:131], v[20:35]
    ds_read_b64_tr_b16 v[108:109], v6 offset:8000
    ds_read_b64_tr_b16 v[110:111], v16 offset:8480
    s_waitcnt lgkmcnt(9)
    v_mfma_f32_32x32x16_bf16 v[36:51], v[116:119], v[128:131], v[36:51]
    s_waitcnt lgkmcnt(8)
    v_mfma_f32_16x16x32_bf16 v[140:143], v[8:11], v[132:135], v[140:143]
    v_mfma_f32_16x16x32_bf16 v[144:147], v[8:11], v[136:139], v[144:147]
    ds_read_b64_tr_b16 v[112:113], v6 offset:8064
    ds_read_b64_tr_b16 v[114:115], v6 offset:8544
    s_waitcnt lgkmcnt(8)
    v_mfma_f32_32x32x16_bf16 v[52:67], v[120:123], v[128:131], v[52:67]
    ds_read_b128 v[124:127], v4
    ds_read_b64_tr_b16 v[116:117], v6 offset:15360
    ds_read_b64_tr_b16 v[118:119], v16 offset:15840
    s_waitcnt lgkmcnt(9)
    v_mfma_f32_32x32x16_bf16 v[68:83], v[100:103], v[128:131], v[68:83]
    v_add_u32 v3, 0xb800, v3
    ds_read_b64_tr_b16 v[120:121], v6 offset:15424
    ds_read_b64_tr_b16 v[122:123], v6 offset:15904
    s_waitcnt lgkmcnt(9)
    v_mfma_f32_32x32x16_bf16 v[84:99], v[104:107], v[128:131], v[84:99]
    v_add_u32 v4, 0xb800, v4
    ds_read_b64_tr_b16 v[100:101], v6 offset:15488
    ds_read_b64_tr_b16 v[102:103], v6 offset:15968
    s_waitcnt lgkmcnt(9)
    v_mfma_f32_32x32x16_bf16 v[200:215], v[108:111], v[128:131], v[200:215]
    v_add_u32 v2, 0xb800, v2
    ds_read_b64_tr_b16 v[104:105], v6 offset:15552
    ds_read_b64_tr_b16 v[106:107], v6 offset:16032
    s_waitcnt lgkmcnt(9)
    v_mfma_f32_32x32x16_bf16 v[216:231], v[112:115], v[128:131], v[216:231]
    v_add_u32 v13, 0xb800, v13
    ds_read_b64_tr_b16 v[108:109], v6 offset:15616
    ds_read_b64_tr_b16 v[110:111], v6 offset:16096
    s_waitcnt lgkmcnt(8)
    v_mfma_f32_32x32x16_bf16 v[20:35], v[116:119], v[124:127], v[20:35]
    ds_read_b64_tr_b16 v[8:9], v7 offset:15360
    ds_read_b64_tr_b16 v[112:113], v6 offset:15680
    ds_read_b64_tr_b16 v[114:115], v16 offset:16160
    s_waitcnt lgkmcnt(9)
    v_mfma_f32_32x32x16_bf16 v[36:51], v[120:123], v[124:127], v[36:51]
    ds_read_b64_tr_b16 v[10:11], v7 offset:15840
    ds_read_b64_tr_b16 v[116:117], v6 offset:15744
    ds_read_b64_tr_b16 v[118:119], v6 offset:16224
    s_waitcnt lgkmcnt(10)
    v_mfma_f32_32x32x16_bf16 v[52:67], v[100:103], v[124:127], v[52:67]
    ds_read_b128 v[128:131], v5
    ds_read_b64_tr_b16 v[120:121], v6 offset:23040
    ds_read_b64_tr_b16 v[122:123], v16 offset:23520
    s_waitcnt lgkmcnt(11)
    v_mfma_f32_32x32x16_bf16 v[68:83], v[104:107], v[124:127], v[68:83]
    ds_read_b128 v[132:135], v14 offset:0
    ds_read_b64_tr_b16 v[100:101], v6 offset:23104
    ds_read_b64_tr_b16 v[102:103], v6 offset:23584
    s_waitcnt lgkmcnt(12)
    v_mfma_f32_32x32x16_bf16 v[84:99], v[108:111], v[124:127], v[84:99]
    ds_read_b128 v[136:139], v14 offset:2048
    ds_read_b64_tr_b16 v[104:105], v6 offset:23168
    ds_read_b64_tr_b16 v[106:107], v6 offset:23648
    s_waitcnt lgkmcnt(12)
    v_mfma_f32_32x32x16_bf16 v[200:215], v[112:115], v[124:127], v[200:215]
    v_add_u32 v5, 0xb800, v5
    ds_read_b64_tr_b16 v[108:109], v6 offset:23232
    ds_read_b64_tr_b16 v[110:111], v6 offset:23712
    s_waitcnt lgkmcnt(11)
    v_mfma_f32_32x32x16_bf16 v[216:231], v[116:119], v[124:127], v[216:231]
    v_add_u32 v14, 0xb800, v14
    ds_read_b64_tr_b16 v[112:113], v6 offset:23296
    ds_read_b64_tr_b16 v[114:115], v6 offset:23776
    s_waitcnt lgkmcnt(10)
    v_mfma_f32_32x32x16_bf16 v[20:35], v[120:123], v[128:131], v[20:35]
    v_add_u32 v7, 0xb800, v7
    ds_read_b64_tr_b16 v[116:117], v6 offset:23360
    ds_read_b64_tr_b16 v[118:119], v16 offset:23840
    s_waitcnt lgkmcnt(9)
    v_mfma_f32_32x32x16_bf16 v[36:51], v[100:103], v[128:131], v[36:51]
    s_waitcnt lgkmcnt(8)
    v_mfma_f32_16x16x32_bf16 v[140:143], v[8:11], v[132:135], v[140:143]
    v_mfma_f32_16x16x32_bf16 v[144:147], v[8:11], v[136:139], v[144:147]
    v_add_u32 v16, 0xb800, v16
    ds_read_b64_tr_b16 v[120:121], v6 offset:23424
    ds_read_b64_tr_b16 v[122:123], v6 offset:23904
    s_waitcnt lgkmcnt(8)
    v_mfma_f32_32x32x16_bf16 v[52:67], v[104:107], v[128:131], v[52:67]
    v_add_u32 v6, 0xb800, v6
    s_waitcnt lgkmcnt(0)
    s_barrier
    ds_read_b128 v[124:127], v2
    ds_read_b64_tr_b16 v[100:101], v6 offset:0
    ds_read_b64_tr_b16 v[102:103], v16 offset:480
    v_mfma_f32_32x32x16_bf16 v[68:83], v[108:111], v[128:131], v[68:83]
    ds_read_b64_tr_b16 v[104:105], v6 offset:64
    ds_read_b64_tr_b16 v[106:107], v6 offset:544
    v_mfma_f32_32x32x16_bf16 v[84:99], v[112:115], v[128:131], v[84:99]
    ds_read_b64_tr_b16 v[108:109], v6 offset:128
    ds_read_b64_tr_b16 v[110:111], v6 offset:608
    v_mfma_f32_32x32x16_bf16 v[200:215], v[116:119], v[128:131], v[200:215]
    ds_read_b64_tr_b16 v[112:113], v6 offset:192
    ds_read_b64_tr_b16 v[114:115], v6 offset:672
    v_mfma_f32_32x32x16_bf16 v[216:231], v[120:123], v[128:131], v[216:231]
    ds_read_b64_tr_b16 v[116:117], v6 offset:256
    ds_read_b64_tr_b16 v[118:119], v6 offset:736
    s_waitcnt lgkmcnt(8)
    v_mfma_f32_32x32x16_bf16 v[20:35], v[100:103], v[124:127], v[20:35]
    ds_read_b64_tr_b16 v[8:9], v7 offset:0
    ds_read_b64_tr_b16 v[120:121], v6 offset:320
    ds_read_b64_tr_b16 v[122:123], v16 offset:800
    s_waitcnt lgkmcnt(9)
    v_mfma_f32_32x32x16_bf16 v[36:51], v[104:107], v[124:127], v[36:51]
    ds_read_b64_tr_b16 v[10:11], v7 offset:480
    ds_read_b64_tr_b16 v[100:101], v6 offset:384
    ds_read_b64_tr_b16 v[102:103], v6 offset:864
    s_waitcnt lgkmcnt(10)
    v_mfma_f32_32x32x16_bf16 v[52:67], v[108:111], v[124:127], v[52:67]
    ds_read_b128 v[128:131], v3
    ds_read_b64_tr_b16 v[104:105], v6 offset:7680
    ds_read_b64_tr_b16 v[106:107], v16 offset:8160
    s_waitcnt lgkmcnt(11)
    v_mfma_f32_32x32x16_bf16 v[68:83], v[112:115], v[124:127], v[68:83]
    ds_read_b128 v[132:135], v13 offset:0
    ds_read_b64_tr_b16 v[108:109], v6 offset:7744
    ds_read_b64_tr_b16 v[110:111], v6 offset:8224
    s_waitcnt lgkmcnt(12)
    v_mfma_f32_32x32x16_bf16 v[84:99], v[116:119], v[124:127], v[84:99]
    ds_read_b128 v[136:139], v13 offset:2048
    ds_read_b64_tr_b16 v[112:113], v6 offset:7808
    ds_read_b64_tr_b16 v[114:115], v6 offset:8288
    s_waitcnt lgkmcnt(12)
    v_mfma_f32_32x32x16_bf16 v[200:215], v[120:123], v[124:127], v[200:215]
    ds_read_b64_tr_b16 v[116:117], v6 offset:7872
    ds_read_b64_tr_b16 v[118:119], v6 offset:8352
    s_waitcnt lgkmcnt(11)
    v_mfma_f32_32x32x16_bf16 v[216:231], v[100:103], v[124:127], v[216:231]
    ds_read_b64_tr_b16 v[120:121], v6 offset:7936
    ds_read_b64_tr_b16 v[122:123], v6 offset:8416
    s_waitcnt lgkmcnt(10)
    v_mfma_f32_32x32x16_bf16 v[20:35], v[104:107], v[128:131], v[20:35]
    ds_read_b64_tr_b16 v[100:101], v6 offset:8000
    ds_read_b64_tr_b16 v[102:103], v16 offset:8480
    s_waitcnt lgkmcnt(9)
    v_mfma_f32_32x32x16_bf16 v[36:51], v[108:111], v[128:131], v[36:51]
    s_waitcnt lgkmcnt(8)
    v_mfma_f32_16x16x32_bf16 v[140:143], v[8:11], v[132:135], v[140:143]
    v_mfma_f32_16x16x32_bf16 v[144:147], v[8:11], v[136:139], v[144:147]
    ds_read_b64_tr_b16 v[104:105], v6 offset:8064
    ds_read_b64_tr_b16 v[106:107], v6 offset:8544
    s_waitcnt lgkmcnt(8)
    v_mfma_f32_32x32x16_bf16 v[52:67], v[112:115], v[128:131], v[52:67]
    ds_read_b128 v[124:127], v4
    ds_read_b64_tr_b16 v[108:109], v6 offset:15360
    ds_read_b64_tr_b16 v[110:111], v16 offset:15840
    s_waitcnt lgkmcnt(9)
    v_mfma_f32_32x32x16_bf16 v[68:83], v[116:119], v[128:131], v[68:83]
    ds_read_b64_tr_b16 v[112:113], v6 offset:15424
    ds_read_b64_tr_b16 v[114:115], v6 offset:15904
    s_waitcnt lgkmcnt(9)
    v_mfma_f32_32x32x16_bf16 v[84:99], v[120:123], v[128:131], v[84:99]
    ds_read_b64_tr_b16 v[116:117], v6 offset:15488
    ds_read_b64_tr_b16 v[118:119], v6 offset:15968
    s_waitcnt lgkmcnt(9)
    v_mfma_f32_32x32x16_bf16 v[200:215], v[100:103], v[128:131], v[200:215]
    ds_read_b64_tr_b16 v[120:121], v6 offset:15552
    ds_read_b64_tr_b16 v[122:123], v6 offset:16032
    s_waitcnt lgkmcnt(9)
    v_mfma_f32_32x32x16_bf16 v[216:231], v[104:107], v[128:131], v[216:231]
    ds_read_b64_tr_b16 v[100:101], v6 offset:15616
    ds_read_b64_tr_b16 v[102:103], v6 offset:16096
    s_waitcnt lgkmcnt(8)
    v_mfma_f32_32x32x16_bf16 v[20:35], v[108:111], v[124:127], v[20:35]
    ds_read_b64_tr_b16 v[8:9], v7 offset:15360
    ds_read_b64_tr_b16 v[104:105], v6 offset:15680
    ds_read_b64_tr_b16 v[106:107], v16 offset:16160
    s_waitcnt lgkmcnt(9)
    v_mfma_f32_32x32x16_bf16 v[36:51], v[112:115], v[124:127], v[36:51]
    ds_read_b64_tr_b16 v[10:11], v7 offset:15840
    ds_read_b64_tr_b16 v[108:109], v6 offset:15744
    ds_read_b64_tr_b16 v[110:111], v6 offset:16224
    s_waitcnt lgkmcnt(10)
    v_mfma_f32_32x32x16_bf16 v[52:67], v[116:119], v[124:127], v[52:67]
    ds_read_b128 v[128:131], v5
    ds_read_b64_tr_b16 v[112:113], v6 offset:23040
    ds_read_b64_tr_b16 v[114:115], v16 offset:23520
    s_waitcnt lgkmcnt(11)
    v_mfma_f32_32x32x16_bf16 v[68:83], v[120:123], v[124:127], v[68:83]
    ds_read_b128 v[132:135], v14 offset:0
    ds_read_b64_tr_b16 v[116:117], v6 offset:23104
    ds_read_b64_tr_b16 v[118:119], v6 offset:23584
    s_waitcnt lgkmcnt(12)
    v_mfma_f32_32x32x16_bf16 v[84:99], v[100:103], v[124:127], v[84:99]
    ds_read_b128 v[136:139], v14 offset:2048
    ds_read_b64_tr_b16 v[120:121], v6 offset:23168
    ds_read_b64_tr_b16 v[122:123], v6 offset:23648
    s_waitcnt lgkmcnt(12)
    v_mfma_f32_32x32x16_bf16 v[200:215], v[104:107], v[124:127], v[200:215]
    ds_read_b64_tr_b16 v[100:101], v6 offset:23232
    ds_read_b64_tr_b16 v[102:103], v6 offset:23712
    s_waitcnt lgkmcnt(11)
    v_mfma_f32_32x32x16_bf16 v[216:231], v[108:111], v[124:127], v[216:231]
    ds_read_b64_tr_b16 v[104:105], v6 offset:23296
    ds_read_b64_tr_b16 v[106:107], v6 offset:23776
    s_waitcnt lgkmcnt(10)
    v_mfma_f32_32x32x16_bf16 v[20:35], v[112:115], v[128:131], v[20:35]
    ds_read_b64_tr_b16 v[108:109], v6 offset:23360
    ds_read_b64_tr_b16 v[110:111], v16 offset:23840
    s_waitcnt lgkmcnt(9)
    v_mfma_f32_32x32x16_bf16 v[36:51], v[116:119], v[128:131], v[36:51]
    s_waitcnt lgkmcnt(8)
    v_mfma_f32_16x16x32_bf16 v[140:143], v[8:11], v[132:135], v[140:143]
    v_mfma_f32_16x16x32_bf16 v[144:147], v[8:11], v[136:139], v[144:147]
    ds_read_b64_tr_b16 v[112:113], v6 offset:23424
    ds_read_b64_tr_b16 v[114:115], v6 offset:23904
    s_waitcnt lgkmcnt(8)
    v_mfma_f32_32x32x16_bf16 v[52:67], v[120:123], v[128:131], v[52:67]
    s_waitcnt lgkmcnt(6)
    v_mfma_f32_32x32x16_bf16 v[68:83], v[100:103], v[128:131], v[68:83]
    s_waitcnt lgkmcnt(4)
    v_mfma_f32_32x32x16_bf16 v[84:99], v[104:107], v[128:131], v[84:99]
    s_waitcnt lgkmcnt(2)
    v_mfma_f32_32x32x16_bf16 v[200:215], v[108:111], v[128:131], v[200:215]
    s_waitcnt lgkmcnt(0)
    v_mfma_f32_32x32x16_bf16 v[216:231], v[112:115], v[128:131], v[216:231]
    v_cvt_pk_bf16_f32 v108, v36, v37
    v_cvt_pk_bf16_f32 v109, v38, v39
    v_cvt_pk_bf16_f32 v110, v40, v41
    v_cvt_pk_bf16_f32 v111, v42, v43
    ds_write_b128 v253, v[108:111] offset:0
    v_cvt_pk_bf16_f32 v112, v44, v45
    v_cvt_pk_bf16_f32 v113, v46, v47
    v_cvt_pk_bf16_f32 v114, v48, v49
    v_cvt_pk_bf16_f32 v115, v50, v51
    ds_write_b128 v253, v[112:115] offset:1024
    v_cvt_pk_bf16_f32 v116, v52, v53
    v_cvt_pk_bf16_f32 v117, v54, v55
    v_cvt_pk_bf16_f32 v118, v56, v57
    v_cvt_pk_bf16_f32 v119, v58, v59
    ds_write_b128 v253, v[116:119] offset:2048
    v_cvt_pk_bf16_f32 v100, v20, v21
    v_cvt_pk_bf16_f32 v101, v22, v23
    v_cvt_pk_bf16_f32 v102, v24, v25
    v_cvt_pk_bf16_f32 v103, v26, v27
    v_cvt_pk_bf16_f32 v104, v28, v29
    v_cvt_pk_bf16_f32 v105, v30, v31
    v_cvt_pk_bf16_f32 v106, v32, v33
    v_cvt_pk_bf16_f32 v107, v34, v35
    s_waitcnt lgkmcnt(0)
    s_barrier
    v_mfma_f32_32x32x16_bf16 v[20:35], v[148:151], v[100:103], 0
    v_cvt_pk_bf16_f32 v200, v200, v201
    v_cvt_pk_bf16_f32 v201, v202, v203
    v_cvt_pk_bf16_f32 v202, v204, v205
    v_cvt_pk_bf16_f32 v203, v206, v207
    v_cvt_pk_bf16_f32 v204, v208, v209
    v_cvt_pk_bf16_f32 v205, v210, v211
    v_mfma_f32_32x32x16_bf16 v[20:35], v[152:155], v[104:107], v[20:35]
    buffer_store_dwordx4 v[200:203], v249, s[44:47], s11 offen sc1
    s_add_u32 s11, s11, 0x10000
    v_cvt_pk_bf16_f32 v206, v212, v213
    v_cvt_pk_bf16_f32 v207, v214, v215
    v_cvt_pk_bf16_f32 v208, v216, v217
    v_cvt_pk_bf16_f32 v209, v218, v219
    v_mfma_f32_32x32x16_bf16 v[36:51], v[156:159], v[100:103], 0
    buffer_store_dwordx2 v[204:205], v250, s[44:47], s12 offen sc1
    s_add_u32 s12, s12, 0x8000
    v_cvt_pk_bf16_f32 v210, v220, v221
    v_cvt_pk_bf16_f32 v211, v222, v223
    v_cvt_pk_bf16_f32 v212, v224, v225
    v_cvt_pk_bf16_f32 v213, v226, v227
    v_mfma_f32_32x32x16_bf16 v[36:51], v[160:163], v[104:107], v[36:51]
    buffer_store_dwordx4 v[206:209], v249, s[44:47], s11 offen sc1
    s_add_u32 s11, s11, 0x10000
    v_cvt_pk_bf16_f32 v214, v228, v229
    v_cvt_pk_bf16_f32 v215, v230, v231
    v_cvt_pk_bf16_f32 v216, v140, v141
    v_cvt_pk_bf16_f32 v217, v142, v143
    v_mfma_f32_32x32x16_bf16 v[20:35], v[164:167], v[108:111], v[20:35]
    buffer_store_dwordx4 v[210:213], v249, s[44:47], s11 offen sc1
    s_add_u32 s11, s11, 0x10000
    v_cvt_pk_bf16_f32 v218, v144, v145
    v_cvt_pk_bf16_f32 v219, v146, v147
    v_cvt_pk_bf16_f32 v120, v60, v61
    v_cvt_pk_bf16_f32 v121, v62, v63
    v_mfma_f32_32x32x16_bf16 v[176:191], v[168:171], v[104:107], 0
    buffer_store_dwordx2 v[214:215], v250, s[44:47], s12 offen sc1
    s_add_u32 s12, s12, 0x8000
    v_permlane16_swap_b32 v216, v218
    v_permlane16_swap_b32 v217, v219
    v_cvt_pk_bf16_f32 v122, v64, v65
    v_cvt_pk_bf16_f32 v123, v66, v67
    v_mfma_f32_32x32x16_bf16 v[176:191], v[172:175], v[108:111], v[176:191]
    buffer_store_dwordx4 v[216:219], v249, s[44:47], s11 offen sc1
    s_add_u32 s11, s11, 0x10000
    v_cvt_pk_bf16_f32 v124, v68, v69
    v_cvt_pk_bf16_f32 v125, v70, v71
    v_cvt_pk_bf16_f32 v126, v72, v73
    v_cvt_pk_bf16_f32 v127, v74, v75
    v_max3_f32 v72, v36, v37, v38
    v_max3_f32 v73, v39, v40, v41
    v_max3_f32 v72, v72, v42, v43
    v_max3_f32 v73, v73, v44, v45
    v_max3_f32 v72, v72, v46, v47
    v_max3_f32 v73, v73, v48, v49
    v_max3_f32 v72, v72, v50, v51
    v_max3_f32 v73, v73, v20, v21
    v_max3_f32 v72, v72, v22, v23
    ds_write_b64 v233, v[120:121] offset:0
    v_cvt_pk_bf16_f32 v128, v76, v77
    v_cvt_pk_bf16_f32 v129, v78, v79
    v_cvt_pk_bf16_f32 v130, v80, v81
    v_cvt_pk_bf16_f32 v131, v82, v83
    ds_write_b64 v233, v[122:123] offset:16
    v_max_f32_e64 v72, v72, v73
    v_mul_f32 v72, 0xbfb8aa3b, v72
    v_pk_fma_f32 v[36:37], v[36:37], s[70:71], v[72:73] op_sel_hi:[1,1,0]
    v_pk_fma_f32 v[38:39], v[38:39], s[70:71], v[72:73] op_sel_hi:[1,1,0]
    v_pk_fma_f32 v[40:41], v[40:41], s[70:71], v[72:73] op_sel_hi:[1,1,0]
    v_pk_fma_f32 v[42:43], v[42:43], s[70:71], v[72:73] op_sel_hi:[1,1,0]
    v_pk_fma_f32 v[44:45], v[44:45], s[70:71], v[72:73] op_sel_hi:[1,1,0]
    v_pk_fma_f32 v[46:47], v[46:47], s[70:71], v[72:73] op_sel_hi:[1,1,0]
    v_pk_fma_f32 v[48:49], v[48:49], s[70:71], v[72:73] op_sel_hi:[1,1,0]
    v_pk_fma_f32 v[50:51], v[50:51], s[70:71], v[72:73] op_sel_hi:[1,1,0]
    v_pk_fma_f32 v[20:21], v[20:21], s[70:71], v[72:73] op_sel_hi:[1,1,0]
    v_pk_fma_f32 v[22:23], v[22:23], s[70:71], v[72:73] op_sel_hi:[1,1,0]
    v_exp_f32 v36, v36
    v_exp_f32 v37, v37
    v_exp_f32 v38, v38
    v_exp_f32 v39, v39
    ds_write_b64 v233, v[124:125] offset:32
    v_cvt_pk_bf16_f32 v132, v84, v85
    v_cvt_pk_bf16_f32 v133, v86, v87
    v_cvt_pk_bf16_f32 v134, v88, v89
    v_cvt_pk_bf16_f32 v135, v90, v91
    ds_write_b64 v233, v[126:127] offset:48
    v_exp_f32 v40, v40
    v_exp_f32 v41, v41
    v_pk_add_f32 v[74:75], v[36:37], v[38:39]
    v_exp_f32 v42, v42
    v_exp_f32 v43, v43
    v_pk_add_f32 v[74:75], v[74:75], v[40:41]
    v_exp_f32 v44, v44
    v_exp_f32 v45, v45
    v_pk_add_f32 v[74:75], v[74:75], v[42:43]
    v_exp_f32 v46, v46
    v_exp_f32 v47, v47
    v_pk_add_f32 v[74:75], v[74:75], v[44:45]
    v_exp_f32 v48, v48
    v_exp_f32 v49, v49
    ds_write_b64 v233, v[128:129] offset:64
    v_cvt_pk_bf16_f32 v136, v92, v93
    v_cvt_pk_bf16_f32 v137, v94, v95
    v_cvt_pk_bf16_f32 v138, v96, v97
    v_cvt_pk_bf16_f32 v139, v98, v99
    ds_write_b64 v233, v[130:131] offset:80
    v_pk_add_f32 v[74:75], v[74:75], v[46:47]
    v_exp_f32 v50, v50
    v_exp_f32 v51, v51
    v_pk_add_f32 v[74:75], v[74:75], v[48:49]
    v_exp_f32 v20, v20
    v_exp_f32 v21, v21
    v_pk_add_f32 v[74:75], v[74:75], v[50:51]
    v_exp_f32 v22, v22
    v_exp_f32 v23, v23
    v_pk_add_f32 v[74:75], v[74:75], v[20:21]
    v_pk_add_f32 v[74:75], v[74:75], v[22:23]
    v_add_f32_e64 v74, v74, v75
    v_rcp_f32 v74, v74
    s_nop 0
    v_pk_mul_f32 v[36:37], v[36:37], v[74:75] op_sel_hi:[1,0]
    v_pk_mul_f32 v[38:39], v[38:39], v[74:75] op_sel_hi:[1,0]
    v_cvt_pk_bf16_f32 v52, v36, v37
    v_pk_mul_f32 v[40:41], v[40:41], v[74:75] op_sel_hi:[1,0]
    v_cvt_pk_bf16_f32 v53, v38, v39
    v_pk_mul_f32 v[42:43], v[42:43], v[74:75] op_sel_hi:[1,0]
    v_cvt_pk_bf16_f32 v54, v40, v41
    v_pk_mul_f32 v[44:45], v[44:45], v[74:75] op_sel_hi:[1,0]
    v_cvt_pk_bf16_f32 v55, v42, v43
    v_pk_mul_f32 v[46:47], v[46:47], v[74:75] op_sel_hi:[1,0]
    v_cvt_pk_bf16_f32 v56, v44, v45
    ds_write_b128 v234, v[52:55] offset:0
    v_pk_mul_f32 v[48:49], v[48:49], v[74:75] op_sel_hi:[1,0]
    v_cvt_pk_bf16_f32 v57, v46, v47
    v_pk_mul_f32 v[50:51], v[50:51], v[74:75] op_sel_hi:[1,0]
    v_cvt_pk_bf16_f32 v58, v48, v49
    v_pk_mul_f32 v[20:21], v[20:21], v[74:75] op_sel_hi:[1,0]
    v_cvt_pk_bf16_f32 v59, v50, v51
    v_pk_mul_f32 v[22:23], v[22:23], v[74:75] op_sel_hi:[1,0]
    v_cvt_pk_bf16_f32 v68, v20, v21
    v_cvt_pk_bf16_f32 v69, v22, v23
    v_max3_f32 v72, v176, v177, v178
    v_max3_f32 v73, v179, v180, v181
    v_max3_f32 v72, v72, v182, v183
    v_max3_f32 v73, v73, v184, v185
    v_max3_f32 v72, v72, v186, v187
    v_max3_f32 v73, v73, v188, v189
    v_max3_f32 v72, v72, v190, v191
    v_max3_f32 v73, v73, v24, v25
    v_max3_f32 v72, v72, v26, v27
    ds_write_b128 v235, v[56:59] offset:0
    v_max_f32_e64 v72, v72, v73
    v_mul_f32 v72, 0xbfb8aa3b, v72
    v_pk_fma_f32 v[176:177], v[176:177], s[70:71], v[72:73] op_sel_hi:[1,1,0]
    v_pk_fma_f32 v[178:179], v[178:179], s[70:71], v[72:73] op_sel_hi:[1,1,0]
    v_pk_fma_f32 v[180:181], v[180:181], s[70:71], v[72:73] op_sel_hi:[1,1,0]
    v_pk_fma_f32 v[182:183], v[182:183], s[70:71], v[72:73] op_sel_hi:[1,1,0]
    v_pk_fma_f32 v[184:185], v[184:185], s[70:71], v[72:73] op_sel_hi:[1,1,0]
    v_pk_fma_f32 v[186:187], v[186:187], s[70:71], v[72:73] op_sel_hi:[1,1,0]
    v_pk_fma_f32 v[188:189], v[188:189], s[70:71], v[72:73] op_sel_hi:[1,1,0]
    v_pk_fma_f32 v[190:191], v[190:191], s[70:71], v[72:73] op_sel_hi:[1,1,0]
    v_pk_fma_f32 v[24:25], v[24:25], s[70:71], v[72:73] op_sel_hi:[1,1,0]
    v_pk_fma_f32 v[26:27], v[26:27], s[70:71], v[72:73] op_sel_hi:[1,1,0]
    v_exp_f32 v176, v176
    v_exp_f32 v177, v177
    v_exp_f32 v178, v178
    v_exp_f32 v179, v179
    ds_write_b64 v233, v[132:133] offset:96
    ds_write_b64 v233, v[134:135] offset:112
    ds_write_b64 v232, v[242:243] offset:160
    v_exp_f32 v180, v180
    v_exp_f32 v181, v181
    v_pk_add_f32 v[74:75], v[176:177], v[178:179]
    v_exp_f32 v182, v182
    v_exp_f32 v183, v183
    v_pk_add_f32 v[74:75], v[74:75], v[180:181]
    v_exp_f32 v184, v184
    v_exp_f32 v185, v185
    v_pk_add_f32 v[74:75], v[74:75], v[182:183]
    v_exp_f32 v186, v186
    v_exp_f32 v187, v187
    v_pk_add_f32 v[74:75], v[74:75], v[184:185]
    v_exp_f32 v188, v188
    v_exp_f32 v189, v189
    ds_write_b64 v233, v[136:137] offset:128
    ds_write_b64 v233, v[138:139] offset:144
    v_pk_add_f32 v[74:75], v[74:75], v[186:187]
    v_exp_f32 v190, v190
    v_exp_f32 v191, v191
    v_pk_add_f32 v[74:75], v[74:75], v[188:189]
    v_exp_f32 v24, v24
    v_exp_f32 v25, v25
    v_pk_add_f32 v[74:75], v[74:75], v[190:191]
    v_exp_f32 v26, v26
    v_exp_f32 v27, v27
    v_pk_add_f32 v[74:75], v[74:75], v[24:25]
    v_pk_add_f32 v[74:75], v[74:75], v[26:27]
    v_add_f32_e64 v74, v74, v75
    v_rcp_f32 v74, v74
    s_nop 0
    v_pk_mul_f32 v[176:177], v[176:177], v[74:75] op_sel_hi:[1,0]
    v_pk_mul_f32 v[178:179], v[178:179], v[74:75] op_sel_hi:[1,0]
    v_cvt_pk_bf16_f32 v60, v176, v177
    v_pk_mul_f32 v[180:181], v[180:181], v[74:75] op_sel_hi:[1,0]
    v_cvt_pk_bf16_f32 v61, v178, v179
    v_pk_mul_f32 v[182:183], v[182:183], v[74:75] op_sel_hi:[1,0]
    v_cvt_pk_bf16_f32 v62, v180, v181
    v_pk_mul_f32 v[184:185], v[184:185], v[74:75] op_sel_hi:[1,0]
    v_cvt_pk_bf16_f32 v63, v182, v183
    v_pk_mul_f32 v[186:187], v[186:187], v[74:75] op_sel_hi:[1,0]
    v_cvt_pk_bf16_f32 v64, v184, v185
    ds_write_b128 v234, v[60:63] offset:64
    v_pk_mul_f32 v[188:189], v[188:189], v[74:75] op_sel_hi:[1,0]
    v_cvt_pk_bf16_f32 v65, v186, v187
    v_pk_mul_f32 v[190:191], v[190:191], v[74:75] op_sel_hi:[1,0]
    v_cvt_pk_bf16_f32 v66, v188, v189
    v_pk_mul_f32 v[24:25], v[24:25], v[74:75] op_sel_hi:[1,0]
    v_cvt_pk_bf16_f32 v67, v190, v191
    v_pk_mul_f32 v[26:27], v[26:27], v[74:75] op_sel_hi:[1,0]
    v_cvt_pk_bf16_f32 v70, v24, v25
    v_cvt_pk_bf16_f32 v71, v26, v27
    ds_write_b128 v235, v[64:67] offset:64
    ds_write_b128 v234, v[68:71] offset:256
    s_waitcnt vmcnt(0)
    s_mov_b64 exec, 1
    buffer_atomic_add v252, v251, s[44:47], s13 offen
    s_mov_b64 exec, -1
    s_waitcnt lgkmcnt(0)
    s_barrier
    s_setprio 2
    ds_read_b64_tr_b16 v[108:109], v240 offset:0
    ds_read_b64_tr_b16 v[110:111], v240 offset:800
    ds_read_b64_tr_b16 v[100:101], v238 offset:0
    ds_read_b64_tr_b16 v[102:103], v239 offset:1280
    ds_read_b64_tr_b16 v[104:105], v236 offset:0
    ds_read_b64_tr_b16 v[106:107], v237 offset:1280
    ds_read_b64_tr_b16 v[120:121], v240 offset:3200
    ds_read_b64_tr_b16 v[122:123], v240 offset:4000
    ds_read_b64_tr_b16 v[112:113], v238 offset:5120
    ds_read_b64_tr_b16 v[114:115], v239 offset:6400
    ds_read_b64_tr_b16 v[116:117], v236 offset:5120
    ds_read_b64_tr_b16 v[118:119], v237 offset:6400
    s_waitcnt lgkmcnt(8)
    v_mfma_f32_32x32x16_bf16 v[20:35], v[100:103], v[108:111], 0
    s_waitcnt lgkmcnt(6)
    v_mfma_f32_32x32x16_bf16 v[36:51], v[104:107], v[108:111], 0
    ds_read_b64_tr_b16 v[132:133], v240 offset:6400
    ds_read_b64_tr_b16 v[134:135], v240 offset:7200
    ds_read_b64_tr_b16 v[124:125], v238 offset:10240
    ds_read_b64_tr_b16 v[126:127], v239 offset:11520
    ds_read_b64_tr_b16 v[128:129], v236 offset:10240
    ds_read_b64_tr_b16 v[130:131], v237 offset:11520
    s_waitcnt lgkmcnt(8)
    v_mfma_f32_32x32x16_bf16 v[20:35], v[112:115], v[120:123], v[20:35]
    s_waitcnt lgkmcnt(6)
    v_mfma_f32_32x32x16_bf16 v[36:51], v[116:119], v[120:123], v[36:51]
    ds_read_b64_tr_b16 v[144:145], v240 offset:9600
    ds_read_b64_tr_b16 v[146:147], v240 offset:10400
    ds_read_b64_tr_b16 v[136:137], v238 offset:15360
    ds_read_b64_tr_b16 v[138:139], v239 offset:16640
    ds_read_b64_tr_b16 v[140:141], v236 offset:15360
    ds_read_b64_tr_b16 v[142:143], v237 offset:16640
    s_waitcnt lgkmcnt(8)
    v_mfma_f32_32x32x16_bf16 v[20:35], v[124:127], v[132:135], v[20:35]
    s_waitcnt lgkmcnt(6)
    v_mfma_f32_32x32x16_bf16 v[36:51], v[128:131], v[132:135], v[36:51]
    ds_read_b64_tr_b16 v[156:157], v240 offset:12800
    ds_read_b64_tr_b16 v[158:159], v240 offset:13600
    ds_read_b64_tr_b16 v[148:149], v238 offset:20480
    ds_read_b64_tr_b16 v[150:151], v239 offset:21760
    ds_read_b64_tr_b16 v[152:153], v236 offset:20480
    ds_read_b64_tr_b16 v[154:155], v237 offset:21760
    s_waitcnt lgkmcnt(8)
    v_mfma_f32_32x32x16_bf16 v[20:35], v[136:139], v[144:147], v[20:35]
    s_waitcnt lgkmcnt(6)
    v_mfma_f32_32x32x16_bf16 v[36:51], v[140:143], v[144:147], v[36:51]
    ds_read_b64_tr_b16 v[168:169], v240 offset:16000
    ds_read_b64_tr_b16 v[170:171], v240 offset:16800
    ds_read_b64_tr_b16 v[160:161], v238 offset:25600
    ds_read_b64_tr_b16 v[162:163], v239 offset:26880
    ds_read_b64_tr_b16 v[164:165], v236 offset:25600
    ds_read_b64_tr_b16 v[166:167], v237 offset:26880
    s_waitcnt lgkmcnt(8)
    v_mfma_f32_32x32x16_bf16 v[20:35], v[148:151], v[156:159], v[20:35]
    s_waitcnt lgkmcnt(6)
    v_mfma_f32_32x32x16_bf16 v[36:51], v[152:155], v[156:159], v[36:51]
    ds_read_b64_tr_b16 v[180:181], v240 offset:19200
    ds_read_b64_tr_b16 v[182:183], v240 offset:20000
    ds_read_b64_tr_b16 v[172:173], v238 offset:30720
    ds_read_b64_tr_b16 v[174:175], v239 offset:32000
    ds_read_b64_tr_b16 v[176:177], v236 offset:30720
    ds_read_b64_tr_b16 v[178:179], v237 offset:32000
    s_waitcnt lgkmcnt(8)
    v_mfma_f32_32x32x16_bf16 v[20:35], v[160:163], v[168:171], v[20:35]
    s_waitcnt lgkmcnt(6)
    v_mfma_f32_32x32x16_bf16 v[36:51], v[164:167], v[168:171], v[36:51]
    ds_read_b64_tr_b16 v[192:193], v240 offset:22400
    ds_read_b64_tr_b16 v[194:195], v240 offset:23200
    ds_read_b64_tr_b16 v[184:185], v238 offset:35840
    ds_read_b64_tr_b16 v[186:187], v239 offset:37120
    ds_read_b64_tr_b16 v[188:189], v236 offset:35840
    ds_read_b64_tr_b16 v[190:191], v237 offset:37120
    s_waitcnt lgkmcnt(8)
    v_mfma_f32_32x32x16_bf16 v[20:35], v[172:175], v[180:183], v[20:35]
    s_waitcnt lgkmcnt(6)
    v_mfma_f32_32x32x16_bf16 v[36:51], v[176:179], v[180:183], v[36:51]
    s_waitcnt lgkmcnt(2)
    v_mfma_f32_32x32x16_bf16 v[20:35], v[184:187], v[192:195], v[20:35]
    s_waitcnt lgkmcnt(0)
    v_mfma_f32_32x32x16_bf16 v[36:51], v[188:191], v[192:195], v[36:51]
    s_lshl_b32 s66, s67, 2
    s_lshr_b32 s5, s64, 2
    s_add_u32 s66, s66, s5
    s_and_b32 s65, s64, 3
    s_nop 5
    s_nop 0
    v_cvt_pk_bf16_f32 v200, v20, v21
    v_cvt_pk_bf16_f32 v201, v22, v23
    v_cvt_pk_bf16_f32 v202, v24, v25
    v_cvt_pk_bf16_f32 v203, v26, v27
    v_cvt_pk_bf16_f32 v204, v28, v29
    v_cvt_pk_bf16_f32 v205, v30, v31
    v_cvt_pk_bf16_f32 v206, v32, v33
    v_cvt_pk_bf16_f32 v207, v34, v35
    v_cvt_pk_bf16_f32 v208, v36, v37
    v_cvt_pk_bf16_f32 v209, v38, v39
    buffer_store_dwordx4 v[200:203], v241, s[44:47], s9 offen sc1
    buffer_store_dwordx4 v[204:207], v241, s[44:47], s9 offen offset:768 sc1
    buffer_store_dwordx2 v[208:209], v244, s[44:47], s9 offen offset:1536 sc1
    v_mov_b32 v248, 1
    s_mov_b64 exec, 1
    ds_add_u32 v247, v248
    s_mov_b64 exec, -1
    s_mov_b32 s60, s22
    s_and_b32 s61, s23, 0xffff
    s_mov_b32 s62, 0xc8000
    s_mov_b32 s63, 0x20000
    s_lshr_b32 s4, s43, 2
    s_mul_i32 s4, s4, 160
    v_add_u32 v7, 0, v1
    v_mul_u32_u24 v8, 6554, v7
    v_lshrrev_b32_e64 v8, 16, v8
    v_mul_u32_u24 v8, 1120, v8
    v_lshl_add_u32 v8, v7, 4, v8
    v_add_u32 v2, s4, v8
    v_add_u32 v7, 64, v1
    v_mul_u32_u24 v8, 6554, v7
    v_lshrrev_b32_e64 v8, 16, v8
    v_mul_u32_u24 v8, 1120, v8
    v_lshl_add_u32 v8, v7, 4, v8
    v_add_u32_e64 v3, s4, v8
    v_add_u32 v7, 128, v1
    v_mul_u32_u24 v8, 6554, v7
    v_lshrrev_b32_e64 v8, 16, v8
    v_mul_u32_u24 v8, 1120, v8
    v_lshl_add_u32 v8, v7, 4, v8
    v_add_u32_e64 v4, s4, v8
    v_add_u32 v7, 192, v1
    v_mul_u32_u24 v8, 6554, v7
    v_lshrrev_b32_e64 v8, 16, v8
    v_mul_u32_u24 v8, 1120, v8
    v_lshl_add_u32 v8, v7, 4, v8
    v_add_u32_e64 v5, s4, v8
    v_add_u32 v7, 256, v1
    v_mul_u32_u24 v8, 6554, v7
    v_lshrrev_b32_e64 v8, 16, v8
    v_mul_u32_u24 v8, 1120, v8
    v_lshl_add_u32 v8, v7, 4, v8
    v_add_u32 v6, s4, v8
    v_and_b32 v44, 15, v1
    v_lshl_add_u32 v45, v12, 4, v44
    v_lshlrev_b32_e64 v45, 4, v45
    v_lshl_add_u32 v45, v15, 3, v45
    s_lshl_b32 s4, s3, 9
    s_add_u32 s4, s4, 0
    v_add_u32 v246, s4, v45
    v_lshlrev_b32 v45, 3, v15
    v_sub_u32_e64 v44, v44, v45
    v_mov_b32 v46, 0x3f80
    v_mov_b32 v47, 0x3f800000
    v_cmp_eq_u32 vcc, 0, v44
    s_nop 1
    v_cndmask_b32 v40, 0, v46, vcc
    v_cmp_eq_u32 vcc, 1, v44
    s_nop 1
    v_cndmask_b32 v40, v40, v47, vcc
    v_cmp_eq_u32 vcc, 2, v44
    s_nop 1
    v_cndmask_b32 v41, 0, v46, vcc
    v_cmp_eq_u32 vcc, 3, v44
    s_nop 1
    v_cndmask_b32 v41, v41, v47, vcc
    v_cmp_eq_u32 vcc, 4, v44
    s_nop 1
    v_cndmask_b32 v42, 0, v46, vcc
    v_cmp_eq_u32 vcc, 5, v44
    s_nop 1
    v_cndmask_b32 v42, v42, v47, vcc
    v_cmp_eq_u32 vcc, 6, v44
    s_nop 1
    v_cndmask_b32 v43, 0, v46, vcc
    v_cmp_eq_u32 vcc, 7, v44
    s_nop 1
    v_cndmask_b32_e64 v43, v43, v47, vcc
Ls5:
    ds_read_b32 v10, v247
    s_waitcnt lgkmcnt(0)
    v_cmp_ne_u32 vcc, 4, v10
    s_cmp_eq_u32 s91, 0
    s_cbranch_scc1 Le6
    s_sub_u32 s91, s91, 1
    s_nop 1
    s_cbranch_vccnz Ls5
Le6:
    s_mov_b32 s15, s10
    s_lshl_b32 s4, s15, 8
    s_add_u32 s4, s4, 0xbc0000
    s_add_u32 s96, s40, s4
    s_addc_u32 s97, s41, 0
    s_mov_b32 s100, 1
    s_waitcnt vmcnt(0)
    s_atomic_add s100, s[96:97], 0
    s_atomic_add s100, s[96:97], 256
    s_atomic_add s100, s[96:97], 512
    s_atomic_add s100, s[96:97], 768
    s_add_u32 s4, s3, 9
    s_mov_b32 s5, 13
Lwo7:
    s_cmp_ge_u32 s4, s5
    s_cbranch_scc1 Lwx8
    s_mov_b32 s6, s4
    s_mul_i32 s7, s6, 40960
    s_mul_i32 s6, s6, 5120
    s_add_u32 m0, s6, 61440
    s_nop 0
    buffer_load_dwordx4 v2, s[60:63], s7 offen lds
    s_add_u32 m0, s6, 62464
    s_nop 0
    buffer_load_dwordx4 v3, s[60:63], s7 offen lds
    s_add_u32 m0, s6, 63488
    s_nop 0
    buffer_load_dwordx4 v4, s[60:63], s7 offen lds
    s_add_u32 m0, s6, 64512
    s_nop 0
    buffer_load_dwordx4 v5, s[60:63], s7 offen lds
    s_add_u32 m0, s6, 65536
    s_nop 0
    buffer_load_dwordx4 v6, s[60:63], s7 offen lds
    s_add_u32 s4, s4, 4
    s_branch Lwo7
Lwx8:
    s_lshl_b32 s15, s66, 2
    s_add_u32 s15, s15, s65
    s_add_u32 s15, s15, 64
    s_waitcnt lgkmcnt(0)
    s_lshl_b32 s4, s15, 8
    s_add_u32 s4, s4, 0xbc0000
    s_add_u32 s96, s40, s4
    s_addc_u32 s97, s41, 0
    s_mov_b32 s98, 0
    s_atomic_add s98, s[96:97], 0 glc
    s_xor_b32 s4, s3, 3
    s_mov_b32 s5, 1
Lwo9:
    s_cmp_ge_u32 s4, s5
    s_cbranch_scc1 Lwx10
    s_mov_b32 s6, s4
    s_mul_i32 s7, s6, 40960
    s_mul_i32 s6, s6, 5120
    s_add_u32 m0, s6, 61440
    s_nop 0
    buffer_load_dwordx4 v2, s[60:63], s7 offen lds
    s_add_u32 m0, s6, 62464
    s_nop 0
    buffer_load_dwordx4 v3, s[60:63], s7 offen lds
    s_add_u32 m0, s6, 63488
    s_nop 0
    buffer_load_dwordx4 v4, s[60:63], s7 offen lds
    s_add_u32 m0, s6, 64512
    s_nop 0
    buffer_load_dwordx4 v5, s[60:63], s7 offen lds
    s_add_u32 m0, s6, 65536
    s_nop 0
    buffer_load_dwordx4 v6, s[60:63], s7 offen lds
    s_add_u32 s4, s4, 4
    s_branch Lwo9
Lwx10:
    s_add_u32 s4, s3, 13
    s_mov_b32 s5, 20
Lwo11:
    s_cmp_ge_u32 s4, s5
    s_cbranch_scc1 Lwx12
    s_mov_b32 s6, s4
    s_mul_i32 s7, s6, 40960
    s_mul_i32 s6, s6, 5120
    s_add_u32 m0, s6, 61440
    s_nop 0
    buffer_load_dwordx4 v2, s[60:63], s7 offen lds
    s_add_u32 m0, s6, 62464
    s_nop 0
    buffer_load_dwordx4 v3, s[60:63], s7 offen lds
    s_add_u32 m0, s6, 63488
    s_nop 0
    buffer_load_dwordx4 v4, s[60:63], s7 offen lds
    s_add_u32 m0, s6, 64512
    s_nop 0
    buffer_load_dwordx4 v5, s[60:63], s7 offen lds
    s_add_u32 m0, s6, 65536
    s_nop 0
    buffer_load_dwordx4 v6, s[60:63], s7 offen lds
    s_add_u32 s4, s4, 4
    s_branch Lwo11
Lwx12:
    s_waitcnt lgkmcnt(0)
    s_mov_b32 s101, 0
    s_branch Lc15
Lp13:
    s_mov_b32 s98, 0
    s_atomic_add s98, s[96:97], 0 glc
    s_add_u32 s101, s101, 1
    s_waitcnt lgkmcnt(0)
Lc15:
    s_cmp_eq_u32 s98, 16
    s_cbranch_scc1 Lx14
    s_sleep 1
    s_cmp_lt_u32 s101, 400000
    s_cbranch_scc1 Lp13
Lx14:
    s_mul_i32 s4, s66, 30720
    s_add_u32 s4, s4, 0x500000
    s_lshl_b32 s6, s65, 1
    s_add_u32 s5, s6, 0
    s_and_b32 s5, s5, 7
    s_mul_i32 s5, s5, 1920
    s_add_u32 s5, s5, s4
    buffer_load_dwordx4 v[100:103], v245, s[44:47], s5 offen sc1
    s_add_u32 s5, s6, 1
    s_and_b32 s5, s5, 7
    s_mul_i32 s5, s5, 1920
    s_add_u32 s5, s5, s4
    buffer_load_dwordx4 v[104:107], v245, s[44:47], s5 offen sc1
    s_add_u32 s5, s6, 2
    s_and_b32 s5, s5, 7
    s_mul_i32 s5, s5, 1920
    s_add_u32 s5, s5, s4
    buffer_load_dwordx4 v[108:111], v245, s[44:47], s5 offen sc1
    s_add_u32 s5, s6, 3
    s_and_b32 s5, s5, 7
    s_mul_i32 s5, s5, 1920
    s_add_u32 s5, s5, s4
    buffer_load_dwordx4 v[112:115], v245, s[44:47], s5 offen sc1
    s_add_u32 s5, s6, 4
    s_and_b32 s5, s5, 7
    s_mul_i32 s5, s5, 1920
    s_add_u32 s5, s5, s4
    buffer_load_dwordx4 v[116:119], v245, s[44:47], s5 offen sc1
    s_add_u32 s5, s6, 5
    s_and_b32 s5, s5, 7
    s_mul_i32 s5, s5, 1920
    s_add_u32 s5, s5, s4
    buffer_load_dwordx4 v[120:123], v245, s[44:47], s5 offen sc1
    s_add_u32 s5, s6, 6
    s_and_b32 s5, s5, 7
    s_mul_i32 s5, s5, 1920
    s_add_u32 s5, s5, s4
    buffer_load_dwordx4 v[124:127], v245, s[44:47], s5 offen sc1
    s_add_u32 s5, s6, 7
    s_and_b32 s5, s5, 7
    s_mul_i32 s5, s5, 1920
    s_add_u32 s5, s5, s4
    buffer_load_dwordx4 v[128:131], v245, s[44:47], s5 offen sc1
    s_waitcnt vmcnt(7)
    v_mfma_f32_16x16x32_bf16 v[20:23], v[40:43], v[100:103], 0
    s_waitcnt vmcnt(6)
    v_mfma_f32_16x16x32_bf16 v[20:23], v[40:43], v[104:107], v[20:23]
    s_waitcnt vmcnt(5)
    v_mfma_f32_16x16x32_bf16 v[20:23], v[40:43], v[108:111], v[20:23]
    s_waitcnt vmcnt(4)
    v_mfma_f32_16x16x32_bf16 v[20:23], v[40:43], v[112:115], v[20:23]
    s_waitcnt vmcnt(3)
    v_mfma_f32_16x16x32_bf16 v[20:23], v[40:43], v[116:119], v[20:23]
    s_waitcnt vmcnt(2)
    v_mfma_f32_16x16x32_bf16 v[20:23], v[40:43], v[120:123], v[20:23]
    s_waitcnt vmcnt(1)
    v_mfma_f32_16x16x32_bf16 v[20:23], v[40:43], v[124:127], v[20:23]
    s_waitcnt vmcnt(0)
    v_mfma_f32_16x16x32_bf16 v[20:23], v[40:43], v[128:131], v[20:23]
    s_nop 7
    v_cvt_pk_bf16_f32 v28, v20, v21
    v_cvt_pk_bf16_f32 v29, v22, v23
    ds_write_b64 v246, v[28:29]
    s_waitcnt lgkmcnt(0)
    s_setprio 0
    s_barrier
    s_mov_b32 s52, s36
    s_and_b32 s53, s37, 0xffff
    s_mov_b32 s54, 0x500000
    s_mov_b32 s55, 0x20000
    s_lshl_b32 s64, s42, 2
    s_and_b32 s4, s43, 3
    s_add_u32 s64, s64, s4
    s_lshr_b32 s65, s43, 2
    s_and_b32 s8, s3, 3
    s_lshr_b32 s9, s3, 2
    s_lshl_b32 s4, s64, 2
    s_add_u32 s4, s4, s8
    s_mul_i32 s12, s4, 40960
    s_mul_i32 s6, s65, 160
    s_add_u32 s12, s12, s6
    s_lshr_b32 s10, s4, 1
    s_lshl_b32 s10, s10, 10
    s_and_b32 s6, s4, 1
    s_lshl_b32 s6, s6, 8
    s_add_u32 s10, s10, s6
    s_lshl_b32 s6, s9, 20
    s_add_u32 s10, s10, s6
    s_add_u32 s10, s10, 0x280000
    s_lshl_b32 s11, s4, 7
    s_lshl_b32 s7, s9, 18
    s_add_u32 s11, s11, s7
    s_add_u32 s11, s11, 0x480000
    v_and_b32 v2, 15, v1
    v_lshrrev_b32 v3, 4, v1
    v_lshrrev_b32 v4, 5, v1
    v_and_b32 v5, 1, v3
    v_lshlrev_b32_e64 v6, 4, v2
    v_lshl_add_u32 v6, v5, 9, v6
    v_lshl_add_u32 v6, v4, 16, v6
    v_lshlrev_b32_e64 v7, 3, v2
    v_lshl_add_u32 v7, v3, 14, v7
    v_bfe_u32 v8, v1, 2, 2
    v_and_b32_e64 v9, 3, v1
    s_mul_i32 s7, s9, 51200
    s_add_u32 s7, s7, 61440
    v_lshl_add_u32 v9, v9, 3, s7
    v_mul_u32_u24_e64 v11, 20, v3
    v_add3_u32 v11, v11, v8, 16
    v_mul_u32_u24 v11, 160, v11
    v_add_u32 v11, v11, v9
    s_lshl_b32 s4, s8, 12
    s_add_u32 s4, s4, 41984
    v_lshl_add_u32 v8, v1, 4, s4
    s_mul_i32 s4, s8, 2560
    v_lshl_add_u32 v236, v1, 4, s4
    s_add_u32 s4, s4, 10240
    v_mul_u32_u24 v9, 160, v2
    v_lshl_add_u32 v9, v3, 3, v9
    v_add_u32 v9, s4, v9
    v_add_u32 v10, 0, v1
    v_mul_u32_u24 v13, 6554, v10
    v_lshrrev_b32_e64 v13, 16, v13
    v_mul_u32_u24 v12, 2400, v13
    v_lshl_add_u32 v240, v10, 4, v12
    v_add_u32_e64 v10, 64, v1
    v_mul_u32_u24 v13, 6554, v10
    v_lshrrev_b32_e64 v13, 16, v13
    v_mul_u32_u24 v12, 2400, v13
    v_lshl_add_u32 v241, v10, 4, v12
    v_add_u32 v10, 128, v1
    v_mul_u32_u24 v13, 6554, v10
    v_lshrrev_b32_e64 v13, 16, v13
    v_mul_u32_u24 v12, 2400, v13
    v_lshl_add_u32 v242, v10, 4, v12
    v_cmp_gt_u32_e64 vcc, 32, v1
    v_mov_b32 v10, 0x80000000
    s_nop 0
    v_cndmask_b32 v242, v10, v242, vcc
    s_branch L_a3pre2
L_ld:
    s_sub_u32 s4, s3, 4
    v_lshrrev_b32 v2, 3, v1
    v_lshrrev_b32 v3, 4, v1
    v_and_b32 v4, 7, v1
    s_lshl2_add_u32 s5, s64, s4
    s_lshl_b32 s5, s5, 5
    v_add_u32 v2, s5, v2
    v_mul_u32_u24 v2, 1280, v2
    v_xor_b32_e64 v5, v3, v4
    v_lshl_add_u32 v8, v5, 4, v2
    v_xor_b32_e64 v5, 4, v5
    v_lshl_add_u32 v5, v5, 4, v2
    v_add_u32 v9, 10240, v5
    v_add_u32 v10, 20480, v8
    v_add_u32 v11, 30720, v5
    s_lshl_b32 s11, s4, 12
    s_mul_i32 s10, s4, 7680
    s_add_u32 s10, s10, 16384
    s_mul_i32 s5, s4, 61440
    s_mul_i32 s6, s67, 160
    s_add_u32 s5, s5, s6
    s_add_u32 s5, s5, 1280
    s_movk_i32 s7, 3840
    s_movk_i32 s8, 1120
    v_add_u32_e64 v2, 0, v1
    v_mul_u32_u24 v3, 2185, v2
    v_lshrrev_b32 v3, 16, v3
    v_mul_u32_u24 v4, 30, v3
    v_sub_u32_e64 v2, v2, v4
    v_mul_u32_u24 v4, 6554, v2
    v_lshrrev_b32_e64 v4, 16, v4
    v_lshl_add_u32 v2, v2, 4, s5
    v_mad_u32_u24 v2, v4, s8, v2
    v_and_b32_e64 v5, 24, v3
    v_bfe_u32 v6, v3, 1, 2
    v_and_b32_e64 v3, 1, v3
    v_lshl_add_u32 v3, v3, 2, v6
    v_add_u32 v3, v3, v5
    v_lshrrev_b32 v4, 1, v4
    v_sub_u32_e64 v3, v3, v4
    v_mad_i32_i24 v22, v3, s7, v2
    s_mov_b32 s12, 0xc0000000
    s_mov_b32 s13, 0xc0000
    v_add_u32 v2, 0x20, v22
    v_cndmask_b32 v22, v22, v2, s[12:13]
    s_mov_b32 s12, 0x0
    s_mov_b32 s13, 0x300003
    v_add_u32 v2, 0xffffffe0, v22
    v_cndmask_b32 v22, v22, v2, s[12:13]
    v_add_u32 v2, 64, v1
    v_mul_u32_u24 v3, 2185, v2
    v_lshrrev_b32 v3, 16, v3
    v_mul_u32_u24 v4, 30, v3
    v_sub_u32_e64 v2, v2, v4
    v_mul_u32_u24 v4, 6554, v2
    v_lshrrev_b32_e64 v4, 16, v4
    v_lshl_add_u32 v2, v2, 4, s5
    v_mad_u32_u24 v2, v4, s8, v2
    v_and_b32_e64 v5, 24, v3
    v_bfe_u32 v6, v3, 1, 2
    v_and_b32_e64 v3, 1, v3
    v_lshl_add_u32 v3, v3, 2, v6
    v_add_u32 v3, v3, v5
    v_lshrrev_b32 v4, 1, v4
    v_sub_u32_e64 v3, v3, v4
    v_mad_i32_i24 v23, v3, s7, v2
    s_mov_b32 s12, 0xc000000
    s_mov_b32 s13, 0xc000
    v_add_u32_e64 v2, 0x20, v23
    v_cndmask_b32 v23, v23, v2, s[12:13]
    s_mov_b32 s12, 0x30000000
    s_mov_b32 s13, 0x30000
    v_add_u32 v2, 0xffffffe0, v23
    v_cndmask_b32 v23, v23, v2, s[12:13]
    v_add_u32 v2, 128, v1
    v_mul_u32_u24 v3, 2185, v2
    v_lshrrev_b32 v3, 16, v3
    v_mul_u32_u24 v4, 30, v3
    v_sub_u32_e64 v2, v2, v4
    v_mul_u32_u24 v4, 6554, v2
    v_lshrrev_b32_e64 v4, 16, v4
    v_lshl_add_u32 v2, v2, 4, s5
    v_mad_u32_u24 v2, v4, s8, v2
    v_and_b32_e64 v5, 24, v3
    v_bfe_u32 v6, v3, 1, 2
    v_and_b32_e64 v3, 1, v3
    v_lshl_add_u32 v3, v3, 2, v6
    v_add_u32 v3, v3, v5
    v_lshrrev_b32 v4, 1, v4
    v_sub_u32_e64 v3, v3, v4
    v_mad_i32_i24 v24, v3, s7, v2
    s_mov_b32 s12, 0xc00000
    s_mov_b32 s13, 0xc00
    v_add_u32_e64 v2, 0x20, v24
    v_cndmask_b32 v24, v24, v2, s[12:13]
    s_mov_b32 s12, 0x3000000
    s_mov_b32 s13, 0x3000
    v_add_u32 v2, 0xffffffe0, v24
    v_cndmask_b32 v24, v24, v2, s[12:13]
    v_add_u32 v2, 192, v1
    v_mul_u32_u24 v3, 2185, v2
    v_lshrrev_b32 v3, 16, v3
    v_mul_u32_u24 v4, 30, v3
    v_sub_u32_e64 v2, v2, v4
    v_mul_u32_u24 v4, 6554, v2
    v_lshrrev_b32_e64 v4, 16, v4
    v_lshl_add_u32 v2, v2, 4, s5
    v_mad_u32_u24 v2, v4, s8, v2
    v_and_b32_e64 v5, 24, v3
    v_bfe_u32 v6, v3, 1, 2
    v_and_b32_e64 v3, 1, v3
    v_lshl_add_u32 v3, v3, 2, v6
    v_add_u32 v3, v3, v5
    v_lshrrev_b32 v4, 1, v4
    v_sub_u32_e64 v3, v3, v4
    v_mad_i32_i24 v25, v3, s7, v2
    s_mov_b32 s12, 0xc0000
    s_mov_b32 s13, 0xc0
    v_add_u32_e64 v2, 0x20, v25
    v_cndmask_b32 v25, v25, v2, s[12:13]
    s_mov_b32 s12, 0x300000
    s_mov_b32 s13, 0x300
    v_add_u32 v2, 0xffffffe0, v25
    v_cndmask_b32 v25, v25, v2, s[12:13]
    v_add_u32 v2, 256, v1
    v_mul_u32_u24 v3, 2185, v2
    v_lshrrev_b32 v3, 16, v3
    v_mul_u32_u24 v4, 30, v3
    v_sub_u32_e64 v2, v2, v4
    v_mul_u32_u24 v4, 6554, v2
    v_lshrrev_b32_e64 v4, 16, v4
    v_lshl_add_u32 v2, v2, 4, s5
    v_mad_u32_u24 v2, v4, s8, v2
    v_and_b32_e64 v5, 24, v3
    v_bfe_u32 v6, v3, 1, 2
    v_and_b32_e64 v3, 1, v3
    v_lshl_add_u32 v3, v3, 2, v6
    v_add_u32 v3, v3, v5
    v_lshrrev_b32 v4, 1, v4
    v_sub_u32_e64 v3, v3, v4
    v_mad_i32_i24 v26, v3, s7, v2
    s_mov_b32 s12, 0xc000
    s_mov_b32 s13, 0xc
    v_add_u32 v2, 0x20, v26
    v_cndmask_b32 v26, v26, v2, s[12:13]
    s_mov_b32 s12, 0x30000
    s_mov_b32 s13, 0x30
    v_add_u32 v2, 0xffffffe0, v26
    v_cndmask_b32 v26, v26, v2, s[12:13]
    v_add_u32 v2, 320, v1
    v_mul_u32_u24 v3, 2185, v2
    v_lshrrev_b32 v3, 16, v3
    v_mul_u32_u24 v4, 30, v3
    v_sub_u32 v2, v2, v4
    v_mul_u32_u24 v4, 6554, v2
    v_lshrrev_b32_e64 v4, 16, v4
    v_lshl_add_u32 v2, v2, 4, s5
    v_mad_u32_u24 v2, v4, s8, v2
    v_and_b32_e64 v5, 24, v3
    v_bfe_u32 v6, v3, 1, 2
    v_and_b32_e64 v3, 1, v3
    v_lshl_add_u32 v3, v3, 2, v6
    v_add_u32 v3, v3, v5
    v_lshrrev_b32 v4, 1, v4
    v_sub_u32_e64 v3, v3, v4
    v_mad_i32_i24 v27, v3, s7, v2
    s_mov_b32 s12, 0xc0000c00
    s_mov_b32 s13, 0x0
    v_add_u32 v2, 0x20, v27
    v_cndmask_b32 v27, v27, v2, s[12:13]
    s_mov_b32 s12, 0x3000
    s_mov_b32 s13, 0x3
    v_add_u32 v2, 0xffffffe0, v27
    v_cndmask_b32 v27, v27, v2, s[12:13]
    v_add_u32 v2, 384, v1
    v_mul_u32_u24 v3, 2185, v2
    v_lshrrev_b32 v3, 16, v3
    v_mul_u32_u24 v4, 30, v3
    v_sub_u32 v2, v2, v4
    v_mul_u32_u24 v4, 6554, v2
    v_lshrrev_b32_e64 v4, 16, v4
    v_lshl_add_u32 v2, v2, 4, s5
    v_mad_u32_u24 v2, v4, s8, v2
    v_and_b32_e64 v5, 24, v3
    v_bfe_u32 v6, v3, 1, 2
    v_and_b32_e64 v3, 1, v3
    v_lshl_add_u32 v3, v3, 2, v6
    v_add_u32 v3, v3, v5
    v_lshrrev_b32 v4, 1, v4
    v_sub_u32_e64 v3, v3, v4
    v_mad_i32_i24 v28, v3, s7, v2
    s_mov_b32 s12, 0xc0000c0
    s_mov_b32 s13, 0x0
    v_add_u32 v2, 0x20, v28
    v_cndmask_b32 v28, v28, v2, s[12:13]
    s_mov_b32 s12, 0x30000300
    s_mov_b32 s13, 0x0
    v_add_u32 v2, 0xffffffe0, v28
    v_cndmask_b32 v28, v28, v2, s[12:13]
    v_add_u32 v2, 448, v1
    v_mul_u32_u24 v3, 2185, v2
    v_lshrrev_b32 v3, 16, v3
    v_mul_u32_u24 v4, 30, v3
    v_sub_u32 v2, v2, v4
    v_mul_u32_u24 v4, 6554, v2
    v_lshrrev_b32_e64 v4, 16, v4
    v_lshl_add_u32 v2, v2, 4, s5
    v_mad_u32_u24 v2, v4, s8, v2
    v_and_b32_e64 v5, 24, v3
    v_bfe_u32 v6, v3, 1, 2
    v_and_b32_e64 v3, 1, v3
    v_lshl_add_u32 v3, v3, 2, v6
    v_add_u32 v3, v3, v5
    v_lshrrev_b32 v4, 1, v4
    v_sub_u32_e64 v3, v3, v4
    v_mad_i32_i24 v29, v3, s7, v2
    s_mov_b32 s12, 0xc0000c
    s_mov_b32 s13, 0xc0000000
    v_add_u32 v2, 0x20, v29
    v_cndmask_b32 v29, v29, v2, s[12:13]
    s_mov_b32 s12, 0x3000030
    s_mov_b32 s13, 0x0
    v_add_u32 v2, 0xffffffe0, v29
    v_cndmask_b32 v29, v29, v2, s[12:13]
    s_mov_b32 s44, s40
    s_and_b32 s45, s41, 0xffff
    s_mov_b32 s46, 0xbe0000
    s_mov_b32 s47, 0x20000
    s_mov_b32 s60, s22
    s_and_b32 s61, s23, 0xffff
    s_mov_b32 s62, 0xc8000
    s_mov_b32 s63, 0x20000
    s_lshr_b32 s4, s43, 2
    s_mul_i32 s4, s4, 160
    v_add_u32_e64 v245, 0, v1
    v_mul_u32_u24 v246, 6554, v245
    v_lshrrev_b32_e64 v246, 16, v246
    v_mul_u32_u24 v246, 1120, v246
    v_lshl_add_u32 v246, v245, 4, v246
    v_add_u32 v240, s4, v246
    v_add_u32 v245, 64, v1
    v_mul_u32_u24 v246, 6554, v245
    v_lshrrev_b32_e64 v246, 16, v246
    v_mul_u32_u24 v246, 1120, v246
    v_lshl_add_u32 v246, v245, 4, v246
    v_add_u32_e64 v241, s4, v246
    v_add_u32 v245, 128, v1
    v_mul_u32_u24 v246, 6554, v245
    v_lshrrev_b32_e64 v246, 16, v246
    v_mul_u32_u24 v246, 1120, v246
    v_lshl_add_u32 v246, v245, 4, v246
    v_add_u32_e64 v242, s4, v246
    v_add_u32 v245, 192, v1
    v_mul_u32_u24 v246, 6554, v245
    v_lshrrev_b32_e64 v246, 16, v246
    v_mul_u32_u24 v246, 1120, v246
    v_lshl_add_u32 v246, v245, 4, v246
    v_add_u32_e64 v243, s4, v246
    v_add_u32 v245, 256, v1
    v_mul_u32_u24 v246, 6554, v245
    v_lshrrev_b32_e64 v246, 16, v246
    v_mul_u32_u24 v246, 1120, v246
    v_lshl_add_u32 v246, v245, 4, v246
    v_add_u32 v244, s4, v246
    v_lshlrev_b32 v238, 4, v1
    s_mul_i32 s4, s3, 3072
    s_add_u32 s4, s4, 139264
    v_add_u32 v238, s4, v238
    v_lshrrev_b32 v12, 5, v1
    v_bfe_u32 v13, v1, 2, 2
    v_and_b32_e64 v17, 3, v1
    v_bfe_u32 v19, v1, 4, 1
    v_lshl_add_u32 v17, v19, 2, v17
    v_and_b32 v19, 31, v1
    s_lshl_b32 s4, s3, 5
    s_sub_u32 s4, s4, 128
    v_add_u32_e64 v19, s4, v19
    v_mul_u32_u24 v228, 320, v19
    v_add_u32_e64 v228, 0, v228
    v_bfe_u32 v229, v19, 1, 2
    v_lshlrev_b32 v230, 1, v12
    v_xor_b32 v229, v229, v230
    v_lshl_add_u32 v236, v229, 4, v228
    v_xor_b32_e64 v229, 1, v229
    v_lshl_add_u32 v237, v229, 4, v228
    s_mov_b32 s6, 147456
    v_lshl_add_u32 v228, v12, 2, v13
    v_mul_u32_u24 v228, 40, v228
    v_add_u32 v228, s6, v228
    v_lshrrev_b32_e64 v229, 1, v17
    v_lshl_add_u32 v230, v229, 3, v228
    v_add_u32_e64 v231, 32, v228
    v_bfe_u32 v232, v1, 2, 1
    v_mul_u32_u24 v232, 0x8000, v232
    v_lshl_or_b32 v232, v232, 16, v232
    s_add_u32 m0, s11, 94208
    s_movk_i32 s12, 0
    buffer_load_dwordx4 v8, s[48:51], s12 offen lds
    s_add_u32 m0, s11, 95232
    s_movk_i32 s12, 0
    buffer_load_dwordx4 v9, s[48:51], s12 offen lds
    s_add_u32 m0, s11, 96256
    s_movk_i32 s12, 0
    buffer_load_dwordx4 v10, s[48:51], s12 offen lds
    s_add_u32 m0, s11, 97280
    s_movk_i32 s12, 0
    buffer_load_dwordx4 v11, s[48:51], s12 offen lds
    s_add_u32 m0, s10, 94208
    s_mov_b32 s13, 0
    buffer_load_dwordx4 v22, s[52:55], s13 offen lds
    s_add_u32 m0, s10, 95232
    s_mov_b32 s13, 0
    buffer_load_dwordx4 v23, s[52:55], s13 offen lds
    s_add_u32 m0, s10, 96256
    s_mov_b32 s13, 0
    buffer_load_dwordx4 v24, s[52:55], s13 offen lds
    s_add_u32 m0, s10, 97280
    s_mov_b32 s13, 0
    buffer_load_dwordx4 v25, s[52:55], s13 offen lds
    s_add_u32 m0, s10, 98304
    s_mov_b32 s13, 0
    buffer_load_dwordx4 v26, s[52:55], s13 offen lds
    s_add_u32 m0, s10, 99328
    s_mov_b32 s13, 0
    buffer_load_dwordx4 v27, s[52:55], s13 offen lds
    s_add_u32 m0, s10, 100352
    s_mov_b32 s13, 0
    buffer_load_dwordx4 v28, s[52:55], s13 offen lds
    s_add_u32 m0, s10, 101376
    s_mov_b32 s13, 0
    s_mov_b32 exec_hi, 0
    buffer_load_dwordx4 v29, s[52:55], s13 offen lds
    s_mov_b64 exec, -1
    s_add_u32 m0, s11, 0
    s_movk_i32 s12, 128
    buffer_load_dwordx4 v8, s[48:51], s12 offen lds
    s_add_u32 m0, s11, 1024
    s_movk_i32 s12, 128
    buffer_load_dwordx4 v9, s[48:51], s12 offen lds
    s_add_u32 m0, s11, 2048
    s_movk_i32 s12, 128
    buffer_load_dwordx4 v10, s[48:51], s12 offen lds
    s_add_u32 m0, s11, 3072
    s_movk_i32 s12, 128
    buffer_load_dwordx4 v11, s[48:51], s12 offen lds
    s_waitcnt vmcnt(4)
    s_barrier
    s_add_u32 m0, s10, 0
    s_mov_b32 s13, 245760
    buffer_load_dwordx4 v22, s[52:55], s13 offen lds
    s_add_u32 m0, s10, 1024
    s_mov_b32 s13, 245760
    buffer_load_dwordx4 v23, s[52:55], s13 offen lds
    s_add_u32 m0, s10, 2048
    s_mov_b32 s13, 245760
    buffer_load_dwordx4 v24, s[52:55], s13 offen lds
    s_add_u32 m0, s10, 3072
    s_mov_b32 s13, 245760
    buffer_load_dwordx4 v25, s[52:55], s13 offen lds
    s_add_u32 m0, s10, 4096
    s_mov_b32 s13, 245760
    buffer_load_dwordx4 v26, s[52:55], s13 offen lds
    s_add_u32 m0, s10, 5120
    s_mov_b32 s13, 245760
    buffer_load_dwordx4 v27, s[52:55], s13 offen lds
    s_add_u32 m0, s10, 6144
    s_mov_b32 s13, 245760
    buffer_load_dwordx4 v28, s[52:55], s13 offen lds
    s_add_u32 m0, s10, 7168
    s_mov_b32 s13, 245760
    s_mov_b32 exec_hi, 0
    buffer_load_dwordx4 v29, s[52:55], s13 offen lds
    s_mov_b64 exec, -1
    s_add_u32 m0, s11, 47104
    s_movk_i32 s12, 256
    buffer_load_dwordx4 v8, s[48:51], s12 offen lds
    s_add_u32 m0, s11, 48128
    s_movk_i32 s12, 256
    buffer_load_dwordx4 v9, s[48:51], s12 offen lds
    s_add_u32 m0, s11, 49152
    s_movk_i32 s12, 256
    buffer_load_dwordx4 v10, s[48:51], s12 offen lds
    s_add_u32 m0, s11, 50176
    s_movk_i32 s12, 256
    buffer_load_dwordx4 v11, s[48:51], s12 offen lds
    s_waitcnt vmcnt(4)
    s_barrier
    s_add_u32 m0, s10, 47104
    s_mov_b32 s13, 491520
    buffer_load_dwordx4 v22, s[52:55], s13 offen lds
    s_add_u32 m0, s10, 48128
    s_mov_b32 s13, 491520
    buffer_load_dwordx4 v23, s[52:55], s13 offen lds
    s_add_u32 m0, s10, 49152
    s_mov_b32 s13, 491520
    buffer_load_dwordx4 v24, s[52:55], s13 offen lds
    s_add_u32 m0, s10, 50176
    s_mov_b32 s13, 491520
    buffer_load_dwordx4 v25, s[52:55], s13 offen lds
    s_add_u32 m0, s10, 51200
    s_mov_b32 s13, 491520
    buffer_load_dwordx4 v26, s[52:55], s13 offen lds
    s_add_u32 m0, s10, 52224
    s_mov_b32 s13, 491520
    buffer_load_dwordx4 v27, s[52:55], s13 offen lds
    s_add_u32 m0, s10, 53248
    s_mov_b32 s13, 491520
    buffer_load_dwordx4 v28, s[52:55], s13 offen lds
    s_add_u32 m0, s10, 54272
    s_mov_b32 s13, 491520
    s_mov_b32 exec_hi, 0
    buffer_load_dwordx4 v29, s[52:55], s13 offen lds
    s_mov_b64 exec, -1
    s_add_u32 m0, s11, 94208
    s_movk_i32 s12, 384
    buffer_load_dwordx4 v8, s[48:51], s12 offen lds
    s_add_u32 m0, s11, 95232
    s_movk_i32 s12, 384
    buffer_load_dwordx4 v9, s[48:51], s12 offen lds
    s_add_u32 m0, s11, 96256
    s_movk_i32 s12, 384
    buffer_load_dwordx4 v10, s[48:51], s12 offen lds
    s_add_u32 m0, s11, 97280
    s_movk_i32 s12, 384
    buffer_load_dwordx4 v11, s[48:51], s12 offen lds
    s_waitcnt vmcnt(4)
    s_barrier
    s_add_u32 m0, s10, 94208
    s_mov_b32 s13, 737280
    buffer_load_dwordx4 v22, s[52:55], s13 offen lds
    s_add_u32 m0, s10, 95232
    s_mov_b32 s13, 737280
    buffer_load_dwordx4 v23, s[52:55], s13 offen lds
    s_add_u32 m0, s10, 96256
    s_mov_b32 s13, 737280
    buffer_load_dwordx4 v24, s[52:55], s13 offen lds
    s_add_u32 m0, s10, 97280
    s_mov_b32 s13, 737280
    buffer_load_dwordx4 v25, s[52:55], s13 offen lds
    s_add_u32 m0, s10, 98304
    s_mov_b32 s13, 737280
    buffer_load_dwordx4 v26, s[52:55], s13 offen lds
    s_add_u32 m0, s10, 99328
    s_mov_b32 s13, 737280
    buffer_load_dwordx4 v27, s[52:55], s13 offen lds
    s_add_u32 m0, s10, 100352
    s_mov_b32 s13, 737280
    buffer_load_dwordx4 v28, s[52:55], s13 offen lds
    s_add_u32 m0, s10, 101376
    s_mov_b32 s13, 737280
    s_mov_b32 exec_hi, 0
    buffer_load_dwordx4 v29, s[52:55], s13 offen lds
    s_mov_b64 exec, -1
    s_add_u32 m0, s11, 0
    s_movk_i32 s12, 512
    buffer_load_dwordx4 v8, s[48:51], s12 offen lds
    s_add_u32 m0, s11, 1024
    s_movk_i32 s12, 512
    buffer_load_dwordx4 v9, s[48:51], s12 offen lds
    s_add_u32 m0, s11, 2048
    s_movk_i32 s12, 512
    buffer_load_dwordx4 v10, s[48:51], s12 offen lds
    s_add_u32 m0, s11, 3072
    s_movk_i32 s12, 512
    buffer_load_dwordx4 v11, s[48:51], s12 offen lds
    s_load_dword s98, s[38:39], 0
    s_waitcnt vmcnt(4)
    s_barrier
    s_add_u32 m0, s10, 0
    s_mov_b32 s13, 983040
    buffer_load_dwordx4 v22, s[52:55], s13 offen lds
    s_add_u32 m0, s10, 1024
    s_mov_b32 s13, 983040
    buffer_load_dwordx4 v23, s[52:55], s13 offen lds
    s_add_u32 m0, s10, 2048
    s_mov_b32 s13, 983040
    buffer_load_dwordx4 v24, s[52:55], s13 offen lds
    s_add_u32 m0, s10, 3072
    s_mov_b32 s13, 983040
    buffer_load_dwordx4 v25, s[52:55], s13 offen lds
    s_add_u32 m0, s10, 4096
    s_mov_b32 s13, 983040
    buffer_load_dwordx4 v26, s[52:55], s13 offen lds
    s_add_u32 m0, s10, 5120
    s_mov_b32 s13, 983040
    buffer_load_dwordx4 v27, s[52:55], s13 offen lds
    s_add_u32 m0, s10, 6144
    s_mov_b32 s13, 983040
    buffer_load_dwordx4 v28, s[52:55], s13 offen lds
    s_add_u32 m0, s10, 7168
    s_mov_b32 s13, 983040
    s_mov_b32 exec_hi, 0
    buffer_load_dwordx4 v29, s[52:55], s13 offen lds
    s_mov_b64 exec, -1
    s_add_u32 m0, s11, 47104
    s_movk_i32 s12, 640
    buffer_load_dwordx4 v8, s[48:51], s12 offen lds
    s_add_u32 m0, s11, 48128
    s_movk_i32 s12, 640
    buffer_load_dwordx4 v9, s[48:51], s12 offen lds
    s_add_u32 m0, s11, 49152
    s_movk_i32 s12, 640
    buffer_load_dwordx4 v10, s[48:51], s12 offen lds
    s_add_u32 m0, s11, 50176
    s_movk_i32 s12, 640
    buffer_load_dwordx4 v11, s[48:51], s12 offen lds
    s_waitcnt vmcnt(4)
    s_barrier
    s_add_u32 m0, s10, 47104
    s_mov_b32 s13, 1228800
    buffer_load_dwordx4 v22, s[52:55], s13 offen lds
    s_add_u32 m0, s10, 48128
    s_mov_b32 s13, 1228800
    buffer_load_dwordx4 v23, s[52:55], s13 offen lds
    s_add_u32 m0, s10, 49152
    s_mov_b32 s13, 1228800
    buffer_load_dwordx4 v24, s[52:55], s13 offen lds
    s_add_u32 m0, s10, 50176
    s_mov_b32 s13, 1228800
    buffer_load_dwordx4 v25, s[52:55], s13 offen lds
    s_add_u32 m0, s10, 51200
    s_mov_b32 s13, 1228800
    buffer_load_dwordx4 v26, s[52:55], s13 offen lds
    s_add_u32 m0, s10, 52224
    s_mov_b32 s13, 1228800
    buffer_load_dwordx4 v27, s[52:55], s13 offen lds
    s_add_u32 m0, s10, 53248
    s_mov_b32 s13, 1228800
    buffer_load_dwordx4 v28, s[52:55], s13 offen lds
    s_add_u32 m0, s10, 54272
    s_mov_b32 s13, 1228800
    s_mov_b32 exec_hi, 0
    buffer_load_dwordx4 v29, s[52:55], s13 offen lds
    s_mov_b64 exec, -1
    s_add_u32 m0, s11, 94208
    s_movk_i32 s12, 768
    buffer_load_dwordx4 v8, s[48:51], s12 offen lds
    s_add_u32 m0, s11, 95232
    s_movk_i32 s12, 768
    buffer_load_dwordx4 v9, s[48:51], s12 offen lds
    s_add_u32 m0, s11, 96256
    s_movk_i32 s12, 768
    buffer_load_dwordx4 v10, s[48:51], s12 offen lds
    s_add_u32 m0, s11, 97280
    s_movk_i32 s12, 768
    buffer_load_dwordx4 v11, s[48:51], s12 offen lds
    s_waitcnt lgkmcnt(0)
    s_mov_b32 s101, 0
    v_mov_b32_e64 v20, 0
Lp16:
    s_cmp_eq_u32 s98, 0xff
    s_cbranch_scc1 Lx17
    global_load_dword v21, v20, s[38:39] offset:0 sc1
    s_add_u32 s101, s101, 1
    s_waitcnt vmcnt(0)
    v_readfirstlane_b32 s98, v21
    s_cmp_lt_u32 s101, 400000
    s_cbranch_scc1 Lp16
Lx17:
    s_waitcnt vmcnt(4)
    s_barrier
    s_nop 0
    s_add_u32 m0, s10, 94208
    s_mov_b32 s13, 1474560
    buffer_load_dwordx4 v22, s[52:55], s13 offen lds
    s_add_u32 m0, s10, 95232
    s_mov_b32 s13, 1474560
    buffer_load_dwordx4 v23, s[52:55], s13 offen lds
    s_add_u32 m0, s10, 96256
    s_mov_b32 s13, 1474560
    buffer_load_dwordx4 v24, s[52:55], s13 offen lds
    s_add_u32 m0, s10, 97280
    s_mov_b32 s13, 1474560
    buffer_load_dwordx4 v25, s[52:55], s13 offen lds
    s_add_u32 m0, s10, 98304
    s_mov_b32 s13, 1474560
    buffer_load_dwordx4 v26, s[52:55], s13 offen lds
    s_add_u32 m0, s10, 99328
    s_mov_b32 s13, 1474560
    buffer_load_dwordx4 v27, s[52:55], s13 offen lds
    s_add_u32 m0, s10, 100352
    s_mov_b32 s13, 1474560
    buffer_load_dwordx4 v28, s[52:55], s13 offen lds
    s_add_u32 m0, s10, 101376
    s_mov_b32 s13, 1474560
    s_mov_b32 exec_hi, 0
    buffer_load_dwordx4 v29, s[52:55], s13 offen lds
    s_mov_b64 exec, -1
    s_add_u32 m0, s11, 0
    s_movk_i32 s12, 896
    buffer_load_dwordx4 v8, s[48:51], s12 offen lds
    s_add_u32 m0, s11, 1024
    s_movk_i32 s12, 896
    buffer_load_dwordx4 v9, s[48:51], s12 offen lds
    s_add_u32 m0, s11, 2048
    s_movk_i32 s12, 896
    buffer_load_dwordx4 v10, s[48:51], s12 offen lds
    s_add_u32 m0, s11, 3072
    s_movk_i32 s12, 896
    buffer_load_dwordx4 v11, s[48:51], s12 offen lds
    s_waitcnt vmcnt(4)
    s_barrier
    s_add_u32 m0, s10, 0
    s_mov_b32 s13, 1720320
    buffer_load_dwordx4 v22, s[52:55], s13 offen lds
    s_add_u32 m0, s10, 1024
    s_mov_b32 s13, 1720320
    buffer_load_dwordx4 v23, s[52:55], s13 offen lds
    s_add_u32 m0, s10, 2048
    s_mov_b32 s13, 1720320
    buffer_load_dwordx4 v24, s[52:55], s13 offen lds
    s_add_u32 m0, s10, 3072
    s_mov_b32 s13, 1720320
    buffer_load_dwordx4 v25, s[52:55], s13 offen lds
    s_add_u32 m0, s10, 4096
    s_mov_b32 s13, 1720320
    buffer_load_dwordx4 v26, s[52:55], s13 offen lds
    s_add_u32 m0, s10, 5120
    s_mov_b32 s13, 1720320
    buffer_load_dwordx4 v27, s[52:55], s13 offen lds
    s_add_u32 m0, s10, 6144
    s_mov_b32 s13, 1720320
    buffer_load_dwordx4 v28, s[52:55], s13 offen lds
    s_add_u32 m0, s10, 7168
    s_mov_b32 s13, 1720320
    s_mov_b32 exec_hi, 0
    buffer_load_dwordx4 v29, s[52:55], s13 offen lds
    s_mov_b64 exec, -1
    s_add_u32 m0, s11, 47104
    s_movk_i32 s12, 1024
    buffer_load_dwordx4 v8, s[48:51], s12 offen lds
    s_add_u32 m0, s11, 48128
    s_movk_i32 s12, 1024
    buffer_load_dwordx4 v9, s[48:51], s12 offen lds
    s_add_u32 m0, s11, 49152
    s_movk_i32 s12, 1024
    buffer_load_dwordx4 v10, s[48:51], s12 offen lds
    s_add_u32 m0, s11, 50176
    s_movk_i32 s12, 1024
    buffer_load_dwordx4 v11, s[48:51], s12 offen lds
    s_waitcnt vmcnt(4)
    s_barrier
    s_add_u32 m0, s10, 47104
    s_mov_b32 s13, 1966080
    buffer_load_dwordx4 v22, s[52:55], s13 offen lds
    s_add_u32 m0, s10, 48128
    s_mov_b32 s13, 1966080
    buffer_load_dwordx4 v23, s[52:55], s13 offen lds
    s_add_u32 m0, s10, 49152
    s_mov_b32 s13, 1966080
    buffer_load_dwordx4 v24, s[52:55], s13 offen lds
    s_add_u32 m0, s10, 50176
    s_mov_b32 s13, 1966080
    buffer_load_dwordx4 v25, s[52:55], s13 offen lds
    s_add_u32 m0, s10, 51200
    s_mov_b32 s13, 1966080
    buffer_load_dwordx4 v26, s[52:55], s13 offen lds
    s_add_u32 m0, s10, 52224
    s_mov_b32 s13, 1966080
    buffer_load_dwordx4 v27, s[52:55], s13 offen lds
    s_add_u32 m0, s10, 53248
    s_mov_b32 s13, 1966080
    buffer_load_dwordx4 v28, s[52:55], s13 offen lds
    s_add_u32 m0, s10, 54272
    s_mov_b32 s13, 1966080
    s_mov_b32 exec_hi, 0
    buffer_load_dwordx4 v29, s[52:55], s13 offen lds
    s_mov_b64 exec, -1
    s_add_u32 m0, s11, 94208
    s_movk_i32 s12, 1152
    buffer_load_dwordx4 v8, s[48:51], s12 offen lds
    s_add_u32 m0, s11, 95232
    s_movk_i32 s12, 1152
    buffer_load_dwordx4 v9, s[48:51], s12 offen lds
    s_add_u32 m0, s11, 96256
    s_movk_i32 s12, 1152
    buffer_load_dwordx4 v10, s[48:51], s12 offen lds
    s_add_u32 m0, s11, 97280
    s_movk_i32 s12, 1152
    buffer_load_dwordx4 v11, s[48:51], s12 offen lds
    s_waitcnt vmcnt(4)
    s_barrier
    s_add_u32 m0, s10, 94208
    s_mov_b32 s13, 2211840
    buffer_load_dwordx4 v22, s[52:55], s13 offen lds
    s_add_u32 m0, s10, 95232
    s_mov_b32 s13, 2211840
    buffer_load_dwordx4 v23, s[52:55], s13 offen lds
    s_add_u32 m0, s10, 96256
    s_mov_b32 s13, 2211840
    buffer_load_dwordx4 v24, s[52:55], s13 offen lds
    s_add_u32 m0, s10, 97280
    s_mov_b32 s13, 2211840
    buffer_load_dwordx4 v25, s[52:55], s13 offen lds
    s_add_u32 m0, s10, 98304
    s_mov_b32 s13, 2211840
    buffer_load_dwordx4 v26, s[52:55], s13 offen lds
    s_add_u32 m0, s10, 99328
    s_mov_b32 s13, 2211840
    buffer_load_dwordx4 v27, s[52:55], s13 offen lds
    s_add_u32 m0, s10, 100352
    s_mov_b32 s13, 2211840
    buffer_load_dwordx4 v28, s[52:55], s13 offen lds
    s_add_u32 m0, s10, 101376
    s_mov_b32 s13, 2211840
    s_mov_b32 exec_hi, 0
    buffer_load_dwordx4 v29, s[52:55], s13 offen lds
    s_mov_b64 exec, -1
    s_waitcnt vmcnt(0)
    s_barrier
    ds_read_b64_tr_b16 v[200:201], v231 offset:1280
    ds_read_b64_tr_b16 v[202:203], v231 offset:1600
    ds_read_b64_tr_b16 v[204:205], v231 offset:1920
    ds_read_b64_tr_b16 v[206:207], v231 offset:2240
    v_mov_b32 v208, 0
    v_mov_b32 v209, 0
    ds_read_b64_tr_b16 v[210:211], v230 offset:1600
    ds_read_b64_tr_b16 v[212:213], v230 offset:1920
    ds_read_b64_tr_b16 v[214:215], v230 offset:2240
    ds_read_b64_tr_b16 v[216:217], v231 offset:2560
    ds_read_b64_tr_b16 v[218:219], v231 offset:2880
    v_mov_b32 v220, 0
    v_mov_b32 v221, 0
    ds_read_b64_tr_b16 v[222:223], v230 offset:2240
    ds_read_b64_tr_b16 v[224:225], v230 offset:2560
    ds_read_b64_tr_b16 v[226:227], v230 offset:2880
    s_waitcnt lgkmcnt(11)
    v_xor_b32 v200, v200, v232
    v_xor_b32_e64 v201, v201, v232
    s_mov_b32 s4, 0xff00
    s_mov_b32 s5, 0xff00
    v_cndmask_b32 v200, 0, v200, s[4:5]
    v_cndmask_b32 v201, 0, v201, s[4:5]
    s_waitcnt lgkmcnt(10)
    v_xor_b32 v202, v202, v232
    v_xor_b32_e64 v203, v203, v232
    s_mov_b32 s4, 0xff0000
    s_mov_b32 s5, 0xff0000
    v_cndmask_b32 v202, 0, v202, s[4:5]
    v_cndmask_b32 v203, 0, v203, s[4:5]
    s_waitcnt lgkmcnt(9)
    v_xor_b32 v204, v204, v232
    v_xor_b32_e64 v205, v205, v232
    s_mov_b32 s4, 0xff0000
    s_mov_b32 s5, 0xff0000
    v_cndmask_b32 v204, 0, v204, s[4:5]
    v_cndmask_b32 v205, 0, v205, s[4:5]
    s_waitcnt lgkmcnt(8)
    v_xor_b32 v206, v206, v232
    v_xor_b32_e64 v207, v207, v232
    s_mov_b32 s4, 0xff0000
    s_mov_b32 s5, 0xff000000
    v_cndmask_b32 v206, 0, v206, s[4:5]
    v_cndmask_b32 v207, 0, v207, s[4:5]
    s_waitcnt lgkmcnt(7)
    v_xor_b32 v210, v210, v232
    v_xor_b32 v211, v211, v232
    s_waitcnt lgkmcnt(6)
    v_xor_b32 v212, v212, v232
    v_xor_b32 v213, v213, v232
    s_waitcnt lgkmcnt(5)
    v_xor_b32 v214, v214, v232
    v_xor_b32 v215, v215, v232
    s_mov_b32 s4, 0xffffffff
    s_mov_b32 s5, 0x0
    v_cndmask_b32 v214, 0, v214, s[4:5]
    v_cndmask_b32 v215, 0, v215, s[4:5]
    s_waitcnt lgkmcnt(4)
    v_xor_b32 v216, v216, v232
    v_xor_b32 v217, v217, v232
    s_mov_b32 s4, 0xff000000
    s_mov_b32 s5, 0xff000000
    v_cndmask_b32 v216, 0, v216, s[4:5]
    v_cndmask_b32 v217, 0, v217, s[4:5]
    s_waitcnt lgkmcnt(3)
    v_xor_b32 v218, v218, v232
    v_xor_b32_e64 v219, v219, v232
    s_mov_b32 s4, 0xff000000
    s_mov_b32 s5, 0xff000000
    v_cndmask_b32 v218, 0, v218, s[4:5]
    v_cndmask_b32 v219, 0, v219, s[4:5]
    s_waitcnt lgkmcnt(2)
    v_xor_b32 v222, v222, v232
    v_xor_b32 v223, v223, v232
    s_mov_b32 s4, 0x0
    s_mov_b32 s5, 0xffffffff
    v_cndmask_b32 v222, 0, v222, s[4:5]
    v_cndmask_b32 v223, 0, v223, s[4:5]
    s_waitcnt lgkmcnt(1)
    v_xor_b32 v224, v224, v232
    v_xor_b32 v225, v225, v232
    s_waitcnt lgkmcnt(0)
    v_xor_b32 v226, v226, v232
    v_xor_b32 v227, v227, v232
    s_lshl_b32 s66, s67, 2
    s_lshr_b32 s5, s64, 2
    s_add_u32 s66, s66, s5
    s_and_b32 s65, s64, 3
    s_lshl_b32 s65, s65, 2
    s_add_u32 s65, s65, s3
    s_sub_u32 s65, s65, 4
    v_lshlrev_b32 v2, 4, v1
    v_and_b32 v3, 31, v1
    v_lshlrev_b32 v4, 3, v3
    s_lshl_b32 s8, s66, 16
    s_lshl_b32 s5, s65, 12
    s_add_u32 s8, s8, s5
    s_lshr_b32 s9, s8, 2
    s_add_u32 s10, s9, 0x200000
    v_lshrrev_b32 v12, 5, v1
    v_bfe_u32 v13, v1, 2, 2
    v_and_b32_e64 v14, 3, v1
    v_bfe_u32 v15, v1, 4, 1
    v_lshl_add_u32 v14, v15, 2, v14
    v_lshrrev_b32 v14, 1, v14
    s_and_b32 s7, s66, 3
    s_mul_i32 s7, s7, 800
    s_add_u32 s7, s7, 147456
    s_and_b32 s4, s66, 1
    s_mul_i32 s5, s4, 160
    s_add_u32 s5, s5, s7
    s_xor_b32 s4, s4, 1
    s_mul_i32 s6, s4, 640
    s_add_u32 s6, s6, s7
    v_lshl_add_u32 v5, v12, 2, v13
    v_mul_u32_u24 v5, 40, v5
    v_add_u32 v5, s5, v5
    v_lshl_add_u32 v6, v14, 3, v5
    v_mul_u32_u24 v7, 40, v13
    v_add_u32 v7, s6, v7
    v_lshl_add_u32 v8, v14, 3, v7
    v_bfe_u32 v9, v1, 2, 1
    v_mul_u32_u24 v9, 0x8000, v9
    v_lshl_or_b32 v9, v9, 16, v9
    ds_read_b64_tr_b16 v[44:45], v6
    ds_read_b64_tr_b16 v[46:47], v6 offset:320
    ds_read_b64_tr_b16 v[48:49], v5 offset:32
    ds_read_b64_tr_b16 v[50:51], v5 offset:352
    ds_read_b64_tr_b16 v[52:53], v8
    ds_read_b64_tr_b16 v[54:55], v7 offset:32
    v_cmp_gt_u32 vcc, 32, v1
    s_waitcnt lgkmcnt(0)
    v_xor_b32 v44, v44, v9
    v_xor_b32 v45, v45, v9
    v_xor_b32 v46, v46, v9
    v_xor_b32 v47, v47, v9
    v_xor_b32 v48, v48, v9
    v_xor_b32 v49, v49, v9
    v_xor_b32 v50, v50, v9
    v_xor_b32 v51, v51, v9
    v_xor_b32 v52, v52, v9
    v_xor_b32 v53, v53, v9
    v_xor_b32 v54, v54, v9
    v_xor_b32 v55, v55, v9
    v_cndmask_b32 v52, 0, v52, vcc
    v_cndmask_b32 v53, 0, v53, vcc
    v_cndmask_b32 v54, 0, v54, vcc
    v_cndmask_b32 v55, 0, v55, vcc
    v_mov_b32 v7, 0x80000000
    v_cndmask_b32 v7, v7, v4, vcc
    v_min_u32 v5, 20, v3
    v_mul_u32_u24 v6, 24, v12
    v_add_u32 v6, v5, v6
    v_lshlrev_b32 v5, 4, v6
    v_add_u32 v5, 0, v5
    v_lshlrev_b32_e64 v6, 3, v6
    v_add_u32 v6, 1536, v6
    v_mov_b32 v16, 41128
    v_mov_b32_e64 v17, 0
    ds_write_b32 v16, v17
    s_waitcnt lgkmcnt(0)
    s_barrier
    ds_read_b128 v[112:115], v238 offset:0
    ds_read_b128 v[116:119], v238 offset:1024
    ds_read_b128 v[120:123], v238 offset:2048
    s_waitcnt lgkmcnt(2)
    v_mfma_f32_32x32x16_bf16 v[64:79], v[200:203], v[112:115], 0
    s_waitcnt lgkmcnt(1)
    v_mfma_f32_32x32x16_bf16 v[64:79], v[204:207], v[116:119], v[64:79]
    v_mfma_f32_32x32x16_bf16 v[80:95], v[208:211], v[112:115], 0
    v_mfma_f32_32x32x16_bf16 v[80:95], v[212:215], v[116:119], v[80:95]
    s_waitcnt lgkmcnt(0)
    v_mfma_f32_32x32x16_bf16 v[64:79], v[216:219], v[120:123], v[64:79]
    v_mfma_f32_32x32x16_bf16 v[96:111], v[220:223], v[116:119], 0
    v_mfma_f32_32x32x16_bf16 v[96:111], v[224:227], v[120:123], v[96:111]
    s_nop 7
    v_max3_f32 v144, v80, v81, v82
    v_max3_f32 v145, v83, v84, v85
    v_max3_f32 v144, v144, v86, v87
    v_max3_f32 v145, v145, v88, v89
    v_max3_f32 v144, v144, v90, v91
    v_max3_f32 v145, v145, v92, v93
    v_max3_f32 v144, v144, v94, v95
    v_max3_f32 v145, v145, v72, v73
    v_max3_f32 v144, v144, v74, v75
    v_max_f32_e64 v144, v144, v145
    v_mul_f32 v144, 0xbfb8aa3b, v144
    v_pk_fma_f32 v[80:81], v[80:81], s[70:71], v[144:145] op_sel_hi:[1,1,0]
    v_pk_fma_f32 v[82:83], v[82:83], s[70:71], v[144:145] op_sel_hi:[1,1,0]
    v_pk_fma_f32 v[84:85], v[84:85], s[70:71], v[144:145] op_sel_hi:[1,1,0]
    v_pk_fma_f32 v[86:87], v[86:87], s[70:71], v[144:145] op_sel_hi:[1,1,0]
    v_pk_fma_f32 v[88:89], v[88:89], s[70:71], v[144:145] op_sel_hi:[1,1,0]
    v_pk_fma_f32 v[90:91], v[90:91], s[70:71], v[144:145] op_sel_hi:[1,1,0]
    v_pk_fma_f32 v[92:93], v[92:93], s[70:71], v[144:145] op_sel_hi:[1,1,0]
    v_pk_fma_f32 v[94:95], v[94:95], s[70:71], v[144:145] op_sel_hi:[1,1,0]
    v_pk_fma_f32 v[72:73], v[72:73], s[70:71], v[144:145] op_sel_hi:[1,1,0]
    v_pk_fma_f32 v[74:75], v[74:75], s[70:71], v[144:145] op_sel_hi:[1,1,0]
    v_exp_f32 v80, v80
    v_exp_f32 v81, v81
    v_exp_f32 v82, v82
    v_exp_f32 v83, v83
    v_exp_f32 v84, v84
    v_exp_f32 v85, v85
    v_pk_add_f32 v[146:147], v[80:81], v[82:83]
    v_exp_f32 v86, v86
    v_exp_f32 v87, v87
    v_pk_add_f32 v[146:147], v[146:147], v[84:85]
    v_exp_f32 v88, v88
    v_exp_f32 v89, v89
    v_pk_add_f32 v[146:147], v[146:147], v[86:87]
    v_exp_f32 v90, v90
    v_exp_f32 v91, v91
    v_pk_add_f32 v[146:147], v[146:147], v[88:89]
    v_exp_f32 v92, v92
    v_exp_f32 v93, v93
    v_pk_add_f32 v[146:147], v[146:147], v[90:91]
    v_exp_f32 v94, v94
    v_exp_f32 v95, v95
    v_pk_add_f32 v[146:147], v[146:147], v[92:93]
    v_exp_f32 v72, v72
    v_exp_f32 v73, v73
    v_pk_add_f32 v[146:147], v[146:147], v[94:95]
    v_exp_f32 v74, v74
    v_exp_f32 v75, v75
    v_pk_add_f32 v[146:147], v[146:147], v[72:73]
    v_pk_add_f32 v[146:147], v[146:147], v[74:75]
    v_add_f32_e64 v146, v146, v147
    v_rcp_f32 v146, v146
    s_nop 0
    v_pk_mul_f32 v[80:81], v[80:81], v[146:147] op_sel_hi:[1,0]
    v_pk_mul_f32 v[82:83], v[82:83], v[146:147] op_sel_hi:[1,0]
    v_cvt_pk_bf16_f32 v124, v80, v81
    v_pk_mul_f32 v[84:85], v[84:85], v[146:147] op_sel_hi:[1,0]
    v_cvt_pk_bf16_f32 v125, v82, v83
    v_pk_mul_f32 v[86:87], v[86:87], v[146:147] op_sel_hi:[1,0]
    v_cvt_pk_bf16_f32 v126, v84, v85
    v_pk_mul_f32 v[88:89], v[88:89], v[146:147] op_sel_hi:[1,0]
    v_cvt_pk_bf16_f32 v127, v86, v87
    v_pk_mul_f32 v[90:91], v[90:91], v[146:147] op_sel_hi:[1,0]
    v_cvt_pk_bf16_f32 v128, v88, v89
    ds_write_b128 v236, v[124:127] offset:128
    v_pk_mul_f32 v[92:93], v[92:93], v[146:147] op_sel_hi:[1,0]
    v_cvt_pk_bf16_f32 v129, v90, v91
    v_pk_mul_f32 v[94:95], v[94:95], v[146:147] op_sel_hi:[1,0]
    v_cvt_pk_bf16_f32 v130, v92, v93
    v_pk_mul_f32 v[72:73], v[72:73], v[146:147] op_sel_hi:[1,0]
    v_cvt_pk_bf16_f32 v131, v94, v95
    v_pk_mul_f32 v[74:75], v[74:75], v[146:147] op_sel_hi:[1,0]
    v_cvt_pk_bf16_f32 v140, v72, v73
    v_cvt_pk_bf16_f32 v141, v74, v75
    v_max3_f32 v144, v96, v97, v98
    v_max3_f32 v145, v99, v100, v101
    v_max3_f32 v144, v144, v102, v103
    v_max3_f32 v145, v145, v104, v105
    v_max3_f32 v144, v144, v106, v107
    v_max3_f32 v145, v145, v108, v109
    v_max3_f32 v144, v144, v110, v111
    v_max3_f32 v145, v145, v76, v77
    v_max3_f32 v144, v144, v78, v79
    ds_write_b128 v237, v[128:131] offset:128
    v_max_f32_e64 v144, v144, v145
    v_mul_f32 v144, 0xbfb8aa3b, v144
    v_pk_fma_f32 v[96:97], v[96:97], s[70:71], v[144:145] op_sel_hi:[1,1,0]
    v_pk_fma_f32 v[98:99], v[98:99], s[70:71], v[144:145] op_sel_hi:[1,1,0]
    v_pk_fma_f32 v[100:101], v[100:101], s[70:71], v[144:145] op_sel_hi:[1,1,0]
    v_pk_fma_f32 v[102:103], v[102:103], s[70:71], v[144:145] op_sel_hi:[1,1,0]
    v_pk_fma_f32 v[104:105], v[104:105], s[70:71], v[144:145] op_sel_hi:[1,1,0]
    v_pk_fma_f32 v[106:107], v[106:107], s[70:71], v[144:145] op_sel_hi:[1,1,0]
    v_pk_fma_f32 v[108:109], v[108:109], s[70:71], v[144:145] op_sel_hi:[1,1,0]
    v_pk_fma_f32 v[110:111], v[110:111], s[70:71], v[144:145] op_sel_hi:[1,1,0]
    v_pk_fma_f32 v[76:77], v[76:77], s[70:71], v[144:145] op_sel_hi:[1,1,0]
    v_pk_fma_f32 v[78:79], v[78:79], s[70:71], v[144:145] op_sel_hi:[1,1,0]
    v_exp_f32 v96, v96
    v_exp_f32 v97, v97
    v_exp_f32 v98, v98
    v_exp_f32 v99, v99
    v_exp_f32 v100, v100
    v_exp_f32 v101, v101
    v_pk_add_f32 v[146:147], v[96:97], v[98:99]
    v_exp_f32 v102, v102
    v_exp_f32 v103, v103
    v_pk_add_f32 v[146:147], v[146:147], v[100:101]
    v_exp_f32 v104, v104
    v_exp_f32 v105, v105
    v_pk_add_f32 v[146:147], v[146:147], v[102:103]
    v_exp_f32 v106, v106
    v_exp_f32 v107, v107
    v_pk_add_f32 v[146:147], v[146:147], v[104:105]
    v_exp_f32 v108, v108
    v_exp_f32 v109, v109
    v_pk_add_f32 v[146:147], v[146:147], v[106:107]
    v_exp_f32 v110, v110
    v_exp_f32 v111, v111
    v_pk_add_f32 v[146:147], v[146:147], v[108:109]
    v_exp_f32 v76, v76
    v_exp_f32 v77, v77
    v_pk_add_f32 v[146:147], v[146:147], v[110:111]
    v_exp_f32 v78, v78
    v_exp_f32 v79, v79
    v_pk_add_f32 v[146:147], v[146:147], v[76:77]
    v_pk_add_f32 v[146:147], v[146:147], v[78:79]
    v_add_f32_e64 v146, v146, v147
    v_rcp_f32 v146, v146
    s_nop 0
    v_pk_mul_f32 v[96:97], v[96:97], v[146:147] op_sel_hi:[1,0]
    v_pk_mul_f32 v[98:99], v[98:99], v[146:147] op_sel_hi:[1,0]
    v_cvt_pk_bf16_f32 v132, v96, v97
    v_pk_mul_f32 v[100:101], v[100:101], v[146:147] op_sel_hi:[1,0]
    v_cvt_pk_bf16_f32 v133, v98, v99
    v_pk_mul_f32 v[102:103], v[102:103], v[146:147] op_sel_hi:[1,0]
    v_cvt_pk_bf16_f32 v134, v100, v101
    v_pk_mul_f32 v[104:105], v[104:105], v[146:147] op_sel_hi:[1,0]
    v_cvt_pk_bf16_f32 v135, v102, v103
    v_pk_mul_f32 v[106:107], v[106:107], v[146:147] op_sel_hi:[1,0]
    v_cvt_pk_bf16_f32 v136, v104, v105
    ds_write_b128 v236, v[132:135] offset:192
    v_pk_mul_f32 v[108:109], v[108:109], v[146:147] op_sel_hi:[1,0]
    v_cvt_pk_bf16_f32 v137, v106, v107
    v_pk_mul_f32 v[110:111], v[110:111], v[146:147] op_sel_hi:[1,0]
    v_cvt_pk_bf16_f32 v138, v108, v109
    v_pk_mul_f32 v[76:77], v[76:77], v[146:147] op_sel_hi:[1,0]
    v_cvt_pk_bf16_f32 v139, v110, v111
    v_pk_mul_f32 v[78:79], v[78:79], v[146:147] op_sel_hi:[1,0]
    v_cvt_pk_bf16_f32 v142, v76, v77
    v_cvt_pk_bf16_f32 v143, v78, v79
    ds_write_b128 v237, v[136:139] offset:192
    ds_write_b128 v237, v[140:143] offset:256
    s_waitcnt lgkmcnt(0)
    s_lshl4_add_u32 s15, s67, s65
    s_add_u32 s15, s15, 384
    s_barrier
    s_lshl_b32 s4, s15, 8
    s_add_u32 s4, s4, 0xbc0000
    s_add_u32 s96, s40, s4
    s_addc_u32 s97, s41, 0
    s_mov_b32 s98, 0
    s_atomic_add s98, s[96:97], 0 glc
    s_add_u32 s4, s3, 0xfffffffd
    s_mov_b32 s5, 9
Lwo18:
    s_cmp_ge_u32 s4, s5
    s_cbranch_scc1 Lwx19
    s_mov_b32 s6, s4
    s_mul_i32 s7, s6, 40960
    s_mul_i32 s6, s6, 5120
    s_add_u32 m0, s6, 61440
    s_nop 0
    buffer_load_dwordx4 v240, s[60:63], s7 offen lds
    s_add_u32 m0, s6, 62464
    s_nop 0
    buffer_load_dwordx4 v241, s[60:63], s7 offen lds
    s_add_u32 m0, s6, 63488
    s_nop 0
    buffer_load_dwordx4 v242, s[60:63], s7 offen lds
    s_add_u32 m0, s6, 64512
    s_nop 0
    buffer_load_dwordx4 v243, s[60:63], s7 offen lds
    s_add_u32 m0, s6, 65536
    s_nop 0
    buffer_load_dwordx4 v244, s[60:63], s7 offen lds
    s_add_u32 s4, s4, 4
    s_branch Lwo18
Lwx19:
    s_waitcnt lgkmcnt(0)
    s_mov_b32 s101, 0
    s_branch Lc22
Lp20:
    s_mov_b32 s98, 0
    s_atomic_add s98, s[96:97], 0 glc
    s_add_u32 s101, s101, 1
    s_waitcnt lgkmcnt(0)
Lc22:
    s_cmp_eq_u32 s98, 4
    s_cbranch_scc1 Lx21
    s_sleep 1
    s_cmp_lt_u32 s101, 400000
    s_cbranch_scc1 Lp20
    s_nop 0
Lx21:
    buffer_load_dwordx4 v[20:23], v2, s[44:47], s8 offen offset:0 sc1
    buffer_load_dwordx2 v[24:25], v4, s[44:47], s10 offen offset:0 sc1
    buffer_load_dwordx4 v[26:29], v2, s[44:47], s8 offen offset:1024 sc1
    buffer_load_dwordx2 v[30:31], v4, s[44:47], s10 offen offset:256 sc1
    buffer_load_dwordx4 v[32:35], v2, s[44:47], s8 offen offset:2048 sc1
    buffer_load_dwordx2 v[36:37], v4, s[44:47], s10 offen offset:512 sc1
    buffer_load_dwordx4 v[38:41], v2, s[44:47], s8 offen offset:3072 sc1
    buffer_load_dwordx2 v[42:43], v4, s[44:47], s10 offen offset:768 sc1
    s_waitcnt vmcnt(6)
    v_mfma_f32_32x32x16_bf16 v[64:79], v[44:47], v[20:23], 0
    v_mfma_f32_32x32x16_bf16 v[80:95], v[48:51], v[20:23], 0
    s_waitcnt vmcnt(4)
    v_mfma_f32_32x32x16_bf16 v[96:111], v[44:47], v[26:29], 0
    v_mfma_f32_32x32x16_bf16 v[112:127], v[48:51], v[26:29], 0
    s_waitcnt vmcnt(2)
    v_mfma_f32_32x32x16_bf16 v[128:143], v[44:47], v[32:35], 0
    v_mfma_f32_32x32x16_bf16 v[144:159], v[48:51], v[32:35], 0
    s_waitcnt vmcnt(0)
    v_mfma_f32_32x32x16_bf16 v[160:175], v[44:47], v[38:41], 0
    v_mfma_f32_32x32x16_bf16 v[176:191], v[48:51], v[38:41], 0
    v_mfma_f32_32x32x8_bf16 v[64:79], v[52:53], v[24:25], v[64:79]
    v_mfma_f32_32x32x8_bf16 v[80:95], v[54:55], v[24:25], v[80:95]
    s_nop 10
    v_max3_f32 v232, v64, v65, v66
    v_max3_f32 v233, v67, v68, v69
    v_max3_f32 v232, v232, v70, v71
    v_max3_f32 v233, v233, v72, v73
    v_max3_f32 v232, v232, v74, v75
    v_max3_f32 v233, v233, v76, v77
    v_max3_f32 v232, v232, v78, v79
    v_max3_f32 v233, v233, v80, v81
    v_max3_f32 v232, v232, v82, v83
    v_mfma_f32_32x32x8_bf16 v[96:111], v[52:53], v[30:31], v[96:111]
    v_mfma_f32_32x32x8_bf16 v[112:127], v[54:55], v[30:31], v[112:127]
    v_max_f32_e64 v232, v232, v233
    v_mul_f32 v232, 0xbfb8aa3b, v232
    v_pk_fma_f32 v[64:65], v[64:65], s[70:71], v[232:233] op_sel_hi:[1,1,0]
    v_pk_fma_f32 v[66:67], v[66:67], s[70:71], v[232:233] op_sel_hi:[1,1,0]
    v_pk_fma_f32 v[68:69], v[68:69], s[70:71], v[232:233] op_sel_hi:[1,1,0]
    v_pk_fma_f32 v[70:71], v[70:71], s[70:71], v[232:233] op_sel_hi:[1,1,0]
    v_pk_fma_f32 v[72:73], v[72:73], s[70:71], v[232:233] op_sel_hi:[1,1,0]
    v_pk_fma_f32 v[74:75], v[74:75], s[70:71], v[232:233] op_sel_hi:[1,1,0]
    v_pk_fma_f32 v[76:77], v[76:77], s[70:71], v[232:233] op_sel_hi:[1,1,0]
    v_pk_fma_f32 v[78:79], v[78:79], s[70:71], v[232:233] op_sel_hi:[1,1,0]
    v_pk_fma_f32 v[80:81], v[80:81], s[70:71], v[232:233] op_sel_hi:[1,1,0]
    v_pk_fma_f32 v[82:83], v[82:83], s[70:71], v[232:233] op_sel_hi:[1,1,0]
    v_exp_f32 v64, v64
    v_exp_f32 v65, v65
    v_exp_f32 v66, v66
    v_exp_f32 v67, v67
    v_exp_f32 v68, v68
    v_exp_f32_e64 v69, v69
    v_pk_add_f32 v[234:235], v[64:65], v[66:67]
    v_exp_f32 v70, v70
    v_exp_f32 v71, v71
    v_pk_add_f32 v[234:235], v[234:235], v[68:69]
    v_exp_f32 v72, v72
    v_exp_f32 v73, v73
    v_pk_add_f32 v[234:235], v[234:235], v[70:71]
    v_exp_f32 v74, v74
    v_exp_f32 v75, v75
    v_pk_add_f32 v[234:235], v[234:235], v[72:73]
    v_exp_f32 v76, v76
    v_exp_f32 v77, v77
    v_pk_add_f32 v[234:235], v[234:235], v[74:75]
    v_exp_f32 v78, v78
    v_exp_f32 v79, v79
    v_pk_add_f32 v[234:235], v[234:235], v[76:77]
    v_exp_f32 v80, v80
    v_exp_f32 v81, v81
    v_pk_add_f32 v[234:235], v[234:235], v[78:79]
    v_exp_f32 v82, v82
    v_exp_f32 v83, v83
    v_pk_add_f32 v[234:235], v[234:235], v[80:81]
    v_pk_add_f32 v[234:235], v[234:235], v[82:83]
    v_add_f32_e64 v234, v234, v235
    v_rcp_f32 v234, v234
    s_nop 0
    v_pk_mul_f32 v[64:65], v[64:65], v[234:235] op_sel_hi:[1,0]
    v_pk_mul_f32 v[66:67], v[66:67], v[234:235] op_sel_hi:[1,0]
    v_cvt_pk_bf16_f32 v192, v64, v65
    v_pk_mul_f32 v[68:69], v[68:69], v[234:235] op_sel_hi:[1,0]
    v_cvt_pk_bf16_f32 v193, v66, v67
    v_pk_mul_f32 v[70:71], v[70:71], v[234:235] op_sel_hi:[1,0]
    v_cvt_pk_bf16_f32 v194, v68, v69
    v_pk_mul_f32 v[72:73], v[72:73], v[234:235] op_sel_hi:[1,0]
    v_cvt_pk_bf16_f32 v195, v70, v71
    v_pk_mul_f32 v[74:75], v[74:75], v[234:235] op_sel_hi:[1,0]
    v_cvt_pk_bf16_f32 v196, v72, v73
    v_pk_mul_f32 v[76:77], v[76:77], v[234:235] op_sel_hi:[1,0]
    v_cvt_pk_bf16_f32 v197, v74, v75
    v_pk_mul_f32 v[78:79], v[78:79], v[234:235] op_sel_hi:[1,0]
    v_cvt_pk_bf16_f32 v198, v76, v77
    v_pk_mul_f32 v[80:81], v[80:81], v[234:235] op_sel_hi:[1,0]
    v_cvt_pk_bf16_f32 v199, v78, v79
    v_pk_mul_f32 v[82:83], v[82:83], v[234:235] op_sel_hi:[1,0]
    v_cvt_pk_bf16_f32 v200, v80, v81
    v_cvt_pk_bf16_f32 v201, v82, v83
    v_max3_f32 v232, v96, v97, v98
    v_max3_f32 v233, v99, v100, v101
    v_max3_f32 v232, v232, v102, v103
    v_max3_f32 v233, v233, v104, v105
    v_max3_f32 v232, v232, v106, v107
    v_max3_f32 v233, v233, v108, v109
    v_max3_f32 v232, v232, v110, v111
    v_max3_f32 v233, v233, v112, v113
    v_max3_f32 v232, v232, v114, v115
    v_mfma_f32_32x32x8_bf16 v[128:143], v[52:53], v[36:37], v[128:143]
    v_mfma_f32_32x32x8_bf16 v[144:159], v[54:55], v[36:37], v[144:159]
    v_max_f32_e64 v232, v232, v233
    v_mul_f32 v232, 0xbfb8aa3b, v232
    v_pk_fma_f32 v[96:97], v[96:97], s[70:71], v[232:233] op_sel_hi:[1,1,0]
    v_pk_fma_f32 v[98:99], v[98:99], s[70:71], v[232:233] op_sel_hi:[1,1,0]
    v_pk_fma_f32 v[100:101], v[100:101], s[70:71], v[232:233] op_sel_hi:[1,1,0]
    v_pk_fma_f32 v[102:103], v[102:103], s[70:71], v[232:233] op_sel_hi:[1,1,0]
    v_pk_fma_f32 v[104:105], v[104:105], s[70:71], v[232:233] op_sel_hi:[1,1,0]
    v_pk_fma_f32 v[106:107], v[106:107], s[70:71], v[232:233] op_sel_hi:[1,1,0]
    v_pk_fma_f32 v[108:109], v[108:109], s[70:71], v[232:233] op_sel_hi:[1,1,0]
    v_pk_fma_f32 v[110:111], v[110:111], s[70:71], v[232:233] op_sel_hi:[1,1,0]
    v_pk_fma_f32 v[112:113], v[112:113], s[70:71], v[232:233] op_sel_hi:[1,1,0]
    v_pk_fma_f32 v[114:115], v[114:115], s[70:71], v[232:233] op_sel_hi:[1,1,0]
    v_exp_f32 v96, v96
    v_exp_f32 v97, v97
    v_exp_f32 v98, v98
    v_exp_f32 v99, v99
    v_exp_f32 v100, v100
    v_exp_f32 v101, v101
    v_pk_add_f32 v[234:235], v[96:97], v[98:99]
    v_exp_f32 v102, v102
    v_exp_f32 v103, v103
    v_pk_add_f32 v[234:235], v[234:235], v[100:101]
    v_exp_f32 v104, v104
    v_exp_f32 v105, v105
    v_pk_add_f32 v[234:235], v[234:235], v[102:103]
    v_exp_f32 v106, v106
    v_exp_f32 v107, v107
    v_pk_add_f32 v[234:235], v[234:235], v[104:105]
    v_exp_f32 v108, v108
    v_exp_f32 v109, v109
    v_pk_add_f32 v[234:235], v[234:235], v[106:107]
    v_exp_f32 v110, v110
    v_exp_f32 v111, v111
    v_pk_add_f32 v[234:235], v[234:235], v[108:109]
    v_exp_f32 v112, v112
    v_exp_f32 v113, v113
    v_pk_add_f32 v[234:235], v[234:235], v[110:111]
    v_exp_f32 v114, v114
    v_exp_f32 v115, v115
    v_pk_add_f32 v[234:235], v[234:235], v[112:113]
    v_pk_add_f32 v[234:235], v[234:235], v[114:115]
    v_add_f32_e64 v234, v234, v235
    v_rcp_f32 v234, v234
    s_nop 0
    v_pk_mul_f32 v[96:97], v[96:97], v[234:235] op_sel_hi:[1,0]
    v_pk_mul_f32 v[98:99], v[98:99], v[234:235] op_sel_hi:[1,0]
    v_cvt_pk_bf16_f32 v202, v96, v97
    v_pk_mul_f32 v[100:101], v[100:101], v[234:235] op_sel_hi:[1,0]
    v_cvt_pk_bf16_f32 v203, v98, v99
    v_pk_mul_f32 v[102:103], v[102:103], v[234:235] op_sel_hi:[1,0]
    v_cvt_pk_bf16_f32 v204, v100, v101
    v_pk_mul_f32 v[104:105], v[104:105], v[234:235] op_sel_hi:[1,0]
    v_cvt_pk_bf16_f32 v205, v102, v103
    v_pk_mul_f32 v[106:107], v[106:107], v[234:235] op_sel_hi:[1,0]
    v_cvt_pk_bf16_f32 v206, v104, v105
    v_pk_mul_f32 v[108:109], v[108:109], v[234:235] op_sel_hi:[1,0]
    v_cvt_pk_bf16_f32 v207, v106, v107
    v_pk_mul_f32 v[110:111], v[110:111], v[234:235] op_sel_hi:[1,0]
    v_cvt_pk_bf16_f32 v208, v108, v109
    v_pk_mul_f32 v[112:113], v[112:113], v[234:235] op_sel_hi:[1,0]
    v_cvt_pk_bf16_f32 v209, v110, v111
    v_pk_mul_f32 v[114:115], v[114:115], v[234:235] op_sel_hi:[1,0]
    v_cvt_pk_bf16_f32 v210, v112, v113
    v_cvt_pk_bf16_f32 v211, v114, v115
    v_max3_f32 v232, v128, v129, v130
    v_max3_f32 v233, v131, v132, v133
    v_max3_f32 v232, v232, v134, v135
    v_max3_f32 v233, v233, v136, v137
    v_max3_f32 v232, v232, v138, v139
    v_max3_f32 v233, v233, v140, v141
    v_max3_f32 v232, v232, v142, v143
    v_max3_f32 v233, v233, v144, v145
    v_max3_f32 v232, v232, v146, v147
    v_mfma_f32_32x32x8_bf16 v[160:175], v[52:53], v[42:43], v[160:175]
    v_mfma_f32_32x32x8_bf16 v[176:191], v[54:55], v[42:43], v[176:191]
    v_max_f32_e64 v232, v232, v233
    v_mul_f32 v232, 0xbfb8aa3b, v232
    v_pk_fma_f32 v[128:129], v[128:129], s[70:71], v[232:233] op_sel_hi:[1,1,0]
    v_pk_fma_f32 v[130:131], v[130:131], s[70:71], v[232:233] op_sel_hi:[1,1,0]
    v_pk_fma_f32 v[132:133], v[132:133], s[70:71], v[232:233] op_sel_hi:[1,1,0]
    v_pk_fma_f32 v[134:135], v[134:135], s[70:71], v[232:233] op_sel_hi:[1,1,0]
    v_pk_fma_f32 v[136:137], v[136:137], s[70:71], v[232:233] op_sel_hi:[1,1,0]
    v_pk_fma_f32 v[138:139], v[138:139], s[70:71], v[232:233] op_sel_hi:[1,1,0]
    v_pk_fma_f32 v[140:141], v[140:141], s[70:71], v[232:233] op_sel_hi:[1,1,0]
    v_pk_fma_f32 v[142:143], v[142:143], s[70:71], v[232:233] op_sel_hi:[1,1,0]
    v_pk_fma_f32 v[144:145], v[144:145], s[70:71], v[232:233] op_sel_hi:[1,1,0]
    v_pk_fma_f32 v[146:147], v[146:147], s[70:71], v[232:233] op_sel_hi:[1,1,0]
    v_exp_f32 v128, v128
    v_exp_f32 v129, v129
    v_exp_f32 v130, v130
    v_exp_f32 v131, v131
    v_exp_f32 v132, v132
    v_exp_f32 v133, v133
    v_pk_add_f32 v[234:235], v[128:129], v[130:131]
    v_exp_f32 v134, v134
    v_exp_f32 v135, v135
    v_pk_add_f32 v[234:235], v[234:235], v[132:133]
    v_exp_f32 v136, v136
    v_exp_f32 v137, v137
    v_pk_add_f32 v[234:235], v[234:235], v[134:135]
    v_exp_f32 v138, v138
    v_exp_f32 v139, v139
    v_pk_add_f32 v[234:235], v[234:235], v[136:137]
    v_exp_f32 v140, v140
    v_exp_f32 v141, v141
    v_pk_add_f32 v[234:235], v[234:235], v[138:139]
    v_exp_f32 v142, v142
    v_exp_f32 v143, v143
    v_pk_add_f32 v[234:235], v[234:235], v[140:141]
    v_exp_f32 v144, v144
    v_exp_f32 v145, v145
    v_pk_add_f32 v[234:235], v[234:235], v[142:143]
    v_exp_f32 v146, v146
    v_exp_f32 v147, v147
    v_pk_add_f32 v[234:235], v[234:235], v[144:145]
    v_pk_add_f32 v[234:235], v[234:235], v[146:147]
    v_add_f32_e64 v234, v234, v235
    v_rcp_f32 v234, v234
    s_nop 0
    v_pk_mul_f32 v[128:129], v[128:129], v[234:235] op_sel_hi:[1,0]
    v_pk_mul_f32 v[130:131], v[130:131], v[234:235] op_sel_hi:[1,0]
    v_cvt_pk_bf16_f32 v212, v128, v129
    v_pk_mul_f32 v[132:133], v[132:133], v[234:235] op_sel_hi:[1,0]
    v_cvt_pk_bf16_f32 v213, v130, v131
    v_pk_mul_f32 v[134:135], v[134:135], v[234:235] op_sel_hi:[1,0]
    v_cvt_pk_bf16_f32 v214, v132, v133
    v_pk_mul_f32 v[136:137], v[136:137], v[234:235] op_sel_hi:[1,0]
    v_cvt_pk_bf16_f32 v215, v134, v135
    v_pk_mul_f32 v[138:139], v[138:139], v[234:235] op_sel_hi:[1,0]
    v_cvt_pk_bf16_f32 v216, v136, v137
    v_pk_mul_f32 v[140:141], v[140:141], v[234:235] op_sel_hi:[1,0]
    v_cvt_pk_bf16_f32 v217, v138, v139
    v_pk_mul_f32 v[142:143], v[142:143], v[234:235] op_sel_hi:[1,0]
    v_cvt_pk_bf16_f32 v218, v140, v141
    v_pk_mul_f32 v[144:145], v[144:145], v[234:235] op_sel_hi:[1,0]
    v_cvt_pk_bf16_f32 v219, v142, v143
    v_pk_mul_f32 v[146:147], v[146:147], v[234:235] op_sel_hi:[1,0]
    v_cvt_pk_bf16_f32 v220, v144, v145
    v_cvt_pk_bf16_f32 v221, v146, v147
    v_max3_f32 v232, v160, v161, v162
    v_max3_f32 v233, v163, v164, v165
    v_max3_f32 v232, v232, v166, v167
    v_max3_f32 v233, v233, v168, v169
    v_max3_f32 v232, v232, v170, v171
    v_max3_f32 v233, v233, v172, v173
    v_max3_f32 v232, v232, v174, v175
    v_max3_f32 v233, v233, v176, v177
    v_max3_f32 v232, v232, v178, v179
    v_max_f32_e64 v232, v232, v233
    v_mul_f32 v232, 0xbfb8aa3b, v232
    v_pk_fma_f32 v[160:161], v[160:161], s[70:71], v[232:233] op_sel_hi:[1,1,0]
    v_pk_fma_f32 v[162:163], v[162:163], s[70:71], v[232:233] op_sel_hi:[1,1,0]
    v_pk_fma_f32 v[164:165], v[164:165], s[70:71], v[232:233] op_sel_hi:[1,1,0]
    v_pk_fma_f32 v[166:167], v[166:167], s[70:71], v[232:233] op_sel_hi:[1,1,0]
    v_pk_fma_f32 v[168:169], v[168:169], s[70:71], v[232:233] op_sel_hi:[1,1,0]
    v_pk_fma_f32 v[170:171], v[170:171], s[70:71], v[232:233] op_sel_hi:[1,1,0]
    v_pk_fma_f32 v[172:173], v[172:173], s[70:71], v[232:233] op_sel_hi:[1,1,0]
    v_pk_fma_f32 v[174:175], v[174:175], s[70:71], v[232:233] op_sel_hi:[1,1,0]
    v_pk_fma_f32 v[176:177], v[176:177], s[70:71], v[232:233] op_sel_hi:[1,1,0]
    v_pk_fma_f32 v[178:179], v[178:179], s[70:71], v[232:233] op_sel_hi:[1,1,0]
    v_exp_f32 v160, v160
    v_exp_f32 v161, v161
    v_exp_f32 v162, v162
    v_exp_f32 v163, v163
    v_exp_f32 v164, v164
    v_exp_f32 v165, v165
    v_pk_add_f32 v[234:235], v[160:161], v[162:163]
    v_exp_f32 v166, v166
    v_exp_f32 v167, v167
    v_pk_add_f32 v[234:235], v[234:235], v[164:165]
    v_exp_f32 v168, v168
    v_exp_f32 v169, v169
    v_pk_add_f32 v[234:235], v[234:235], v[166:167]
    v_exp_f32 v170, v170
    v_exp_f32 v171, v171
    v_pk_add_f32 v[234:235], v[234:235], v[168:169]
    v_exp_f32 v172, v172
    v_exp_f32 v173, v173
    v_pk_add_f32 v[234:235], v[234:235], v[170:171]
    v_exp_f32 v174, v174
    v_exp_f32 v175, v175
    v_pk_add_f32 v[234:235], v[234:235], v[172:173]
    v_exp_f32 v176, v176
    v_exp_f32 v177, v177
    v_pk_add_f32 v[234:235], v[234:235], v[174:175]
    v_exp_f32 v178, v178
    v_exp_f32 v179, v179
    v_pk_add_f32 v[234:235], v[234:235], v[176:177]
    v_pk_add_f32 v[234:235], v[234:235], v[178:179]
    v_add_f32_e64 v234, v234, v235
    v_rcp_f32 v234, v234
    s_nop 0
    v_pk_mul_f32 v[160:161], v[160:161], v[234:235] op_sel_hi:[1,0]
    v_pk_mul_f32 v[162:163], v[162:163], v[234:235] op_sel_hi:[1,0]
    v_cvt_pk_bf16_f32 v222, v160, v161
    v_pk_mul_f32 v[164:165], v[164:165], v[234:235] op_sel_hi:[1,0]
    v_cvt_pk_bf16_f32 v223, v162, v163
    v_pk_mul_f32 v[166:167], v[166:167], v[234:235] op_sel_hi:[1,0]
    v_cvt_pk_bf16_f32 v224, v164, v165
    v_pk_mul_f32 v[168:169], v[168:169], v[234:235] op_sel_hi:[1,0]
    v_cvt_pk_bf16_f32 v225, v166, v167
    v_pk_mul_f32 v[170:171], v[170:171], v[234:235] op_sel_hi:[1,0]
    v_cvt_pk_bf16_f32 v226, v168, v169
    v_pk_mul_f32 v[172:173], v[172:173], v[234:235] op_sel_hi:[1,0]
    v_cvt_pk_bf16_f32 v227, v170, v171
    v_pk_mul_f32 v[174:175], v[174:175], v[234:235] op_sel_hi:[1,0]
    v_cvt_pk_bf16_f32 v228, v172, v173
    v_pk_mul_f32 v[176:177], v[176:177], v[234:235] op_sel_hi:[1,0]
    v_cvt_pk_bf16_f32 v229, v174, v175
    v_pk_mul_f32 v[178:179], v[178:179], v[234:235] op_sel_hi:[1,0]
    v_cvt_pk_bf16_f32 v230, v176, v177
    v_cvt_pk_bf16_f32 v231, v178, v179
    s_add_u32 s8, s8, 0x280000
    s_add_u32 s9, s9, 0x480000
    s_lshl_b32 s15, s65, 3
    s_and_b32 s4, s66, 1
    s_add_u32 s15, s15, s4
    s_add_u32 s15, s15, 192
    s_waitcnt vmcnt(0)
    s_barrier
    ds_read_b64 v[52:53], v6
    ds_read_b128 v[44:47], v5
    ds_read_b128 v[48:51], v5 offset:768
    s_waitcnt lgkmcnt(2)
    v_mfma_f32_32x32x8_bf16 v[64:79], v[52:53], v[200:201], 0
    v_mfma_f32_32x32x8_bf16 v[80:95], v[52:53], v[210:211], 0
    v_mfma_f32_32x32x8_bf16 v[96:111], v[52:53], v[220:221], 0
    v_mfma_f32_32x32x8_bf16 v[112:127], v[52:53], v[230:231], 0
    s_waitcnt lgkmcnt(0)
    s_nop 5
    v_mfma_f32_32x32x16_bf16 v[64:79], v[44:47], v[192:195], v[64:79]
    v_mfma_f32_32x32x16_bf16 v[64:79], v[48:51], v[196:199], v[64:79]
    v_mfma_f32_32x32x16_bf16 v[80:95], v[44:47], v[202:205], v[80:95]
    v_mfma_f32_32x32x16_bf16 v[80:95], v[48:51], v[206:209], v[80:95]
    v_mfma_f32_32x32x16_bf16 v[96:111], v[44:47], v[212:215], v[96:111]
    v_mfma_f32_32x32x16_bf16 v[96:111], v[48:51], v[216:219], v[96:111]
    s_nop 7
    v_add_f32 v76, 0x358637bd, v76
    v_rcp_f32 v76, v76
    s_nop 0
    v_pk_mul_f32 v[64:65], v[64:65], v[76:77] op_sel_hi:[1,0]
    v_pk_mul_f32 v[66:67], v[66:67], v[76:77] op_sel_hi:[1,0]
    v_pk_mul_f32 v[68:69], v[68:69], v[76:77] op_sel_hi:[1,0]
    v_pk_mul_f32 v[70:71], v[70:71], v[76:77] op_sel_hi:[1,0]
    v_pk_mul_f32 v[72:73], v[72:73], v[76:77] op_sel_hi:[1,0]
    v_pk_mul_f32 v[74:75], v[74:75], v[76:77] op_sel_hi:[1,0]
    v_cvt_pk_bf16_f32 v20, v64, v65
    v_cvt_pk_bf16_f32 v21, v66, v67
    v_cvt_pk_bf16_f32 v22, v68, v69
    v_cvt_pk_bf16_f32 v23, v70, v71
    v_cvt_pk_bf16_f32 v24, v72, v73
    v_cvt_pk_bf16_f32 v25, v74, v75
    buffer_store_dwordx4 v[20:23], v2, s[44:47], s8 offen offset:0 sc1
    buffer_store_dwordx2 v[24:25], v7, s[44:47], s9 offen offset:0 sc1
    v_mfma_f32_32x32x16_bf16 v[112:127], v[44:47], v[222:225], v[112:127]
    v_mfma_f32_32x32x16_bf16 v[112:127], v[48:51], v[226:229], v[112:127]
    v_add_f32 v92, 0x358637bd, v92
    v_rcp_f32 v92, v92
    s_nop 0
    s_nop 0
    v_pk_mul_f32 v[80:81], v[80:81], v[92:93] op_sel_hi:[1,0]
    v_pk_mul_f32 v[82:83], v[82:83], v[92:93] op_sel_hi:[1,0]
    v_pk_mul_f32 v[84:85], v[84:85], v[92:93] op_sel_hi:[1,0]
    v_pk_mul_f32 v[86:87], v[86:87], v[92:93] op_sel_hi:[1,0]
    v_pk_mul_f32 v[88:89], v[88:89], v[92:93] op_sel_hi:[1,0]
    v_pk_mul_f32 v[90:91], v[90:91], v[92:93] op_sel_hi:[1,0]
    v_cvt_pk_bf16_f32 v26, v80, v81
    v_cvt_pk_bf16_f32 v27, v82, v83
    v_cvt_pk_bf16_f32 v28, v84, v85
    v_cvt_pk_bf16_f32 v29, v86, v87
    v_cvt_pk_bf16_f32 v30, v88, v89
    v_cvt_pk_bf16_f32 v31, v90, v91
    buffer_store_dwordx4 v[26:29], v2, s[44:47], s8 offen offset:1024 sc1
    buffer_store_dwordx2 v[30:31], v7, s[44:47], s9 offen offset:256 sc1
    v_add_f32 v108, 0x358637bd, v108
    v_rcp_f32 v108, v108
    s_nop 0
    v_pk_mul_f32 v[96:97], v[96:97], v[108:109] op_sel_hi:[1,0]
    v_pk_mul_f32 v[98:99], v[98:99], v[108:109] op_sel_hi:[1,0]
    v_pk_mul_f32 v[100:101], v[100:101], v[108:109] op_sel_hi:[1,0]
    v_pk_mul_f32 v[102:103], v[102:103], v[108:109] op_sel_hi:[1,0]
    v_pk_mul_f32 v[104:105], v[104:105], v[108:109] op_sel_hi:[1,0]
    v_pk_mul_f32 v[106:107], v[106:107], v[108:109] op_sel_hi:[1,0]
    v_cvt_pk_bf16_f32 v32, v96, v97
    v_cvt_pk_bf16_f32 v33, v98, v99
    v_cvt_pk_bf16_f32 v34, v100, v101
    v_cvt_pk_bf16_f32 v35, v102, v103
    v_cvt_pk_bf16_f32 v36, v104, v105
    v_cvt_pk_bf16_f32 v37, v106, v107
    buffer_store_dwordx4 v[32:35], v2, s[44:47], s8 offen offset:2048 sc1
    buffer_store_dwordx2 v[36:37], v7, s[44:47], s9 offen offset:512 sc1
    v_add_f32 v124, 0x358637bd, v124
    v_rcp_f32 v124, v124
    s_nop 0
    v_pk_mul_f32 v[112:113], v[112:113], v[124:125] op_sel_hi:[1,0]
    v_pk_mul_f32 v[114:115], v[114:115], v[124:125] op_sel_hi:[1,0]
    v_pk_mul_f32 v[116:117], v[116:117], v[124:125] op_sel_hi:[1,0]
    v_pk_mul_f32 v[118:119], v[118:119], v[124:125] op_sel_hi:[1,0]
    v_pk_mul_f32 v[120:121], v[120:121], v[124:125] op_sel_hi:[1,0]
    v_pk_mul_f32 v[122:123], v[122:123], v[124:125] op_sel_hi:[1,0]
    v_cvt_pk_bf16_f32 v38, v112, v113
    v_cvt_pk_bf16_f32 v39, v114, v115
    v_cvt_pk_bf16_f32 v40, v116, v117
    v_cvt_pk_bf16_f32 v41, v118, v119
    v_cvt_pk_bf16_f32 v42, v120, v121
    v_cvt_pk_bf16_f32 v43, v122, v123
    buffer_store_dwordx4 v[38:41], v2, s[44:47], s8 offen offset:3072 sc1
    buffer_store_dwordx2 v[42:43], v7, s[44:47], s9 offen offset:768 sc1
    s_mov_b32 s52, s36
    s_and_b32 s53, s37, 0xffff
    s_mov_b32 s54, 0x500000
    s_mov_b32 s55, 0x20000
    s_lshl_b32 s64, s42, 2
    s_and_b32 s4, s43, 3
    s_add_u32 s64, s64, s4
    s_lshr_b32 s65, s43, 2
    s_and_b32 s8, s3, 3
    s_lshr_b32 s9, s3, 2
    s_lshl_b32 s4, s64, 2
    s_add_u32 s4, s4, s8
    s_mul_i32 s12, s4, 40960
    s_mul_i32 s6, s65, 160
    s_add_u32 s12, s12, s6
    s_lshr_b32 s10, s4, 1
    s_lshl_b32 s10, s10, 10
    s_and_b32 s6, s4, 1
    s_lshl_b32 s6, s6, 8
    s_add_u32 s10, s10, s6
    s_lshl_b32 s6, s9, 20
    s_add_u32 s10, s10, s6
    s_add_u32 s10, s10, 0x280000
    s_lshl_b32 s11, s4, 7
    s_lshl_b32 s7, s9, 18
    s_add_u32 s11, s11, s7
    s_add_u32 s11, s11, 0x480000
    v_and_b32 v2, 15, v1
    v_lshrrev_b32 v3, 4, v1
    v_lshrrev_b32 v4, 5, v1
    v_and_b32 v5, 1, v3
    v_lshlrev_b32_e64 v6, 4, v2
    v_lshl_add_u32 v6, v5, 9, v6
    v_lshl_add_u32 v6, v4, 16, v6
    v_lshlrev_b32_e64 v7, 3, v2
    v_lshl_add_u32 v7, v3, 14, v7
    v_bfe_u32 v8, v1, 2, 2
    v_and_b32_e64 v9, 3, v1
    s_mul_i32 s7, s9, 51200
    s_add_u32 s7, s7, 61440
    v_lshl_add_u32 v9, v9, 3, s7
    v_mul_u32_u24_e64 v11, 20, v3
    v_add3_u32 v11, v11, v8, 16
    v_mul_u32_u24 v11, 160, v11
    v_add_u32 v11, v11, v9
    s_lshl_b32 s4, s8, 12
    s_add_u32 s4, s4, 41984
    v_lshl_add_u32 v8, v1, 4, s4
    s_mul_i32 s4, s8, 2560
    v_lshl_add_u32 v236, v1, 4, s4
    s_add_u32 s4, s4, 10240
    v_mul_u32_u24 v9, 160, v2
    v_lshl_add_u32 v9, v3, 3, v9
    v_add_u32 v9, s4, v9
    v_add_u32 v10, 0, v1
    v_mul_u32_u24 v13, 6554, v10
    v_lshrrev_b32_e64 v13, 16, v13
    v_mul_u32_u24 v12, 2400, v13
    v_lshl_add_u32 v240, v10, 4, v12
    v_add_u32_e64 v10, 64, v1
    v_mul_u32_u24 v13, 6554, v10
    v_lshrrev_b32_e64 v13, 16, v13
    v_mul_u32_u24 v12, 2400, v13
    v_lshl_add_u32 v241, v10, 4, v12
    v_add_u32 v10, 128, v1
    v_mul_u32_u24 v13, 6554, v10
    v_lshrrev_b32_e64 v13, 16, v13
    v_mul_u32_u24 v12, 2400, v13
    v_lshl_add_u32 v242, v10, 4, v12
    v_cmp_gt_u32_e64 vcc, 32, v1
    v_mov_b32 v10, 0x80000000
    s_nop 0
    v_cndmask_b32 v242, v10, v242, vcc
    s_lshl_b32 s4, s15, 8
    s_add_u32 s4, s4, 0xbc0000
    s_add_u32 s96, s40, s4
    s_addc_u32 s97, s41, 0
    s_mov_b32 s100, 1
    s_waitcnt vmcnt(0)
    s_atomic_add s100, s[96:97], 0
    s_atomic_add s100, s[96:97], 512
    s_atomic_add s100, s[96:97], 1024
    s_atomic_add s100, s[96:97], 1536
    s_branch L_a3pre2
L_b:
    s_mov_b32 s69, 2
    s_waitcnt lgkmcnt(0)
    s_mov_b32 s48, s16
    s_and_b32 s49, s17, 0xffff
    s_mov_b32 s50, 0x280000
    s_mov_b32 s51, 0x20000
    s_mov_b32 s52, s18
    s_and_b32 s53, s19, 0xffff
    s_mov_b32 s54, 0x258000
    s_mov_b32 s55, 0x20000
    s_sub_u32 s5, s3, 0
    s_lshl4_add_u32 s4, s5, s43
    s_add_u32 s4, s4, 32
    s_cmp_lt_u32 s5, 2
    s_cselect_b32 s4, s4, 240
    s_min_u32 s4, s4, 240
    s_mul_i32 s7, s4, 713
    s_lshr_b32 s7, s7, 14
    s_mul_i32 s5, s7, 23
    s_sub_u32 s5, s4, s5
    s_cmp_ge_u32 s5, 8
    s_cbranch_scc1 Lpw23
    s_and_b32 s13, s42, 3
    s_lshl3_add_u32 s5, s13, s5
    s_mul_i32 s5, s5, 81920
    s_lshl_b32 s7, s7, 7
    s_add_u32 s5, s5, s7
    s_cmp_ge_u32 s4, 230
    s_cselect_b32 s5, 0x10000000, s5
    v_mul_u32_u24 v14, 1280, v1
    buffer_load_dword v255, v14, s[48:51], s5 offen
    s_branch Lpn24
Lpw23:
    s_sub_u32 s5, s5, 8
    s_mul_i32 s13, s5, 52
    s_lshr_b32 s13, s13, 8
    s_mul_i32 s15, s13, 5
    s_sub_u32 s5, s5, s15
    s_mul_i32 s7, s7, 192
    s_add_u32 s7, s7, s13
    s_lshr_b32 s13, s42, 2
    s_lshl1_add_u32 s7, s7, s13
    s_mul_i32 s7, s7, 640
    s_lshl_b32 s5, s5, 6
    s_movk_i32 s13, 3200
    v_add_u32_e64 v14, s5, v1
    v_mul_u32_u24 v15, 13108, v14
    v_lshrrev_b32 v15, 16, v15
    v_lshlrev_b32 v14, 7, v14
    v_mad_u32_u24 v14, v15, s13, v14
    buffer_load_dword v255, v14, s[52:55], s7 offen
Lpn24:
    s_bfe_u32 s4, s43, 0x30001
    s_lshl3_add_u32 s12, s42, s4
    s_and_b32 s9, s43, 1
    s_lshr_b32 s8, s3, 2
    s_lshl1_add_u32 s11, s9, s8
    s_and_b32 s4, s3, 3
    s_lshl2_add_u32 s4, s12, s4
    s_mul_i32 s4, s4, 10240
    s_mul_i32 s5, s11, 320
    s_add_u32 s4, s4, s5
    s_sub_u32 s5, s4, 3840
    s_mul_i32 s14, s11, 1280
    s_mul_i32 s10, s3, 7168
    s_movk_i32 s7, 960
    v_and_b32 v2, 15, v1
    v_lshlrev_b32 v3, 6, v2
    v_lshlrev_b32_e64 v4, 4, v2
    v_mul_u32_u24 v6, 3277, v1
    v_lshlrev_b32 v7, 4, v1
    v_add_u32 v5, 0, v6
    v_lshrrev_b32 v5, 16, v5
    v_add_u32 v8, 0, v7
    v_mad_u32_u24 v8, v5, s7, v8
    v_add_u32_e64 v12, s5, v8
    v_add_u32 v5, 209728, v6
    v_lshrrev_b32_e64 v5, 16, v5
    v_add_u32 v9, 1024, v7
    v_mad_u32_u24 v9, v5, s7, v9
    v_add_u32_e64 v13, s5, v9
    v_add_u32 v5, 419456, v6
    v_lshrrev_b32_e64 v5, 16, v5
    v_add_u32 v10, 2048, v7
    v_mad_u32_u24 v10, v5, s7, v10
    v_add_u32_e64 v14, s5, v10
    v_add_u32 v5, 629184, v6
    v_lshrrev_b32_e64 v5, 16, v5
    v_add_u32 v11, 3072, v7
    v_mad_u32_u24 v11, v5, s7, v11
    v_add_u32 v15, s5, v11
    s_waitcnt lgkmcnt(0)
    s_mov_b32 s56, s26
    s_and_b32 s57, s27, 0xffff
    s_mov_b32 s58, 0x280000
    s_mov_b32 s59, 0x20000
    s_add_u32 m0, s10, 0
    s_nop 0
    buffer_load_dwordx4 v12, s[56:59], 0 offen nt lds
    s_add_u32 m0, s10, 1024
    s_nop 0
    buffer_load_dwordx4 v13, s[56:59], 0 offen nt lds
    s_add_u32 m0, s10, 2048
    s_nop 0
    buffer_load_dwordx4 v14, s[56:59], 0 offen nt lds
    s_add_u32 m0, s10, 3072
    s_mov_b64 exec, 0xfffffff
    buffer_load_dwordx4 v15, s[56:59], 0 offen nt lds
    s_mov_b64 exec, -1
    s_mov_b32 s60, s30
    s_nop 0
    s_and_b32 s61, s31, 0xffff
    s_mov_b32 s62, 0x1400
    s_mov_b32 s63, 0x20000
    buffer_load_dwordx4 v[76:79], v3, s[60:63], s14 offen offset:0
    buffer_load_dwordx4 v[80:83], v3, s[60:63], s14 offen offset:16
    buffer_load_dwordx4 v[84:87], v3, s[60:63], s14 offen offset:32
    buffer_load_dwordx4 v[88:91], v3, s[60:63], s14 offen offset:48
    buffer_load_dwordx4 v[92:95], v4, s[60:63], s14 offen offset:1024
    s_mov_b32 s56, s28
    s_and_b32 s57, s29, 0xffff
    s_mov_b32 s58, 0x280000
    s_mov_b32 s59, 0x20000
    s_add_u32 m0, s10, 4096
    s_nop 0
    buffer_load_dwordx4 v8, s[56:59], s4 offen nt lds
    s_add_u32 m0, s10, 5120
    s_nop 0
    buffer_load_dwordx4 v9, s[56:59], s4 offen nt lds
    s_add_u32 m0, s10, 6144
    s_mov_b32 exec_hi, 0
    buffer_load_dwordx4 v10, s[56:59], s4 offen nt lds
    s_mov_b64 exec, -1
    s_barrier
    s_sub_u32 s5, s3, 4
    s_lshl4_add_u32 s4, s5, s43
    s_add_u32 s4, s4, 64
    s_cmp_lt_u32 s5, 4
    s_cselect_b32 s4, s4, 240
    s_min_u32 s4, s4, 240
    s_mul_i32 s7, s4, 713
    s_lshr_b32 s7, s7, 14
    s_mul_i32 s5, s7, 23
    s_sub_u32 s5, s4, s5
    s_cmp_ge_u32 s5, 8
    s_cbranch_scc1 Lpw25
    s_and_b32 s13, s42, 3
    s_lshl3_add_u32 s5, s13, s5
    s_mul_i32 s5, s5, 81920
    s_lshl_b32 s7, s7, 7
    s_add_u32 s5, s5, s7
    s_cmp_ge_u32 s4, 230
    s_cselect_b32 s5, 0x10000000, s5
    v_mul_u32_u24 v14, 1280, v1
    buffer_load_dword v255, v14, s[48:51], s5 offen
    s_branch Lpn26
Lpw25:
    s_sub_u32 s5, s5, 8
    s_mul_i32 s13, s5, 52
    s_lshr_b32 s13, s13, 8
    s_mul_i32 s15, s13, 5
    s_sub_u32 s5, s5, s15
    s_mul_i32 s7, s7, 192
    s_add_u32 s7, s7, s13
    s_lshr_b32 s13, s42, 2
    s_lshl1_add_u32 s7, s7, s13
    s_mul_i32 s7, s7, 640
    s_lshl_b32 s5, s5, 6
    s_movk_i32 s13, 3200
    v_add_u32_e64 v14, s5, v1
    v_mul_u32_u24 v15, 13108, v14
    v_lshrrev_b32 v15, 16, v15
    v_lshlrev_b32 v14, 7, v14
    v_mad_u32_u24 v14, v15, s13, v14
    buffer_load_dword v255, v14, s[52:55], s7 offen
Lpn26:
    s_mov_b32 s44, s40
    s_and_b32 s45, s41, 0xffff
    s_mov_b32 s46, 0xbe0000
    s_mov_b32 s47, 0x20000
    v_lshrrev_b32 v5, 4, v1
    v_mul_u32_u24 v6, 640, v5
    v_add3_u32 v8, v6, v4, s10
    v_lshl_add_u32 v9, v2, 2, v6
    s_add_u32 s4, s10, 256
    v_add_u32_e64 v9, s4, v9
    v_mul_u32_u24 v6, 672, v5
    s_mul_i32 s4, s3, 2688
    s_add_u32 s4, s4, 57344
    v_add3_u32 v10, v6, v4, s4
    v_lshl_add_u32 v11, v2, 2, v6
    s_add_u32 s4, s4, 256
    v_add_u32_e64 v11, s4, v11
    v_mul_u32_u24 v12, 336, v2
    v_lshl_add_u32 v12, v5, 3, v12
    s_lshr_b32 s4, s3, 1
    s_mul_i32 s4, s4, 10432
    s_mul_i32 s5, s3, 160
    s_add_u32 s4, s4, s5
    s_add_u32 s4, s4, 57344
    v_add_u32 v12, s4, v12
    s_add_u32 s5, s12, 8
    s_and_b32 s5, s5, 15
    v_xor_b32 v13, s5, v2
    v_lshlrev_b32_e64 v13, 4, v13
    v_lshl_add_u32 v13, v5, 14, v13
    s_lshl2_add_u32 s14, s9, s3
    s_mul_i32 s14, s14, 5
    s_lshl_b32 s14, s14, 16
    s_lshl_b32 s5, s12, 8
    s_add_u32 s14, s14, s5
    s_add_u32 s14, s14, 0x6c0000
    v_mov_b32 v245, 78848
    v_mov_b32 v246, 0
    ds_write_b32 v245, v246
    s_mov_b32 s6, 0xffff0000
    s_waitcnt vmcnt(9)
    s_nop 0
    ds_read_b128 v[20:23], v8 offset:0
    ds_read_b32 v24, v9 offset:0
    ds_read_b128 v[26:29], v8 offset:320
    ds_read_b32 v30, v9 offset:320
    ds_read_b128 v[32:35], v8 offset:640
    ds_read_b32 v36, v9 offset:640
    ds_read_b128 v[38:41], v8 offset:960
    ds_read_b32 v42, v9 offset:960
    ds_read_b128 v[44:47], v8 offset:1280
    ds_read_b32 v48, v9 offset:1280
    s_waitcnt lgkmcnt(8)
    v_lshlrev_b32 v96, 16, v20
    v_and_b32 v97, s6, v20
    v_lshlrev_b32 v98, 16, v21
    v_and_b32 v99, s6, v21
    v_lshlrev_b32 v100, 16, v22
    v_and_b32 v101, s6, v22
    v_lshlrev_b32 v102, 16, v23
    v_and_b32 v103, s6, v23
    v_lshlrev_b32 v104, 16, v24
    v_and_b32 v105, s6, v24
    s_waitcnt lgkmcnt(6)
    v_lshlrev_b32 v106, 16, v26
    v_and_b32 v107, s6, v26
    v_lshlrev_b32 v108, 16, v27
    v_and_b32 v109, s6, v27
    v_lshlrev_b32 v110, 16, v28
    v_and_b32 v111, s6, v28
    v_lshlrev_b32 v112, 16, v29
    v_and_b32 v113, s6, v29
    v_lshlrev_b32 v114, 16, v30
    v_and_b32 v115, s6, v30
    s_waitcnt lgkmcnt(4)
    v_lshlrev_b32 v116, 16, v32
    v_and_b32 v117, s6, v32
    v_lshlrev_b32 v118, 16, v33
    v_and_b32 v119, s6, v33
    v_lshlrev_b32 v120, 16, v34
    v_and_b32 v121, s6, v34
    v_lshlrev_b32 v122, 16, v35
    v_and_b32 v123, s6, v35
    v_lshlrev_b32 v124, 16, v36
    v_and_b32 v125, s6, v36
    s_waitcnt lgkmcnt(2)
    v_lshlrev_b32 v126, 16, v38
    v_and_b32 v127, s6, v38
    v_lshlrev_b32 v128, 16, v39
    v_and_b32 v129, s6, v39
    v_lshlrev_b32 v130, 16, v40
    v_and_b32 v131, s6, v40
    v_lshlrev_b32 v132, 16, v41
    v_and_b32 v133, s6, v41
    v_lshlrev_b32 v134, 16, v42
    v_and_b32 v135, s6, v42
    s_waitcnt lgkmcnt(0)
    v_lshlrev_b32 v136, 16, v44
    v_and_b32 v137, s6, v44
    v_lshlrev_b32 v138, 16, v45
    v_and_b32 v139, s6, v45
    v_lshlrev_b32 v140, 16, v46
    v_and_b32 v141, s6, v46
    v_lshlrev_b32 v142, 16, v47
    v_and_b32 v143, s6, v47
    v_lshlrev_b32 v144, 16, v48
    v_and_b32 v145, s6, v48
    s_waitcnt vmcnt(4)
    v_lshlrev_b32 v166, 16, v76
    v_lshlrev_b32 v167, 16, v78
    v_and_b32 v168, s6, v76
    v_and_b32 v169, s6, v78
    v_lshlrev_b32 v170, 16, v77
    v_lshlrev_b32 v171, 16, v79
    v_and_b32 v172, s6, v77
    v_and_b32 v173, s6, v79
    v_lshlrev_b32 v174, 16, v80
    v_lshlrev_b32 v175, 16, v82
    v_and_b32 v176, s6, v80
    v_and_b32 v177, s6, v82
    v_lshlrev_b32 v178, 16, v81
    v_lshlrev_b32 v179, 16, v83
    v_and_b32 v180, s6, v81
    v_and_b32 v181, s6, v83
    v_lshlrev_b32 v182, 16, v84
    v_lshlrev_b32 v183, 16, v86
    v_and_b32 v184, s6, v84
    v_and_b32 v185, s6, v86
    v_lshlrev_b32 v186, 16, v85
    v_lshlrev_b32 v187, 16, v87
    v_and_b32 v188, s6, v85
    v_and_b32 v189, s6, v87
    v_lshlrev_b32 v190, 16, v88
    v_lshlrev_b32 v191, 16, v90
    v_and_b32 v192, s6, v88
    v_and_b32 v193, s6, v90
    v_lshlrev_b32 v194, 16, v89
    v_lshlrev_b32 v195, 16, v91
    v_and_b32 v196, s6, v89
    v_and_b32 v197, s6, v91
    v_lshlrev_b32 v198, 16, v92
    v_lshlrev_b32 v199, 16, v94
    v_and_b32 v200, s6, v92
    v_and_b32 v201, s6, v94
    v_lshlrev_b32 v202, 16, v93
    v_lshlrev_b32 v203, 16, v95
    v_and_b32 v204, s6, v93
    v_and_b32 v205, s6, v95
    s_waitcnt vmcnt(1)
    s_nop 0
    ds_read_b128 v[52:55], v8 offset:4096
    ds_read_b32 v56, v9 offset:4096
    ds_read_b128 v[58:61], v8 offset:4416
    ds_read_b32 v62, v9 offset:4416
    v_pk_mul_f32 v[206:207], v[96:97], v[172:173]
    v_pk_mul_f32 v[208:209], v[98:99], v[180:181]
    v_pk_mul_f32 v[210:211], v[100:101], v[188:189]
    v_pk_mul_f32 v[212:213], v[102:103], v[196:197]
    v_pk_mul_f32 v[214:215], v[104:105], v[204:205]
    v_pk_fma_f32 v[206:207], v[106:107], v[170:171], v[206:207]
    v_pk_fma_f32 v[208:209], v[108:109], v[178:179], v[208:209]
    v_pk_fma_f32 v[210:211], v[110:111], v[186:187], v[210:211]
    v_pk_fma_f32 v[212:213], v[112:113], v[194:195], v[212:213]
    v_pk_fma_f32 v[214:215], v[114:115], v[202:203], v[214:215]
    v_pk_fma_f32 v[206:207], v[116:117], v[168:169], v[206:207]
    v_pk_fma_f32 v[208:209], v[118:119], v[176:177], v[208:209]
    v_pk_fma_f32 v[210:211], v[120:121], v[184:185], v[210:211]
    v_pk_fma_f32 v[212:213], v[122:123], v[192:193], v[212:213]
    v_pk_fma_f32 v[214:215], v[124:125], v[200:201], v[214:215]
    v_pk_fma_f32 v[206:207], v[126:127], v[166:167], v[206:207]
    v_pk_fma_f32 v[208:209], v[128:129], v[174:175], v[208:209]
    v_pk_fma_f32 v[210:211], v[130:131], v[182:183], v[210:211]
    v_pk_fma_f32 v[212:213], v[132:133], v[190:191], v[212:213]
    v_pk_fma_f32 v[214:215], v[134:135], v[198:199], v[214:215]
    v_pk_mul_f32 v[216:217], v[106:107], v[172:173]
    v_pk_mul_f32 v[218:219], v[108:109], v[180:181]
    v_pk_mul_f32 v[220:221], v[110:111], v[188:189]
    v_pk_mul_f32 v[222:223], v[112:113], v[196:197]
    v_pk_mul_f32 v[224:225], v[114:115], v[204:205]
    v_pk_fma_f32 v[216:217], v[116:117], v[170:171], v[216:217]
    v_pk_fma_f32 v[218:219], v[118:119], v[178:179], v[218:219]
    v_pk_fma_f32 v[220:221], v[120:121], v[186:187], v[220:221]
    v_pk_fma_f32 v[222:223], v[122:123], v[194:195], v[222:223]
    v_pk_fma_f32 v[224:225], v[124:125], v[202:203], v[224:225]
    v_pk_fma_f32 v[216:217], v[126:127], v[168:169], v[216:217]
    v_pk_fma_f32 v[218:219], v[128:129], v[176:177], v[218:219]
    v_pk_fma_f32 v[220:221], v[130:131], v[184:185], v[220:221]
    v_pk_fma_f32 v[222:223], v[132:133], v[192:193], v[222:223]
    v_pk_fma_f32 v[224:225], v[134:135], v[200:201], v[224:225]
    v_pk_fma_f32 v[216:217], v[136:137], v[166:167], v[216:217]
    v_pk_fma_f32 v[218:219], v[138:139], v[174:175], v[218:219]
    v_pk_fma_f32 v[220:221], v[140:141], v[182:183], v[220:221]
    v_pk_fma_f32 v[222:223], v[142:143], v[190:191], v[222:223]
    v_pk_fma_f32 v[224:225], v[144:145], v[198:199], v[224:225]
    s_waitcnt lgkmcnt(2)
    v_lshlrev_b32 v96, 16, v52
    v_and_b32 v97, s6, v52
    v_lshlrev_b32 v98, 16, v53
    v_and_b32 v99, s6, v53
    v_lshlrev_b32 v100, 16, v54
    v_and_b32 v101, s6, v54
    v_lshlrev_b32 v102, 16, v55
    v_and_b32 v103, s6, v55
    v_lshlrev_b32 v104, 16, v56
    v_and_b32_e64 v105, s6, v56
    v_pk_mul_f32 v[206:207], v[206:207], v[96:97]
    v_pk_mul_f32 v[208:209], v[208:209], v[98:99]
    v_pk_mul_f32 v[210:211], v[210:211], v[100:101]
    v_pk_mul_f32 v[212:213], v[212:213], v[102:103]
    v_pk_mul_f32 v[214:215], v[214:215], v[104:105]
    v_cvt_pk_bf16_f32 v20, v206, v207
    v_cvt_pk_bf16_f32 v21, v208, v209
    v_cvt_pk_bf16_f32 v22, v210, v211
    v_cvt_pk_bf16_f32 v23, v212, v213
    v_cvt_pk_bf16_f32 v24, v214, v215
    ds_write_b128 v10, v[20:23] offset:0
    ds_write_b32 v11, v24 offset:0
    s_waitcnt lgkmcnt(2)
    v_lshlrev_b32 v96, 16, v58
    v_and_b32 v97, s6, v58
    v_lshlrev_b32 v98, 16, v59
    v_and_b32 v99, s6, v59
    v_lshlrev_b32 v100, 16, v60
    v_and_b32 v101, s6, v60
    v_lshlrev_b32 v102, 16, v61
    v_and_b32 v103, s6, v61
    v_lshlrev_b32 v104, 16, v62
    v_and_b32_e64 v105, s6, v62
    v_pk_mul_f32 v[216:217], v[216:217], v[96:97]
    v_pk_mul_f32 v[218:219], v[218:219], v[98:99]
    v_pk_mul_f32 v[220:221], v[220:221], v[100:101]
    v_pk_mul_f32 v[222:223], v[222:223], v[102:103]
    v_pk_mul_f32 v[224:225], v[224:225], v[104:105]
    v_cvt_pk_bf16_f32 v26, v216, v217
    v_cvt_pk_bf16_f32 v27, v218, v219
    v_cvt_pk_bf16_f32 v28, v220, v221
    v_cvt_pk_bf16_f32 v29, v222, v223
    v_cvt_pk_bf16_f32 v30, v224, v225
    ds_write_b128 v10, v[26:29] offset:336
    ds_write_b32 v11, v30 offset:336
    s_waitcnt lgkmcnt(0)
    s_barrier
    s_cmp_gt_u32 s3, 3
    s_cbranch_scc1 L_b1s
    ds_read_b64_tr_b16 v[180:181], v12 offset:0
    ds_read_b64_tr_b16 v[182:183], v12 offset:5376
    ds_read_b64_tr_b16 v[184:185], v12 offset:32
    ds_read_b64_tr_b16 v[186:187], v12 offset:5408
    ds_read_b64_tr_b16 v[188:189], v12 offset:64
    ds_read_b64_tr_b16 v[190:191], v12 offset:5440
    ds_read_b64_tr_b16 v[192:193], v12 offset:96
    ds_read_b64_tr_b16 v[194:195], v12 offset:5472
    ds_read_b64_tr_b16 v[196:197], v12 offset:128
    ds_read_b64_tr_b16 v[198:199], v12 offset:5504
    s_waitcnt lgkmcnt(8)
    buffer_store_dwordx4 v[180:183], v13, s[44:47], s14 offen sc1
    s_add_u32 s14, s14, 0x10000
    s_waitcnt lgkmcnt(6)
    buffer_store_dwordx4 v[184:187], v13, s[44:47], s14 offen sc1
    s_add_u32 s14, s14, 0x10000
    s_waitcnt lgkmcnt(4)
    buffer_store_dwordx4 v[188:191], v13, s[44:47], s14 offen sc1
    s_add_u32 s14, s14, 0x10000
    s_waitcnt lgkmcnt(2)
    buffer_store_dwordx4 v[192:195], v13, s[44:47], s14 offen sc1
    s_add_u32 s14, s14, 0x10000
    s_waitcnt lgkmcnt(0)
    buffer_store_dwordx4 v[196:199], v13, s[44:47], s14 offen sc1
L_b1s:
    s_barrier
    s_sub_u32 s9, s2, 128
    s_lshr_b32 s4, s9, 2
    s_add_u32 s4, s4, 128
    s_and_b32 s5, s9, 3
    s_add_u32 s6, s3, 1
    s_and_b32 s14, s3, 3
    s_cmp_lt_u32 s3, 4
    s_cselect_b32 s9, s4, s9
    s_cselect_b32 s8, s5, s14
    s_cselect_b32 s11, s6, 0
    s_cselect_b32 s10, 0, 18432
    s_lshl2_add_u32 s12, s9, s8
    s_max_u32 s68, s3, 3
    s_mul_i32 s68, s68, 4128
    s_add_u32 s68, s68, 98304
    s_cmp_lt_u32 s3, 4
    s_cbranch_scc1 L_cl
    s_sub_u32 s5, s3, 4
    s_lshl4_add_u32 s4, s5, s43
    s_add_u32 s4, s4, 128
    s_cmp_lt_u32 s5, 4
    s_cselect_b32 s4, s4, 240
    s_min_u32 s4, s4, 240
    s_mul_i32 s7, s4, 713
    s_lshr_b32 s7, s7, 14
    s_mul_i32 s5, s7, 23
    s_sub_u32 s5, s4, s5
    s_cmp_ge_u32 s5, 8
    s_cbranch_scc1 Lpw27
    s_and_b32 s13, s42, 3
    s_lshl3_add_u32 s5, s13, s5
    s_mul_i32 s5, s5, 81920
    s_lshl_b32 s7, s7, 7
    s_add_u32 s5, s5, s7
    s_cmp_ge_u32 s4, 230
    s_cselect_b32 s5, 0x10000000, s5
    v_mul_u32_u24 v14, 1280, v1
    buffer_load_dword v255, v14, s[48:51], s5 offen
    s_branch Lpn28
Lpw27:
    s_sub_u32 s5, s5, 8
    s_mul_i32 s13, s5, 52
    s_lshr_b32 s13, s13, 8
    s_mul_i32 s15, s13, 5
    s_sub_u32 s5, s5, s15
    s_mul_i32 s7, s7, 192
    s_add_u32 s7, s7, s13
    s_lshr_b32 s13, s42, 2
    s_lshl1_add_u32 s7, s7, s13
    s_mul_i32 s7, s7, 640
    s_lshl_b32 s5, s5, 6
    s_movk_i32 s13, 3200
    v_add_u32 v14, s5, v1
    v_mul_u32_u24 v15, 13108, v14
    v_lshrrev_b32 v15, 16, v15
    v_lshlrev_b32 v14, 7, v14
    v_mad_u32_u24 v14, v15, s13, v14
    buffer_load_dword v255, v14, s[52:55], s7 offen
Lpn28:
    s_sub_u32 s5, s3, 4
    s_lshl4_add_u32 s4, s5, s43
    s_add_u32 s4, s4, 192
    s_cmp_lt_u32 s5, 4
    s_cselect_b32 s4, s4, 240
    s_min_u32 s4, s4, 240
    s_mul_i32 s7, s4, 713
    s_lshr_b32 s7, s7, 14
    s_mul_i32 s5, s7, 23
    s_sub_u32 s5, s4, s5
    s_cmp_ge_u32 s5, 8
    s_cbranch_scc1 Lpw29
    s_and_b32 s13, s42, 3
    s_lshl3_add_u32 s5, s13, s5
    s_mul_i32 s5, s5, 81920
    s_lshl_b32 s7, s7, 7
    s_add_u32 s5, s5, s7
    s_cmp_ge_u32 s4, 230
    s_cselect_b32 s5, 0x10000000, s5
    v_mul_u32_u24 v14, 1280, v1
    buffer_load_dword v255, v14, s[48:51], s5 offen
    s_branch Lpn30
Lpw29:
    s_sub_u32 s5, s5, 8
    s_mul_i32 s13, s5, 52
    s_lshr_b32 s13, s13, 8
    s_mul_i32 s15, s13, 5
    s_sub_u32 s5, s5, s15
    s_mul_i32 s7, s7, 192
    s_add_u32 s7, s7, s13
    s_lshr_b32 s13, s42, 2
    s_lshl1_add_u32 s7, s7, s13
    s_mul_i32 s7, s7, 640
    s_lshl_b32 s5, s5, 6
    s_movk_i32 s13, 3200
    v_add_u32 v14, s5, v1
    v_mul_u32_u24 v15, 13108, v14
    v_lshrrev_b32 v15, 16, v15
    v_lshlrev_b32 v14, 7, v14
    v_mad_u32_u24 v14, v15, s13, v14
    buffer_load_dword v255, v14, s[52:55], s7 offen
Lpn30:
    v_lshlrev_b32 v2, 4, v1
    s_mov_b32 s56, s32
    s_and_b32 s57, s33, 0xffff
    s_mov_b32 s58, 0x280000
    s_mov_b32 s59, 0x20000
    s_mov_b32 s60, s34
    s_and_b32 s61, s35, 0xffff
    s_mov_b32 s62, 0x500
    s_mov_b32 s63, 0x20000
    s_lshl_b32 s5, s12, 12
    s_add_u32 m0, s68, 32
    v_mov_b32 v252, 0
    buffer_load_dwordx4 v2, s[56:59], s5 offen offset:0 nt lds
    buffer_load_dwordx4 v2, s[56:59], s5 offen offset:1024 nt lds
    buffer_load_dwordx4 v2, s[56:59], s5 offen offset:2048 nt lds
    buffer_load_dwordx4 v2, s[56:59], s5 offen offset:3072 nt lds
    s_lshl_b32 s7, s12, 1
    buffer_load_ushort v250, v252, s[56:59], s5 offen
    buffer_load_ushort v251, v252, s[60:63], s7 offen
    s_sub_u32 s4, s2, 0xfffffe80
    s_lshl_b32 s5, s4, 12
    s_lshl_b32 s7, s4, 1
    buffer_load_ushort v245, v252, s[56:59], s5 offen
    buffer_load_ushort v246, v252, s[60:63], s7 offen
    s_lshl_b32 s4, s14, 10
    s_add_u32 s5, s5, s4
    s_add_u32 m0, s4, 110720
    s_nop 0
    buffer_load_dwordx4 v2, s[56:59], s5 offen nt lds
    v_lshrrev_b32 v8, 4, v1
    v_and_b32 v9, 15, v1
    v_and_b32_e64 v10, 3, v1
    v_bfe_u32 v11, v1, 2, 2
    v_sub_u32 v10, v10, v11
    v_lshlrev_b32 v11, 3, v8
    v_sub_u32_e64 v10, v10, v11
    s_add_u32 s7, s68, 224
    v_lshl_add_u32 v247, v10, 3, s7
    v_lshl_add_u32 v10, v8, 1, v9
    s_lshl_b32 s4, s11, 2
    s_lshr_b32 s4, 0x4c888, s4
    s_and_b32 s4, s4, 15
    s_xor_b32 s4, s4, s8
    v_add_u32 v11, 1, v10
    v_and_b32_e64 v12, 1, v11
    v_lshl_add_u32 v12, v12, 3, s10
    v_lshrrev_b32 v11, 1, v11
    v_add_u32 v13, 0, v11
    v_and_b32 v208, 15, v13
    v_xor_b32 v208, s4, v208
    v_lshl_add_u32 v208, v208, 4, v12
    v_lshl_add_u32 v208, v13, 8, v208
    v_add_u32 v13, 4, v11
    v_and_b32 v210, 15, v13
    v_xor_b32_e64 v210, s4, v210
    v_lshl_add_u32 v210, v210, 4, v12
    v_lshl_add_u32 v210, v13, 8, v210
    v_add_u32 v13, 8, v11
    v_and_b32 v212, 15, v13
    v_xor_b32_e64 v212, s4, v212
    v_lshl_add_u32 v212, v212, 4, v12
    v_lshl_add_u32 v212, v13, 8, v212
    v_add_u32 v13, 12, v11
    v_and_b32 v214, 15, v13
    v_xor_b32_e64 v214, s4, v214
    v_lshl_add_u32 v214, v214, 4, v12
    v_lshl_add_u32 v214, v13, 8, v214
    v_add_u32 v11, 2, v10
    v_and_b32 v12, 1, v11
    v_lshl_add_u32 v12, v12, 3, s10
    v_lshrrev_b32 v11, 1, v11
    v_add_u32 v13, 0, v11
    v_and_b32 v209, 15, v13
    v_xor_b32 v209, s4, v209
    v_lshl_add_u32 v209, v209, 4, v12
    v_lshl_add_u32 v209, v13, 8, v209
    v_add_u32 v13, 4, v11
    v_and_b32 v211, 15, v13
    v_xor_b32_e64 v211, s4, v211
    v_lshl_add_u32 v211, v211, 4, v12
    v_lshl_add_u32 v211, v13, 8, v211
    v_add_u32 v13, 8, v11
    v_and_b32 v213, 15, v13
    v_xor_b32_e64 v213, s4, v213
    v_lshl_add_u32 v213, v213, 4, v12
    v_lshl_add_u32 v213, v13, 8, v213
    v_add_u32 v13, 12, v11
    v_and_b32 v215, 15, v13
    v_xor_b32_e64 v215, s4, v215
    v_lshl_add_u32 v215, v215, 4, v12
    v_lshl_add_u32 v215, v13, 8, v215
    v_subrev_u32 v8, 16, v1
    v_add_u32 v9, 47, v1
    v_cmp_gt_u32 vcc, 16, v1
    s_nop 1
    v_cndmask_b32 v8, v8, v9, vcc
    v_cmp_eq_u32 vcc, 0, v1
    s_nop 1
    v_cndmask_b32 v8, v8, 63, vcc
    v_lshlrev_b32 v248, 2, v8
    v_lshlrev_b32 v2, 4, v1
    v_mov_b32 v6, 0
    v_mov_b32_e64 v7, 0
    v_pk_mov_b32 v[80:81], v[6:7], v[6:7]
    v_pk_mov_b32 v[86:87], v[6:7], v[6:7]
    v_pk_mov_b32 v[88:89], v[6:7], v[6:7]
    v_pk_mov_b32 v[92:93], v[6:7], v[6:7]
    v_pk_mov_b32 v[98:99], v[6:7], v[6:7]
    v_pk_mov_b32 v[100:101], v[6:7], v[6:7]
    v_pk_mov_b32 v[104:105], v[6:7], v[6:7]
    v_pk_mov_b32 v[110:111], v[6:7], v[6:7]
    v_pk_mov_b32 v[112:113], v[6:7], v[6:7]
    v_pk_mov_b32 v[116:117], v[6:7], v[6:7]
    v_pk_mov_b32 v[122:123], v[6:7], v[6:7]
    v_pk_mov_b32 v[124:125], v[6:7], v[6:7]
    v_pk_mov_b32 v[128:129], v[6:7], v[6:7]
    v_pk_mov_b32 v[134:135], v[6:7], v[6:7]
    v_pk_mov_b32 v[136:137], v[6:7], v[6:7]
    v_pk_mov_b32 v[140:141], v[6:7], v[6:7]
    v_pk_mov_b32 v[146:147], v[6:7], v[6:7]
    v_pk_mov_b32 v[148:149], v[6:7], v[6:7]
    v_pk_mov_b32 v[152:153], v[6:7], v[6:7]
    v_pk_mov_b32 v[158:159], v[6:7], v[6:7]
    v_pk_mov_b32 v[160:161], v[6:7], v[6:7]
    v_pk_mov_b32 v[164:165], v[6:7], v[6:7]
    v_pk_mov_b32 v[170:171], v[6:7], v[6:7]
    v_pk_mov_b32 v[172:173], v[6:7], v[6:7]
    s_mov_b32 s52, s24
    s_and_b32 s53, s25, 0xffff
    s_mov_b32 s54, 0x280000
    s_mov_b32 s55, 0x20000
    s_bfe_u32 s4, s2, 0x20003
    s_lshl_b32 s4, s4, 9
    s_bfe_u32 s5, s2, 0x20001
    s_lshl_b32 s5, s5, 2
    s_add_u32 s4, s4, s5
    s_and_b32 s5, s2, 1
    s_lshl_b32 s5, s5, 7
    s_add_u32 s4, s4, s5
    v_mov_b32 v14, 0x80000000
    v_add_u32 v8, 0, v0
    v_mul_u32_u24 v9, 3277, v8
    v_lshrrev_b32 v9, 16, v9
    v_mul_u32_u24 v10, 20, v9
    v_sub_u32 v10, v8, v10
    v_and_b32 v11, 3, v9
    v_bfe_u32 v12, v9, 2, 1
    v_lshl_add_u32 v11, v12, 8, v11
    v_lshrrev_b32_e64 v12, 3, v9
    v_lshl_add_u32 v11, v12, 4, v11
    v_add_u32_e64 v11, s4, v11
    v_mul_u32_u24 v11, 1280, v11
    v_lshl_add_u32 v234, v10, 4, v11
    v_add_u32 v228, v234, v11
    v_add_u32 v8, v8, v9
    v_lshlrev_b32_e64 v8, 4, v8
    v_add_u32 v231, 20480, v8
    v_add_u32 v8, 512, v0
    v_mul_u32_u24 v9, 3277, v8
    v_lshrrev_b32 v9, 16, v9
    v_mul_u32_u24 v10, 20, v9
    v_sub_u32 v10, v8, v10
    v_and_b32 v11, 3, v9
    v_bfe_u32 v12, v9, 2, 1
    v_lshl_add_u32 v11, v12, 8, v11
    v_lshrrev_b32_e64 v12, 3, v9
    v_lshl_add_u32 v11, v12, 4, v11
    v_add_u32_e64 v11, s4, v11
    v_mul_u32_u24 v11, 1280, v11
    v_lshl_add_u32 v235, v10, 4, v11
    v_add_u32 v229, v235, v11
    v_add_u32 v8, v8, v9
    v_lshlrev_b32_e64 v8, 4, v8
    v_add_u32 v232, 20480, v8
    v_add_u32 v8, 1024, v0
    v_mul_u32_u24 v9, 3277, v8
    v_lshrrev_b32 v9, 16, v9
    v_mul_u32_u24 v10, 20, v9
    v_sub_u32 v10, v8, v10
    v_and_b32 v11, 3, v9
    v_bfe_u32 v12, v9, 2, 1
    v_lshl_add_u32 v11, v12, 8, v11
    v_lshrrev_b32_e64 v12, 3, v9
    v_lshl_add_u32 v11, v12, 4, v11
    v_add_u32_e64 v11, s4, v11
    v_mul_u32_u24 v11, 1280, v11
    v_lshl_add_u32 v236, v10, 4, v11
    v_cmp_gt_u32 vcc, 256, v0
    s_nop 1
    v_cndmask_b32 v236, v14, v236, vcc
    v_add_u32 v230, v236, v11
    v_add_u32 v8, v8, v9
    v_lshlrev_b32_e64 v8, 4, v8
    v_add_u32 v233, 20480, v8
    v_mov_b32 v8, 0
    v_mov_b32 v9, 0
    s_lshl_b32 s7, s14, 9
    s_add_u32 s7, s7, s10
    v_lshl_add_u32 v10, v1, 3, s7
    ds_write_b64 v10, v[8:9]
    s_waitcnt vmcnt(0)
    v_mov_b32 v8, 0
    v_mov_b32 v9, 0
    v_and_b32 v10, 3, v1
    v_lshl_add_u32 v10, v10, 3, s68
    ds_write_b64 v10, v[8:9]
    v_lshlrev_b32 v250, 16, v250
    v_lshlrev_b32 v251, 16, v251
    v_add_f32_e64 v250, v250, v251
    v_cvt_pk_bf16_f32 v250, v250, v250
    v_mov_b32_e64 v11, s68
    ds_write_b16 v11, v250 offset:32
    s_cmp_lg_u32 s3, 4
    s_cbranch_scc1 L_cj
    s_mov_b32 s68, 110688
    v_mov_b32 v8, 0
    v_mov_b32 v9, 0
    v_and_b32_e64 v10, 3, v1
    v_lshl_add_u32 v10, v10, 3, s68
    ds_write_b64 v10, v[8:9]
    v_lshlrev_b32 v245, 16, v245
    v_lshlrev_b32 v246, 16, v246
    v_add_f32_e64 v245, v245, v246
    v_cvt_pk_bf16_f32 v245, v245, v245
    v_mov_b32_e64 v11, s68
    ds_write_b16 v11, v245 offset:32
    s_branch L_cj
L_cl:
    s_load_dword s98, s[38:39], 0
    v_lshrrev_b32 v8, 4, v1
    v_and_b32 v9, 15, v1
    v_and_b32 v10, 3, v1
    v_bfe_u32 v11, v1, 2, 2
    v_sub_u32 v10, v10, v11
    v_lshlrev_b32 v11, 3, v8
    v_sub_u32_e64 v10, v10, v11
    s_add_u32 s7, s68, 224
    v_lshl_add_u32 v247, v10, 3, s7
    v_lshl_add_u32 v10, v8, 1, v9
    s_lshl_b32 s4, s11, 2
    s_lshr_b32 s4, 0x4c888, s4
    s_and_b32 s4, s4, 15
    s_xor_b32 s4, s4, s8
    v_add_u32 v11, 1, v10
    v_and_b32_e64 v12, 1, v11
    v_lshl_add_u32 v12, v12, 3, s10
    v_lshrrev_b32 v11, 1, v11
    v_add_u32 v13, 0, v11
    v_and_b32 v208, 15, v13
    v_xor_b32 v208, s4, v208
    v_lshl_add_u32 v208, v208, 4, v12
    v_lshl_add_u32 v208, v13, 8, v208
    v_add_u32 v13, 4, v11
    v_and_b32 v210, 15, v13
    v_xor_b32_e64 v210, s4, v210
    v_lshl_add_u32 v210, v210, 4, v12
    v_lshl_add_u32 v210, v13, 8, v210
    v_add_u32 v13, 8, v11
    v_and_b32 v212, 15, v13
    v_xor_b32_e64 v212, s4, v212
    v_lshl_add_u32 v212, v212, 4, v12
    v_lshl_add_u32 v212, v13, 8, v212
    v_add_u32 v13, 12, v11
    v_and_b32 v214, 15, v13
    v_xor_b32_e64 v214, s4, v214
    v_lshl_add_u32 v214, v214, 4, v12
    v_lshl_add_u32 v214, v13, 8, v214
    v_add_u32 v11, 2, v10
    v_and_b32 v12, 1, v11
    v_lshl_add_u32 v12, v12, 3, s10
    v_lshrrev_b32 v11, 1, v11
    v_add_u32 v13, 0, v11
    v_and_b32 v209, 15, v13
    v_xor_b32 v209, s4, v209
    v_lshl_add_u32 v209, v209, 4, v12
    v_lshl_add_u32 v209, v13, 8, v209
    v_add_u32 v13, 4, v11
    v_and_b32 v211, 15, v13
    v_xor_b32_e64 v211, s4, v211
    v_lshl_add_u32 v211, v211, 4, v12
    v_lshl_add_u32 v211, v13, 8, v211
    v_add_u32 v13, 8, v11
    v_and_b32 v213, 15, v13
    v_xor_b32_e64 v213, s4, v213
    v_lshl_add_u32 v213, v213, 4, v12
    v_lshl_add_u32 v213, v13, 8, v213
    v_add_u32 v13, 12, v11
    v_and_b32 v215, 15, v13
    v_xor_b32_e64 v215, s4, v215
    v_lshl_add_u32 v215, v215, 4, v12
    v_lshl_add_u32 v215, v13, 8, v215
    v_subrev_u32 v8, 16, v1
    v_add_u32 v9, 47, v1
    v_cmp_gt_u32 vcc, 16, v1
    s_nop 1
    v_cndmask_b32 v8, v8, v9, vcc
    v_cmp_eq_u32 vcc, 0, v1
    s_nop 1
    v_cndmask_b32 v8, v8, 63, vcc
    v_lshlrev_b32 v248, 2, v8
    v_lshlrev_b32 v2, 4, v1
    v_mov_b32 v6, 0
    v_mov_b32_e64 v7, 0
    v_pk_mov_b32 v[80:81], v[6:7], v[6:7]
    v_pk_mov_b32 v[86:87], v[6:7], v[6:7]
    v_pk_mov_b32 v[88:89], v[6:7], v[6:7]
    v_pk_mov_b32 v[92:93], v[6:7], v[6:7]
    v_pk_mov_b32 v[98:99], v[6:7], v[6:7]
    v_pk_mov_b32 v[100:101], v[6:7], v[6:7]
    v_pk_mov_b32 v[104:105], v[6:7], v[6:7]
    v_pk_mov_b32 v[110:111], v[6:7], v[6:7]
    v_pk_mov_b32 v[112:113], v[6:7], v[6:7]
    v_pk_mov_b32 v[116:117], v[6:7], v[6:7]
    v_pk_mov_b32 v[122:123], v[6:7], v[6:7]
    v_pk_mov_b32 v[124:125], v[6:7], v[6:7]
    v_pk_mov_b32 v[128:129], v[6:7], v[6:7]
    v_pk_mov_b32 v[134:135], v[6:7], v[6:7]
    v_pk_mov_b32 v[136:137], v[6:7], v[6:7]
    v_pk_mov_b32 v[140:141], v[6:7], v[6:7]
    v_pk_mov_b32 v[146:147], v[6:7], v[6:7]
    v_pk_mov_b32 v[148:149], v[6:7], v[6:7]
    v_pk_mov_b32 v[152:153], v[6:7], v[6:7]
    v_pk_mov_b32 v[158:159], v[6:7], v[6:7]
    v_pk_mov_b32 v[160:161], v[6:7], v[6:7]
    v_pk_mov_b32 v[164:165], v[6:7], v[6:7]
    v_pk_mov_b32 v[170:171], v[6:7], v[6:7]
    v_pk_mov_b32 v[172:173], v[6:7], v[6:7]
    v_mov_b32 v246, 1
    s_waitcnt vmcnt(0)
    s_mov_b64 exec, 1
    ds_add_rtn_u32 v246, v245, v246
    s_waitcnt lgkmcnt(0)
    v_readfirstlane_b32 s66, v246
    s_mov_b64 exec, -1
    s_cmp_lg_u32 s66, 3
    s_cbranch_scc1 L_cn
    s_mov_b32 s101, 0
    v_mov_b32 v4, 0
Lp31:
    s_cmp_eq_u32 s98, 0xff
    s_cbranch_scc1 Lx32
    global_load_dword v5, v4, s[38:39] offset:0 sc1
    s_add_u32 s101, s101, 1
    s_waitcnt vmcnt(0)
    v_readfirstlane_b32 s98, v5
    s_cmp_lt_u32 s101, 400000
    s_cbranch_scc1 Lp31
Lx32:
    s_and_b32 s15, s43, 3
    s_lshl_b32 s4, s15, 8
    s_add_u32 s4, s4, 0xbc0000
    s_add_u32 s96, s40, s4
    s_addc_u32 s97, s41, 0
    s_mov_b32 s100, 1
    s_atomic_add s100, s[96:97], 0
    s_atomic_add s100, s[96:97], 1024
    s_atomic_add s100, s[96:97], 2048
    s_atomic_add s100, s[96:97], 3072
    s_atomic_add s100, s[96:97], 4096
    s_atomic_add s100, s[96:97], 5120
    s_atomic_add s100, s[96:97], 6144
    s_atomic_add s100, s[96:97], 7168
    s_atomic_add s100, s[96:97], 8192
    s_atomic_add s100, s[96:97], 9216
    s_atomic_add s100, s[96:97], 10240
    s_atomic_add s100, s[96:97], 11264
    s_atomic_add s100, s[96:97], 12288
    s_atomic_add s100, s[96:97], 13312
    s_atomic_add s100, s[96:97], 14336
    s_atomic_add s100, s[96:97], 15360
L_cn:
    s_mov_b32 s52, s24
    s_and_b32 s53, s25, 0xffff
    s_mov_b32 s54, 0x280000
    s_mov_b32 s55, 0x20000
    s_bfe_u32 s4, s2, 0x20003
    s_lshl_b32 s4, s4, 9
    s_bfe_u32 s5, s2, 0x20001
    s_lshl_b32 s5, s5, 2
    s_add_u32 s4, s4, s5
    s_and_b32 s5, s2, 1
    s_lshl_b32 s5, s5, 7
    s_add_u32 s4, s4, s5
    v_mov_b32 v14, 0x80000000
    v_add_u32 v8, 0, v0
    v_mul_u32_u24 v9, 3277, v8
    v_lshrrev_b32 v9, 16, v9
    v_mul_u32_u24 v10, 20, v9
    v_sub_u32 v10, v8, v10
    v_and_b32 v11, 3, v9
    v_bfe_u32 v12, v9, 2, 1
    v_lshl_add_u32 v11, v12, 8, v11
    v_lshrrev_b32_e64 v12, 3, v9
    v_lshl_add_u32 v11, v12, 4, v11
    v_add_u32_e64 v11, s4, v11
    v_mul_u32_u24 v11, 1280, v11
    v_lshl_add_u32 v234, v10, 4, v11
    v_add_u32 v228, v234, v11
    v_add_u32 v8, v8, v9
    v_lshlrev_b32_e64 v8, 4, v8
    v_add_u32 v231, 20480, v8
    v_add_u32 v8, 512, v0
    v_mul_u32_u24 v9, 3277, v8
    v_lshrrev_b32 v9, 16, v9
    v_mul_u32_u24 v10, 20, v9
    v_sub_u32 v10, v8, v10
    v_and_b32 v11, 3, v9
    v_bfe_u32 v12, v9, 2, 1
    v_lshl_add_u32 v11, v12, 8, v11
    v_lshrrev_b32_e64 v12, 3, v9
    v_lshl_add_u32 v11, v12, 4, v11
    v_add_u32_e64 v11, s4, v11
    v_mul_u32_u24 v11, 1280, v11
    v_lshl_add_u32 v235, v10, 4, v11
    v_add_u32 v229, v235, v11
    v_add_u32 v8, v8, v9
    v_lshlrev_b32_e64 v8, 4, v8
    v_add_u32 v232, 20480, v8
    v_add_u32 v8, 1024, v0
    v_mul_u32_u24 v9, 3277, v8
    v_lshrrev_b32 v9, 16, v9
    v_mul_u32_u24 v10, 20, v9
    v_sub_u32 v10, v8, v10
    v_and_b32 v11, 3, v9
    v_bfe_u32 v12, v9, 2, 1
    v_lshl_add_u32 v11, v12, 8, v11
    v_lshrrev_b32_e64 v12, 3, v9
    v_lshl_add_u32 v11, v12, 4, v11
    v_add_u32_e64 v11, s4, v11
    v_mul_u32_u24 v11, 1280, v11
    v_lshl_add_u32 v236, v10, 4, v11
    v_cmp_gt_u32 vcc, 256, v0
    s_nop 1
    v_cndmask_b32 v236, v14, v236, vcc
    v_add_u32 v230, v236, v11
    v_add_u32 v8, v8, v9
    v_lshlrev_b32_e64 v8, 4, v8
    v_add_u32 v233, 20480, v8
    v_mov_b32 v8, 0
    v_mov_b32 v9, 0
    s_lshl_b32 s7, s14, 9
    s_add_u32 s7, s7, s10
    v_lshl_add_u32 v10, v1, 3, s7
    ds_write_b64 v10, v[8:9]
    s_cmp_lg_u32 s66, 3
    s_cbranch_scc1 L_cj
    s_and_b32 s15, s2, 15
    s_lshl_b32 s15, s15, 2
    s_waitcnt lgkmcnt(0)
    s_lshl_b32 s4, s15, 8
    s_add_u32 s4, s4, 0xbc0000
    s_add_u32 s96, s40, s4
    s_addc_u32 s97, s41, 0
    s_mov_b32 s101, 0
Lp33:
    s_mov_b32 s92, 0
    s_mov_b32 s93, 0
    s_mov_b32 s94, 0
    s_mov_b32 s95, 0
    s_atomic_add s92, s[96:97], 0 glc
    s_atomic_add s93, s[96:97], 256 glc
    s_atomic_add s94, s[96:97], 512 glc
    s_atomic_add s95, s[96:97], 768 glc
    s_add_u32 s101, s101, 1
    s_waitcnt lgkmcnt(0)
    s_add_u32 s92, s92, s93
    s_add_u32 s92, s92, s94
    s_add_u32 s92, s92, s95
    s_cmp_eq_u32 s92, 128
    s_cbranch_scc1 Lx34
    s_sleep 1
    s_cmp_lt_u32 s101, 400000
    s_cbranch_scc1 Lp33
Lx34:
L_cj:
    s_waitcnt lgkmcnt(0)
    s_barrier
    s_lshl_b32 s4, s14, 12
    s_lshl_b32 s5, s9, 14
    s_add_u32 s5, s5, s4
    s_add_u32 s5, s5, 0x6c0000
    s_add_u32 s4, s4, s10
    s_add_u32 m0, s4, 2048
    s_nop 0
    buffer_load_dwordx4 v2, s[44:47], s5 offen offset:0 sc1 lds
    buffer_load_dwordx4 v2, s[44:47], s5 offen offset:1024 sc1 lds
    buffer_load_dwordx4 v2, s[44:47], s5 offen offset:2048 sc1 lds
    buffer_load_dwordx4 v2, s[44:47], s5 offen offset:3072 sc1 lds
    ds_read_b64_tr_b16 v[20:21], v247 offset:288
    ds_read_b64_tr_b16 v[22:23], v247 offset:256
    ds_read_b64_tr_b16 v[28:29], v247 offset:800
    ds_read_b64_tr_b16 v[30:31], v247 offset:768
    ds_read_b64_tr_b16 v[36:37], v247 offset:1312
    ds_read_b64_tr_b16 v[38:39], v247 offset:1280
    ds_read_b64_tr_b16 v[44:45], v247 offset:1824
    ds_read_b64_tr_b16 v[46:47], v247 offset:1792
    ds_read_b64_tr_b16 v[52:53], v247 offset:2336
    ds_read_b64_tr_b16 v[54:55], v247 offset:2304
    ds_read_b64_tr_b16 v[60:61], v247 offset:2848
    ds_read_b64_tr_b16 v[62:63], v247 offset:2816
    ds_read_b64_tr_b16 v[68:69], v247 offset:3360
    ds_read_b64_tr_b16 v[70:71], v247 offset:3328
    ds_read_b64_tr_b16 v[76:77], v247 offset:3872
    ds_read_b64_tr_b16 v[78:79], v247 offset:3840
    ds_read_b64_tr_b16 v[16:17], v247 offset:32
    ds_read_b64_tr_b16 v[18:19], v247 offset:0
    ds_read_b64_tr_b16 v[24:25], v247 offset:544
    ds_read_b64_tr_b16 v[26:27], v247 offset:512
    ds_read_b64_tr_b16 v[32:33], v247 offset:1056
    ds_read_b64_tr_b16 v[34:35], v247 offset:1024
    ds_read_b64_tr_b16 v[40:41], v247 offset:1568
    ds_read_b64_tr_b16 v[42:43], v247 offset:1536
    ds_read_b64_tr_b16 v[48:49], v247 offset:2080
    ds_read_b64_tr_b16 v[50:51], v247 offset:2048
    ds_read_b64_tr_b16 v[56:57], v247 offset:2592
    ds_read_b64_tr_b16 v[58:59], v247 offset:2560
    ds_read_b64_tr_b16 v[64:65], v247 offset:3104
    ds_read_b64_tr_b16 v[66:67], v247 offset:3072
    ds_read_b64_tr_b16 v[72:73], v247 offset:3616
    ds_read_b64_tr_b16 v[74:75], v247 offset:3584
    s_waitcnt vmcnt(0) lgkmcnt(0)
    s_barrier
L_conv:
    s_lshl_b32 s66, s12, 12
    s_add_u32 s66, s66, 0x940000
    v_cmp_eq_u32 vcc, 63, v1
    s_cmp_eq_u32 s11, 2
    s_cbranch_scc1 L_in2
    s_cmp_eq_u32 s11, 3
    s_cbranch_scc1 L_in3
    s_cmp_eq_u32 s11, 4
    s_cbranch_scc1 L_in4
    ds_read_b64 v[176:177], v208 offset:0
    ds_read_b64 v[178:179], v209 offset:0
    ds_read_b64 v[180:181], v214 offset:12288
    ds_read_b64 v[182:183], v215 offset:12288
    ds_read_b64 v[184:185], v210 offset:0
    ds_read_b64 v[186:187], v211 offset:0
    ds_read_b64 v[188:189], v212 offset:12288
    ds_read_b64 v[190:191], v213 offset:12288
    s_waitcnt lgkmcnt(6)
    v_mfma_f32_16x16x32_bf16 v[82:85], v[20:23], v[176:179], 0
    ds_read_b64 v[192:193], v212 offset:0
    v_mfma_f32_16x16x32_bf16 v[94:97], v[28:31], v[176:179], 0
    ds_read_b64 v[194:195], v213 offset:0
    v_mfma_f32_16x16x32_bf16 v[106:109], v[36:39], v[176:179], 0
    ds_read_b64 v[196:197], v210 offset:12288
    v_mfma_f32_16x16x32_bf16 v[118:121], v[44:47], v[176:179], 0
    ds_read_b64 v[198:199], v211 offset:12288
    v_mfma_f32_16x16x32_bf16 v[130:133], v[52:55], v[176:179], 0
    ds_read_b64 v[200:201], v214 offset:0
    v_mfma_f32_16x16x32_bf16 v[142:145], v[60:63], v[176:179], 0
    ds_read_b64 v[202:203], v215 offset:0
    v_mfma_f32_16x16x32_bf16 v[154:157], v[68:71], v[176:179], 0
    v_mfma_f32_16x16x32_bf16 v[166:169], v[76:79], v[176:179], 0
    s_bfe_u32 s6, s2, 0x20005
    s_mul_i32 s6, s6, 320
    buffer_load_dwordx4 v[216:219], v234, s[52:55], s6 offen nt
    buffer_load_dwordx4 v[220:223], v235, s[52:55], s6 offen nt
    buffer_load_dwordx4 v[224:227], v236, s[52:55], s6 offen nt
    s_waitcnt lgkmcnt(10)
    v_mfma_f32_16x16x32_bf16 v[166:169], v[16:19], v[180:183], v[166:169]
    s_waitcnt lgkmcnt(8)
    v_mfma_f32_16x16x32_bf16 v[82:85], v[16:19], v[184:187], v[82:85]
    ds_read_b64 v[204:205], v208 offset:12288
    v_mfma_f32_16x16x32_bf16 v[94:97], v[24:27], v[184:187], v[94:97]
    ds_read_b64 v[206:207], v209 offset:12288
    v_mfma_f32_16x16x32_bf16 v[106:109], v[32:35], v[184:187], v[106:109]
    ds_read_b64 v[176:177], v208 offset:4096
    v_mfma_f32_16x16x32_bf16 v[118:121], v[40:43], v[184:187], v[118:121]
    ds_read_b64 v[178:179], v209 offset:4096
    v_mfma_f32_16x16x32_bf16 v[130:133], v[48:51], v[184:187], v[130:133]
    v_mfma_f32_16x16x32_bf16 v[142:145], v[56:59], v[184:187], v[142:145]
    v_mfma_f32_16x16x32_bf16 v[154:157], v[64:67], v[184:187], v[154:157]
    v_mfma_f32_16x16x32_bf16 v[166:169], v[72:75], v[184:187], v[166:169]
    s_waitcnt lgkmcnt(10)
    v_mfma_f32_16x16x32_bf16 v[166:169], v[20:23], v[188:191], v[166:169]
    s_waitcnt lgkmcnt(8)
    v_mfma_f32_16x16x32_bf16 v[94:97], v[20:23], v[192:195], v[94:97]
    ds_read_b64 v[180:181], v214 offset:8192
    v_mfma_f32_16x16x32_bf16 v[106:109], v[28:31], v[192:195], v[106:109]
    ds_read_b64 v[182:183], v215 offset:8192
    v_mfma_f32_16x16x32_bf16 v[118:121], v[36:39], v[192:195], v[118:121]
    ds_read_b64 v[184:185], v210 offset:4096
    v_mfma_f32_16x16x32_bf16 v[130:133], v[44:47], v[192:195], v[130:133]
    ds_read_b64 v[186:187], v211 offset:4096
    v_mfma_f32_16x16x32_bf16 v[142:145], v[52:55], v[192:195], v[142:145]
    v_mfma_f32_16x16x32_bf16 v[154:157], v[60:63], v[192:195], v[154:157]
    v_mfma_f32_16x16x32_bf16 v[166:169], v[68:71], v[192:195], v[166:169]
    s_waitcnt lgkmcnt(10)
    v_mfma_f32_16x16x32_bf16 v[154:157], v[16:19], v[196:199], v[154:157]
    ds_read_b64 v[188:189], v212 offset:8192
    v_mfma_f32_16x16x32_bf16 v[166:169], v[24:27], v[196:199], v[166:169]
    s_waitcnt lgkmcnt(9)
    v_mfma_f32_16x16x32_bf16 v[94:97], v[16:19], v[200:203], v[94:97]
    ds_read_b64 v[190:191], v213 offset:8192
    v_mfma_f32_16x16x32_bf16 v[106:109], v[24:27], v[200:203], v[106:109]
    ds_read_b64 v[192:193], v212 offset:4096
    v_mfma_f32_16x16x32_bf16 v[118:121], v[32:35], v[200:203], v[118:121]
    ds_read_b64 v[194:195], v213 offset:4096
    v_mfma_f32_16x16x32_bf16 v[130:133], v[40:43], v[200:203], v[130:133]
    v_mfma_f32_16x16x32_bf16 v[142:145], v[48:51], v[200:203], v[142:145]
    v_mfma_f32_16x16x32_bf16 v[154:157], v[56:59], v[200:203], v[154:157]
    v_mfma_f32_16x16x32_bf16 v[166:169], v[64:67], v[200:203], v[166:169]
    s_waitcnt lgkmcnt(10)
    v_mfma_f32_16x16x32_bf16 v[154:157], v[20:23], v[204:207], v[154:157]
    ds_read_b64 v[196:197], v210 offset:8192
    v_mfma_f32_16x16x32_bf16 v[166:169], v[28:31], v[204:207], v[166:169]
    s_waitcnt lgkmcnt(9)
    v_mfma_f32_16x16x32_bf16 v[106:109], v[20:23], v[176:179], v[106:109]
    ds_read_b64 v[198:199], v211 offset:8192
    v_mfma_f32_16x16x32_bf16 v[118:121], v[28:31], v[176:179], v[118:121]
    ds_read_b64 v[200:201], v214 offset:4096
    v_mfma_f32_16x16x32_bf16 v[130:133], v[36:39], v[176:179], v[130:133]
    ds_read_b64 v[202:203], v215 offset:4096
    v_mfma_f32_16x16x32_bf16 v[142:145], v[44:47], v[176:179], v[142:145]
    v_mfma_f32_16x16x32_bf16 v[154:157], v[52:55], v[176:179], v[154:157]
    v_mfma_f32_16x16x32_bf16 v[166:169], v[60:63], v[176:179], v[166:169]
    s_waitcnt lgkmcnt(10)
    v_mfma_f32_16x16x32_bf16 v[142:145], v[16:19], v[180:183], v[142:145]
    ds_read_b64 v[204:205], v208 offset:8192
    v_mfma_f32_16x16x32_bf16 v[154:157], v[24:27], v[180:183], v[154:157]
    ds_read_b64 v[206:207], v209 offset:8192
    v_mfma_f32_16x16x32_bf16 v[166:169], v[32:35], v[180:183], v[166:169]
    s_waitcnt lgkmcnt(10)
    v_mfma_f32_16x16x32_bf16 v[106:109], v[16:19], v[184:187], v[106:109]
    v_xor_b32 v208, 64, v208
    v_mfma_f32_16x16x32_bf16 v[118:121], v[24:27], v[184:187], v[118:121]
    ds_read_b64 v[176:177], v208 offset:0
    v_mfma_f32_16x16x32_bf16 v[130:133], v[32:35], v[184:187], v[130:133]
    v_xor_b32_e64 v209, 64, v209
    v_mfma_f32_16x16x32_bf16 v[142:145], v[40:43], v[184:187], v[142:145]
    ds_read_b64 v[178:179], v209 offset:0
    v_mfma_f32_16x16x32_bf16 v[154:157], v[48:51], v[184:187], v[154:157]
    v_mfma_f32_16x16x32_bf16 v[166:169], v[56:59], v[184:187], v[166:169]
    s_waitcnt lgkmcnt(10)
    v_mfma_f32_16x16x32_bf16 v[142:145], v[20:23], v[188:191], v[142:145]
    v_xor_b32 v214, 64, v214
    v_mfma_f32_16x16x32_bf16 v[154:157], v[28:31], v[188:191], v[154:157]
    ds_read_b64 v[180:181], v214 offset:12288
    v_mfma_f32_16x16x32_bf16 v[166:169], v[36:39], v[188:191], v[166:169]
    s_waitcnt lgkmcnt(9)
    v_mfma_f32_16x16x32_bf16 v[118:121], v[20:23], v[192:195], v[118:121]
    v_xor_b32 v215, 64, v215
    v_mfma_f32_16x16x32_bf16 v[130:133], v[28:31], v[192:195], v[130:133]
    ds_read_b64 v[182:183], v215 offset:12288
    v_mfma_f32_16x16x32_bf16 v[142:145], v[36:39], v[192:195], v[142:145]
    v_xor_b32_e64 v210, 64, v210
    v_mfma_f32_16x16x32_bf16 v[154:157], v[44:47], v[192:195], v[154:157]
    ds_read_b64 v[184:185], v210 offset:0
    v_mfma_f32_16x16x32_bf16 v[166:169], v[52:55], v[192:195], v[166:169]
    s_waitcnt lgkmcnt(9)
    v_mfma_f32_16x16x32_bf16 v[130:133], v[16:19], v[196:199], v[130:133]
    v_xor_b32 v211, 64, v211
    v_mfma_f32_16x16x32_bf16 v[142:145], v[24:27], v[196:199], v[142:145]
    ds_read_b64 v[186:187], v211 offset:0
    v_mfma_f32_16x16x32_bf16 v[154:157], v[32:35], v[196:199], v[154:157]
    v_xor_b32_e64 v212, 64, v212
    v_mfma_f32_16x16x32_bf16 v[166:169], v[40:43], v[196:199], v[166:169]
    s_waitcnt lgkmcnt(8)
    v_mfma_f32_16x16x32_bf16 v[118:121], v[16:19], v[200:203], v[118:121]
    ds_read_b64 v[188:189], v212 offset:12288
    v_mfma_f32_16x16x32_bf16 v[130:133], v[24:27], v[200:203], v[130:133]
    v_xor_b32 v213, 64, v213
    v_mfma_f32_16x16x32_bf16 v[142:145], v[32:35], v[200:203], v[142:145]
    ds_read_b64 v[190:191], v213 offset:12288
    v_mfma_f32_16x16x32_bf16 v[154:157], v[40:43], v[200:203], v[154:157]
    ds_read_b64 v[192:193], v212 offset:0
    v_mfma_f32_16x16x32_bf16 v[166:169], v[48:51], v[200:203], v[166:169]
    s_waitcnt lgkmcnt(9)
    v_mfma_f32_16x16x32_bf16 v[130:133], v[20:23], v[204:207], v[130:133]
    ds_read_b64 v[194:195], v213 offset:0
    v_mfma_f32_16x16x32_bf16 v[142:145], v[28:31], v[204:207], v[142:145]
    ds_read_b64 v[196:197], v210 offset:12288
    v_mfma_f32_16x16x32_bf16 v[154:157], v[36:39], v[204:207], v[154:157]
    ds_read_b64 v[198:199], v211 offset:12288
    v_mfma_f32_16x16x32_bf16 v[166:169], v[44:47], v[204:207], v[166:169]
    s_cmp_lg_u32 s11, 0
    s_cbranch_scc1 L_out1
L_s1:
    s_waitcnt lgkmcnt(10)
    v_mfma_f32_16x16x32_bf16 v[88:91], v[20:23], v[176:179], 0
    ds_read_b64 v[200:201], v214 offset:0
    v_mfma_f32_16x16x32_bf16 v[100:103], v[28:31], v[176:179], 0
    ds_read_b64 v[202:203], v215 offset:0
    v_mfma_f32_16x16x32_bf16 v[112:115], v[36:39], v[176:179], 0
    v_mfma_f32_16x16x32_bf16 v[124:127], v[44:47], v[176:179], 0
    v_mfma_f32_16x16x32_bf16 v[136:139], v[52:55], v[176:179], 0
    v_mfma_f32_16x16x32_bf16 v[148:151], v[60:63], v[176:179], 0
    v_mfma_f32_16x16x32_bf16 v[160:163], v[68:71], v[176:179], 0
    v_mfma_f32_16x16x32_bf16 v[172:175], v[76:79], v[176:179], 0
    s_waitcnt lgkmcnt(10)
    v_mfma_f32_16x16x32_bf16 v[172:175], v[16:19], v[180:183], v[172:175]
    s_waitcnt lgkmcnt(8)
    v_mfma_f32_16x16x32_bf16 v[88:91], v[16:19], v[184:187], v[88:91]
    ds_read_b64 v[204:205], v208 offset:12288
    v_mfma_f32_16x16x32_bf16 v[100:103], v[24:27], v[184:187], v[100:103]
    ds_read_b64 v[206:207], v209 offset:12288
    v_mfma_f32_16x16x32_bf16 v[112:115], v[32:35], v[184:187], v[112:115]
    ds_read_b64 v[176:177], v208 offset:4096
    v_mfma_f32_16x16x32_bf16 v[124:127], v[40:43], v[184:187], v[124:127]
    ds_read_b64 v[178:179], v209 offset:4096
    v_mfma_f32_16x16x32_bf16 v[136:139], v[48:51], v[184:187], v[136:139]
    v_mfma_f32_16x16x32_bf16 v[148:151], v[56:59], v[184:187], v[148:151]
    v_mfma_f32_16x16x32_bf16 v[160:163], v[64:67], v[184:187], v[160:163]
    v_mfma_f32_16x16x32_bf16 v[172:175], v[72:75], v[184:187], v[172:175]
    s_waitcnt lgkmcnt(10)
    v_mfma_f32_16x16x32_bf16 v[172:175], v[20:23], v[188:191], v[172:175]
    s_waitcnt lgkmcnt(8)
    v_mfma_f32_16x16x32_bf16 v[100:103], v[20:23], v[192:195], v[100:103]
    ds_read_b64 v[180:181], v214 offset:8192
    v_mfma_f32_16x16x32_bf16 v[112:115], v[28:31], v[192:195], v[112:115]
    ds_read_b64 v[182:183], v215 offset:8192
    v_mfma_f32_16x16x32_bf16 v[124:127], v[36:39], v[192:195], v[124:127]
    ds_read_b64 v[184:185], v210 offset:4096
    v_mfma_f32_16x16x32_bf16 v[136:139], v[44:47], v[192:195], v[136:139]
    ds_read_b64 v[186:187], v211 offset:4096
    v_mfma_f32_16x16x32_bf16 v[148:151], v[52:55], v[192:195], v[148:151]
    v_mfma_f32_16x16x32_bf16 v[160:163], v[60:63], v[192:195], v[160:163]
    v_mfma_f32_16x16x32_bf16 v[172:175], v[68:71], v[192:195], v[172:175]
    s_waitcnt lgkmcnt(10)
    v_mfma_f32_16x16x32_bf16 v[160:163], v[16:19], v[196:199], v[160:163]
    ds_read_b64 v[188:189], v212 offset:8192
    v_mfma_f32_16x16x32_bf16 v[172:175], v[24:27], v[196:199], v[172:175]
    s_waitcnt lgkmcnt(9)
    v_mfma_f32_16x16x32_bf16 v[100:103], v[16:19], v[200:203], v[100:103]
    ds_read_b64 v[190:191], v213 offset:8192
    v_mfma_f32_16x16x32_bf16 v[112:115], v[24:27], v[200:203], v[112:115]
    ds_read_b64 v[192:193], v212 offset:4096
    v_mfma_f32_16x16x32_bf16 v[124:127], v[32:35], v[200:203], v[124:127]
    ds_read_b64 v[194:195], v213 offset:4096
    v_mfma_f32_16x16x32_bf16 v[136:139], v[40:43], v[200:203], v[136:139]
    v_mfma_f32_16x16x32_bf16 v[148:151], v[48:51], v[200:203], v[148:151]
    v_mfma_f32_16x16x32_bf16 v[160:163], v[56:59], v[200:203], v[160:163]
    v_mfma_f32_16x16x32_bf16 v[172:175], v[64:67], v[200:203], v[172:175]
    s_waitcnt lgkmcnt(10)
    v_mfma_f32_16x16x32_bf16 v[160:163], v[20:23], v[204:207], v[160:163]
    ds_read_b64 v[196:197], v210 offset:8192
    v_mfma_f32_16x16x32_bf16 v[172:175], v[28:31], v[204:207], v[172:175]
    s_waitcnt lgkmcnt(9)
    v_mfma_f32_16x16x32_bf16 v[112:115], v[20:23], v[176:179], v[112:115]
    ds_read_b64 v[198:199], v211 offset:8192
    v_mfma_f32_16x16x32_bf16 v[124:127], v[28:31], v[176:179], v[124:127]
    ds_read_b64 v[200:201], v214 offset:4096
    v_mfma_f32_16x16x32_bf16 v[136:139], v[36:39], v[176:179], v[136:139]
    ds_read_b64 v[202:203], v215 offset:4096
    v_mfma_f32_16x16x32_bf16 v[148:151], v[44:47], v[176:179], v[148:151]
    v_mfma_f32_16x16x32_bf16 v[160:163], v[52:55], v[176:179], v[160:163]
    v_mfma_f32_16x16x32_bf16 v[172:175], v[60:63], v[176:179], v[172:175]
    s_waitcnt lgkmcnt(10)
    v_mfma_f32_16x16x32_bf16 v[148:151], v[16:19], v[180:183], v[148:151]
    ds_read_b64 v[204:205], v208 offset:8192
    v_mfma_f32_16x16x32_bf16 v[160:163], v[24:27], v[180:183], v[160:163]
    ds_read_b64 v[206:207], v209 offset:8192
    v_mfma_f32_16x16x32_bf16 v[172:175], v[32:35], v[180:183], v[172:175]
    s_waitcnt lgkmcnt(10)
    v_mfma_f32_16x16x32_bf16 v[112:115], v[16:19], v[184:187], v[112:115]
    v_xor_b32 v208, 128, v208
    v_mfma_f32_16x16x32_bf16 v[124:127], v[24:27], v[184:187], v[124:127]
    ds_read_b64 v[176:177], v208 offset:0
    v_mfma_f32_16x16x32_bf16 v[136:139], v[32:35], v[184:187], v[136:139]
    v_xor_b32 v209, 128, v209
    v_mfma_f32_16x16x32_bf16 v[148:151], v[40:43], v[184:187], v[148:151]
    ds_read_b64 v[178:179], v209 offset:0
    v_mfma_f32_16x16x32_bf16 v[160:163], v[48:51], v[184:187], v[160:163]
    v_mfma_f32_16x16x32_bf16 v[172:175], v[56:59], v[184:187], v[172:175]
    s_waitcnt lgkmcnt(10)
    v_mfma_f32_16x16x32_bf16 v[148:151], v[20:23], v[188:191], v[148:151]
    v_xor_b32 v214, 128, v214
    v_mfma_f32_16x16x32_bf16 v[160:163], v[28:31], v[188:191], v[160:163]
    ds_read_b64 v[180:181], v214 offset:12288
    v_mfma_f32_16x16x32_bf16 v[172:175], v[36:39], v[188:191], v[172:175]
    s_waitcnt lgkmcnt(9)
    v_mfma_f32_16x16x32_bf16 v[124:127], v[20:23], v[192:195], v[124:127]
    v_xor_b32 v215, 128, v215
    v_mfma_f32_16x16x32_bf16 v[136:139], v[28:31], v[192:195], v[136:139]
    ds_read_b64 v[182:183], v215 offset:12288
    v_mfma_f32_16x16x32_bf16 v[148:151], v[36:39], v[192:195], v[148:151]
    v_xor_b32 v210, 128, v210
    v_mfma_f32_16x16x32_bf16 v[160:163], v[44:47], v[192:195], v[160:163]
    ds_read_b64 v[184:185], v210 offset:0
    v_mfma_f32_16x16x32_bf16 v[172:175], v[52:55], v[192:195], v[172:175]
    s_waitcnt lgkmcnt(9)
    v_mfma_f32_16x16x32_bf16 v[136:139], v[16:19], v[196:199], v[136:139]
    v_xor_b32 v211, 128, v211
    v_mfma_f32_16x16x32_bf16 v[148:151], v[24:27], v[196:199], v[148:151]
    ds_read_b64 v[186:187], v211 offset:0
    v_mfma_f32_16x16x32_bf16 v[160:163], v[32:35], v[196:199], v[160:163]
    v_xor_b32 v212, 128, v212
    v_mfma_f32_16x16x32_bf16 v[172:175], v[40:43], v[196:199], v[172:175]
    s_waitcnt lgkmcnt(8)
    v_mfma_f32_16x16x32_bf16 v[124:127], v[16:19], v[200:203], v[124:127]
    ds_read_b64 v[188:189], v212 offset:12288
    v_mfma_f32_16x16x32_bf16 v[136:139], v[24:27], v[200:203], v[136:139]
    v_xor_b32 v213, 128, v213
    v_mfma_f32_16x16x32_bf16 v[148:151], v[32:35], v[200:203], v[148:151]
    ds_read_b64 v[190:191], v213 offset:12288
    v_mfma_f32_16x16x32_bf16 v[160:163], v[40:43], v[200:203], v[160:163]
    ds_read_b64 v[192:193], v212 offset:0
    v_mfma_f32_16x16x32_bf16 v[172:175], v[48:51], v[200:203], v[172:175]
    s_waitcnt lgkmcnt(9)
    v_mfma_f32_16x16x32_bf16 v[136:139], v[20:23], v[204:207], v[136:139]
    ds_read_b64 v[194:195], v213 offset:0
    v_mfma_f32_16x16x32_bf16 v[148:151], v[28:31], v[204:207], v[148:151]
    ds_read_b64 v[196:197], v210 offset:12288
    v_mfma_f32_16x16x32_bf16 v[160:163], v[36:39], v[204:207], v[160:163]
    ds_read_b64 v[198:199], v211 offset:12288
    v_mfma_f32_16x16x32_bf16 v[172:175], v[44:47], v[204:207], v[172:175]
    s_cmp_lg_u32 s11, 0
    s_cbranch_scc1 L_out2
L_s2:
    s_waitcnt lgkmcnt(10)
    v_mfma_f32_16x16x32_bf16 v[86:89], v[20:23], v[176:179], v[86:89]
    ds_read_b64 v[200:201], v214 offset:0
    v_mfma_f32_16x16x32_bf16 v[98:101], v[28:31], v[176:179], v[98:101]
    ds_read_b64 v[202:203], v215 offset:0
    v_mfma_f32_16x16x32_bf16 v[110:113], v[36:39], v[176:179], v[110:113]
    v_mfma_f32_16x16x32_bf16 v[122:125], v[44:47], v[176:179], v[122:125]
    v_mfma_f32_16x16x32_bf16 v[134:137], v[52:55], v[176:179], v[134:137]
    v_mfma_f32_16x16x32_bf16 v[146:149], v[60:63], v[176:179], v[146:149]
    v_mfma_f32_16x16x32_bf16 v[158:161], v[68:71], v[176:179], v[158:161]
    v_mfma_f32_16x16x32_bf16 v[170:173], v[76:79], v[176:179], v[170:173]
    s_waitcnt lgkmcnt(10)
    v_mfma_f32_16x16x32_bf16 v[170:173], v[16:19], v[180:183], v[170:173]
    v_add_f32 v85, v85, v90
    s_waitcnt lgkmcnt(8)
    v_mfma_f32_16x16x32_bf16 v[86:89], v[16:19], v[184:187], v[86:89]
    ds_read_b64 v[204:205], v208 offset:12288
    v_cndmask_b32 v237, v91, v6, vcc
    v_mfma_f32_16x16x32_bf16 v[98:101], v[24:27], v[184:187], v[98:101]
    ds_read_b64 v[206:207], v209 offset:12288
    v_cndmask_b32_e64 v81, v85, v6, vcc
    v_mfma_f32_16x16x32_bf16 v[110:113], v[32:35], v[184:187], v[110:113]
    ds_read_b64 v[176:177], v208 offset:4096
    ds_bpermute_b32 v237, v248, v237
    v_mfma_f32_16x16x32_bf16 v[122:125], v[40:43], v[184:187], v[122:125]
    ds_read_b64 v[178:179], v209 offset:4096
    ds_bpermute_b32 v81, v248, v81
    v_mfma_f32_16x16x32_bf16 v[134:137], v[48:51], v[184:187], v[134:137]
    v_add_f32_e64 v97, v97, v102
    v_mfma_f32_16x16x32_bf16 v[146:149], v[56:59], v[184:187], v[146:149]
    v_cndmask_b32_e64 v238, v103, v91, vcc
    v_mfma_f32_16x16x32_bf16 v[158:161], v[64:67], v[184:187], v[158:161]
    v_cndmask_b32_e64 v93, v97, v85, vcc
    v_mfma_f32_16x16x32_bf16 v[170:173], v[72:75], v[184:187], v[170:173]
    ds_bpermute_b32 v238, v248, v238
    s_waitcnt lgkmcnt(13)
    v_mfma_f32_16x16x32_bf16 v[170:173], v[20:23], v[188:191], v[170:173]
    ds_bpermute_b32 v93, v248, v93
    s_waitcnt lgkmcnt(12)
    v_mfma_f32_16x16x32_bf16 v[98:101], v[20:23], v[192:195], v[98:101]
    ds_read_b64 v[180:181], v214 offset:8192
    v_add_f32_e64 v109, v109, v114
    v_mfma_f32_16x16x32_bf16 v[110:113], v[28:31], v[192:195], v[110:113]
    ds_read_b64 v[182:183], v215 offset:8192
    v_cndmask_b32_e64 v239, v115, v103, vcc
    v_mfma_f32_16x16x32_bf16 v[122:125], v[36:39], v[192:195], v[122:125]
    ds_read_b64 v[184:185], v210 offset:4096
    v_cndmask_b32_e64 v105, v109, v97, vcc
    v_mfma_f32_16x16x32_bf16 v[134:137], v[44:47], v[192:195], v[134:137]
    ds_read_b64 v[186:187], v211 offset:4096
    ds_bpermute_b32 v239, v248, v239
    v_mfma_f32_16x16x32_bf16 v[146:149], v[52:55], v[192:195], v[146:149]
    ds_bpermute_b32 v105, v248, v105
    v_mfma_f32_16x16x32_bf16 v[158:161], v[60:63], v[192:195], v[158:161]
    v_add_f32_e64 v121, v121, v126
    v_mfma_f32_16x16x32_bf16 v[170:173], v[68:71], v[192:195], v[170:173]
    v_cndmask_b32 v240, v127, v115, vcc
    s_waitcnt lgkmcnt(15)
    v_mfma_f32_16x16x32_bf16 v[158:161], v[16:19], v[196:199], v[158:161]
    ds_read_b64 v[188:189], v212 offset:8192
    v_cndmask_b32_e64 v117, v121, v109, vcc
    v_mfma_f32_16x16x32_bf16 v[170:173], v[24:27], v[196:199], v[170:173]
    ds_bpermute_b32 v240, v248, v240
    s_waitcnt lgkmcnt(15)
    v_mfma_f32_16x16x32_bf16 v[98:101], v[16:19], v[200:203], v[98:101]
    ds_read_b64 v[190:191], v213 offset:8192
    ds_bpermute_b32 v117, v248, v117
    v_mfma_f32_16x16x32_bf16 v[110:113], v[24:27], v[200:203], v[110:113]
    ds_read_b64 v[192:193], v212 offset:4096
    v_add_f32 v133, v133, v138
    v_mfma_f32_16x16x32_bf16 v[122:125], v[32:35], v[200:203], v[122:125]
    ds_read_b64 v[194:195], v213 offset:4096
    v_cndmask_b32_e64 v241, v139, v127, vcc
    v_mfma_f32_16x16x32_bf16 v[134:137], v[40:43], v[200:203], v[134:137]
    v_cndmask_b32_e64 v129, v133, v121, vcc
    v_mfma_f32_16x16x32_bf16 v[146:149], v[48:51], v[200:203], v[146:149]
    ds_bpermute_b32 v241, v248, v241
    v_mfma_f32_16x16x32_bf16 v[158:161], v[56:59], v[200:203], v[158:161]
    ds_bpermute_b32 v129, v248, v129
    v_mfma_f32_16x16x32_bf16 v[170:173], v[64:67], v[200:203], v[170:173]
    v_add_f32 v145, v145, v150
    s_waitcnt lgkmcnt(15)
    v_mfma_f32_16x16x32_bf16 v[158:161], v[20:23], v[204:207], v[158:161]
    ds_read_b64 v[196:197], v210 offset:8192
    v_cndmask_b32_e64 v242, v151, v139, vcc
    v_mfma_f32_16x16x32_bf16 v[170:173], v[28:31], v[204:207], v[170:173]
    v_cndmask_b32_e64 v141, v145, v133, vcc
    v_mfma_f32_16x16x32_bf16 v[110:113], v[20:23], v[176:179], v[110:113]
    ds_read_b64 v[198:199], v211 offset:8192
    ds_bpermute_b32 v242, v248, v242
    v_mfma_f32_16x16x32_bf16 v[122:125], v[28:31], v[176:179], v[122:125]
    ds_read_b64 v[200:201], v214 offset:4096
    ds_bpermute_b32 v141, v248, v141
    v_mfma_f32_16x16x32_bf16 v[134:137], v[36:39], v[176:179], v[134:137]
    ds_read_b64 v[202:203], v215 offset:4096
    v_add_f32_e64 v157, v157, v162
    v_mfma_f32_16x16x32_bf16 v[146:149], v[44:47], v[176:179], v[146:149]
    v_cndmask_b32_e64 v243, v163, v151, vcc
    v_mfma_f32_16x16x32_bf16 v[158:161], v[52:55], v[176:179], v[158:161]
    v_cndmask_b32_e64 v153, v157, v145, vcc
    v_mfma_f32_16x16x32_bf16 v[170:173], v[60:63], v[176:179], v[170:173]
    ds_bpermute_b32 v243, v248, v243
    s_waitcnt lgkmcnt(15)
    v_mfma_f32_16x16x32_bf16 v[146:149], v[16:19], v[180:183], v[146:149]
    ds_read_b64 v[204:205], v208 offset:8192
    ds_bpermute_b32 v153, v248, v153
    v_mfma_f32_16x16x32_bf16 v[158:161], v[24:27], v[180:183], v[158:161]
    ds_read_b64 v[206:207], v209 offset:8192
    v_add_f32 v169, v169, v174
    v_mfma_f32_16x16x32_bf16 v[170:173], v[32:35], v[180:183], v[170:173]
    v_cndmask_b32_e64 v244, v175, v163, vcc
    v_mfma_f32_16x16x32_bf16 v[110:113], v[16:19], v[184:187], v[110:113]
    v_xor_b32 v208, 64, v208
    v_cndmask_b32 v165, v169, v157, vcc
    v_mfma_f32_16x16x32_bf16 v[122:125], v[24:27], v[184:187], v[122:125]
    ds_read_b64 v[176:177], v208 offset:0
    ds_bpermute_b32 v244, v248, v244
    v_mfma_f32_16x16x32_bf16 v[134:137], v[32:35], v[184:187], v[134:137]
    v_xor_b32_e64 v209, 64, v209
    ds_bpermute_b32 v165, v248, v165
    v_mfma_f32_16x16x32_bf16 v[146:149], v[40:43], v[184:187], v[146:149]
    ds_read_b64 v[178:179], v209 offset:0
    v_add_f32_e64 v82, v82, v237
    v_mfma_f32_16x16x32_bf16 v[158:161], v[48:51], v[184:187], v[158:161]
    v_add_f32_e64 v94, v94, v238
    v_mfma_f32_16x16x32_bf16 v[170:173], v[56:59], v[184:187], v[170:173]
    v_add_f32 v106, v106, v239
    s_waitcnt lgkmcnt(15)
    v_mfma_f32_16x16x32_bf16 v[146:149], v[20:23], v[188:191], v[146:149]
    v_xor_b32 v210, 64, v210
    v_add_f32 v118, v118, v240
    v_mfma_f32_16x16x32_bf16 v[158:161], v[28:31], v[188:191], v[158:161]
    ds_read_b64 v[180:181], v210 offset:0
    s_waitcnt lgkmcnt(15)
    v_add_f32 v130, v130, v241
    v_mfma_f32_16x16x32_bf16 v[170:173], v[36:39], v[188:191], v[170:173]
    s_waitcnt lgkmcnt(10)
    v_add_f32 v142, v142, v242
    v_mfma_f32_16x16x32_bf16 v[122:125], v[20:23], v[192:195], v[122:125]
    v_xor_b32 v211, 64, v211
    s_waitcnt lgkmcnt(6)
    v_add_f32_e64 v154, v154, v243
    v_mfma_f32_16x16x32_bf16 v[134:137], v[28:31], v[192:195], v[134:137]
    ds_read_b64 v[182:183], v211 offset:0
    s_waitcnt lgkmcnt(3)
    v_add_f32 v166, v166, v244
    v_mfma_f32_16x16x32_bf16 v[146:149], v[36:39], v[192:195], v[146:149]
    v_xor_b32_e64 v212, 64, v212
    v_mfma_f32_16x16x32_bf16 v[158:161], v[44:47], v[192:195], v[158:161]
    ds_read_b64 v[184:185], v212 offset:0
    v_mfma_f32_16x16x32_bf16 v[170:173], v[52:55], v[192:195], v[170:173]
    v_mfma_f32_16x16x32_bf16 v[134:137], v[16:19], v[196:199], v[134:137]
    v_xor_b32_e64 v213, 64, v213
    v_mfma_f32_16x16x32_bf16 v[146:149], v[24:27], v[196:199], v[146:149]
    ds_read_b64 v[186:187], v213 offset:0
    v_mfma_f32_16x16x32_bf16 v[158:161], v[32:35], v[196:199], v[158:161]
    v_xor_b32_e64 v214, 64, v214
    v_mfma_f32_16x16x32_bf16 v[170:173], v[40:43], v[196:199], v[170:173]
    v_mfma_f32_16x16x32_bf16 v[122:125], v[16:19], v[200:203], v[122:125]
    ds_read_b64 v[188:189], v214 offset:0
    v_mfma_f32_16x16x32_bf16 v[134:137], v[24:27], v[200:203], v[134:137]
    v_xor_b32_e64 v215, 64, v215
    v_mfma_f32_16x16x32_bf16 v[146:149], v[32:35], v[200:203], v[146:149]
    ds_read_b64 v[190:191], v215 offset:0
    v_mfma_f32_16x16x32_bf16 v[158:161], v[40:43], v[200:203], v[158:161]
    ds_read_b64 v[192:193], v208 offset:4096
    v_mfma_f32_16x16x32_bf16 v[170:173], v[48:51], v[200:203], v[170:173]
    v_mfma_f32_16x16x32_bf16 v[134:137], v[20:23], v[204:207], v[134:137]
    ds_read_b64 v[194:195], v209 offset:4096
    v_mfma_f32_16x16x32_bf16 v[146:149], v[28:31], v[204:207], v[146:149]
    ds_read_b64 v[196:197], v210 offset:4096
    v_mfma_f32_16x16x32_bf16 v[158:161], v[36:39], v[204:207], v[158:161]
    ds_read_b64 v[198:199], v211 offset:4096
    v_mfma_f32_16x16x32_bf16 v[170:173], v[44:47], v[204:207], v[170:173]
    s_cmp_lg_u32 s11, 0
    s_cbranch_scc1 L_out3
L_s3:
    s_waitcnt lgkmcnt(10)
    v_mfma_f32_16x16x32_bf16 v[80:83], v[20:23], v[176:179], v[80:83]
    ds_read_b64 v[200:201], v212 offset:4096
    v_mfma_f32_16x16x32_bf16 v[92:95], v[28:31], v[176:179], v[92:95]
    ds_read_b64 v[202:203], v213 offset:4096
    v_mfma_f32_16x16x32_bf16 v[104:107], v[36:39], v[176:179], v[104:107]
    v_add_f32 v84, v84, v89
    v_cndmask_b32_e64 v89, v84, v6, vcc
    v_mfma_f32_16x16x32_bf16 v[116:119], v[44:47], v[176:179], v[116:119]
    ds_bpermute_b32 v89, v248, v89
    v_add_f32_e64 v96, v96, v101
    v_mfma_f32_16x16x32_bf16 v[128:131], v[52:55], v[176:179], v[128:131]
    v_cndmask_b32_e64 v101, v96, v84, vcc
    ds_bpermute_b32 v101, v248, v101
    v_mfma_f32_16x16x32_bf16 v[140:143], v[60:63], v[176:179], v[140:143]
    v_add_f32 v108, v108, v113
    v_cndmask_b32 v113, v108, v96, vcc
    v_mfma_f32_16x16x32_bf16 v[152:155], v[68:71], v[176:179], v[152:155]
    ds_bpermute_b32 v113, v248, v113
    v_add_f32_e64 v120, v120, v125
    v_mfma_f32_16x16x32_bf16 v[164:167], v[76:79], v[176:179], v[164:167]
    v_cndmask_b32 v125, v120, v108, vcc
    s_waitcnt lgkmcnt(13)
    v_mfma_f32_16x16x32_bf16 v[80:83], v[16:19], v[180:183], v[80:83]
    ds_read_b64 v[204:205], v214 offset:4096
    ds_bpermute_b32 v125, v248, v125
    v_mfma_f32_16x16x32_bf16 v[92:95], v[24:27], v[180:183], v[92:95]
    ds_read_b64 v[206:207], v215 offset:4096
    v_add_f32_e64 v132, v132, v137
    v_mfma_f32_16x16x32_bf16 v[104:107], v[32:35], v[180:183], v[104:107]
    v_cndmask_b32_e64 v137, v132, v120, vcc
    ds_bpermute_b32 v137, v248, v137
    v_mfma_f32_16x16x32_bf16 v[116:119], v[40:43], v[180:183], v[116:119]
    v_add_f32 v144, v144, v149
    v_cndmask_b32 v149, v144, v132, vcc
    v_mfma_f32_16x16x32_bf16 v[128:131], v[48:51], v[180:183], v[128:131]
    ds_bpermute_b32 v149, v248, v149
    v_add_f32_e64 v156, v156, v161
    v_mfma_f32_16x16x32_bf16 v[140:143], v[56:59], v[180:183], v[140:143]
    v_cndmask_b32_e64 v161, v156, v144, vcc
    ds_bpermute_b32 v161, v248, v161
    v_mfma_f32_16x16x32_bf16 v[152:155], v[64:67], v[180:183], v[152:155]
    v_add_f32 v168, v168, v173
    v_cndmask_b32 v173, v168, v156, vcc
    v_mfma_f32_16x16x32_bf16 v[164:167], v[72:75], v[180:183], v[164:167]
    ds_bpermute_b32 v173, v248, v173
    s_waitcnt lgkmcnt(15)
    v_mfma_f32_16x16x32_bf16 v[92:95], v[20:23], v[184:187], v[92:95]
    ds_read_b64 v[176:177], v208 offset:8192
    v_mfma_f32_16x16x32_bf16 v[104:107], v[28:31], v[184:187], v[104:107]
    ds_read_b64 v[178:179], v209 offset:8192
    v_mfma_f32_16x16x32_bf16 v[116:119], v[36:39], v[184:187], v[116:119]
    v_mfma_f32_16x16x32_bf16 v[128:131], v[44:47], v[184:187], v[128:131]
    v_mfma_f32_16x16x32_bf16 v[140:143], v[52:55], v[184:187], v[140:143]
    v_mfma_f32_16x16x32_bf16 v[152:155], v[60:63], v[184:187], v[152:155]
    v_mfma_f32_16x16x32_bf16 v[164:167], v[68:71], v[184:187], v[164:167]
    v_mfma_f32_16x16x32_bf16 v[92:95], v[16:19], v[188:191], v[92:95]
    ds_read_b64 v[180:181], v210 offset:8192
    v_add_f32 v81, v81, v86
    v_mfma_f32_16x16x32_bf16 v[104:107], v[24:27], v[188:191], v[104:107]
    ds_read_b64 v[182:183], v211 offset:8192
    v_add_f32_e64 v82, v82, v87
    v_mfma_f32_16x16x32_bf16 v[116:119], v[32:35], v[188:191], v[116:119]
    v_add_f32 v83, v83, v88
    s_waitcnt lgkmcnt(13)
    v_add_f32_e64 v80, v80, v89
    v_mfma_f32_16x16x32_bf16 v[128:131], v[40:43], v[188:191], v[128:131]
    v_cvt_pk_bf16_f32 v89, v82, v83
    v_cvt_pk_bf16_f32 v88, v80, v81
    v_mfma_f32_16x16x32_bf16 v[140:143], v[48:51], v[188:191], v[140:143]
    v_mfma_f32_16x16x32_bf16 v[152:155], v[56:59], v[188:191], v[152:155]
    v_mfma_f32_16x16x32_bf16 v[164:167], v[64:67], v[188:191], v[164:167]
    v_mfma_f32_16x16x32_bf16 v[104:107], v[20:23], v[192:195], v[104:107]
    ds_read_b64 v[184:185], v212 offset:8192
    v_mfma_f32_16x16x32_bf16 v[116:119], v[28:31], v[192:195], v[116:119]
    ds_read_b64 v[186:187], v213 offset:8192
    v_mfma_f32_16x16x32_bf16 v[128:131], v[36:39], v[192:195], v[128:131]
    v_mfma_f32_16x16x32_bf16 v[140:143], v[44:47], v[192:195], v[140:143]
    v_mfma_f32_16x16x32_bf16 v[152:155], v[52:55], v[192:195], v[152:155]
    v_mfma_f32_16x16x32_bf16 v[164:167], v[60:63], v[192:195], v[164:167]
    v_mfma_f32_16x16x32_bf16 v[104:107], v[16:19], v[196:199], v[104:107]
    ds_read_b64 v[188:189], v214 offset:8192
    v_add_f32_e64 v93, v93, v98
    v_mfma_f32_16x16x32_bf16 v[116:119], v[24:27], v[196:199], v[116:119]
    ds_read_b64 v[190:191], v215 offset:8192
    v_add_f32_e64 v94, v94, v99
    v_mfma_f32_16x16x32_bf16 v[128:131], v[32:35], v[196:199], v[128:131]
    v_add_f32 v95, v95, v100
    s_waitcnt lgkmcnt(15)
    v_add_f32_e64 v92, v92, v101
    v_mfma_f32_16x16x32_bf16 v[140:143], v[40:43], v[196:199], v[140:143]
    v_cvt_pk_bf16_f32 v91, v94, v95
    v_cvt_pk_bf16_f32 v90, v92, v93
    v_mfma_f32_16x16x32_bf16 v[152:155], v[48:51], v[196:199], v[152:155]
    buffer_store_dwordx4 v[88:91], v2, s[44:47], s66 offen offset:0 sc1
    v_mfma_f32_16x16x32_bf16 v[164:167], v[56:59], v[196:199], v[164:167]
    v_mfma_f32_16x16x32_bf16 v[116:119], v[20:23], v[200:203], v[116:119]
    ds_read_b64 v[192:193], v208 offset:12288
    v_mfma_f32_16x16x32_bf16 v[128:131], v[28:31], v[200:203], v[128:131]
    ds_read_b64 v[194:195], v209 offset:12288
    v_mfma_f32_16x16x32_bf16 v[140:143], v[36:39], v[200:203], v[140:143]
    v_mfma_f32_16x16x32_bf16 v[152:155], v[44:47], v[200:203], v[152:155]
    v_mfma_f32_16x16x32_bf16 v[164:167], v[52:55], v[200:203], v[164:167]
    s_waitcnt lgkmcnt(14)
    v_mfma_f32_16x16x32_bf16 v[116:119], v[16:19], v[204:207], v[116:119]
    ds_read_b64 v[196:197], v210 offset:12288
    v_add_f32 v105, v105, v110
    v_mfma_f32_16x16x32_bf16 v[128:131], v[24:27], v[204:207], v[128:131]
    ds_read_b64 v[198:199], v211 offset:12288
    v_add_f32_e64 v106, v106, v111
    v_mfma_f32_16x16x32_bf16 v[140:143], v[32:35], v[204:207], v[140:143]
    v_add_f32 v107, v107, v112
    v_add_f32 v104, v104, v113
    v_mfma_f32_16x16x32_bf16 v[152:155], v[40:43], v[204:207], v[152:155]
    v_cvt_pk_bf16_f32 v113, v106, v107
    v_cvt_pk_bf16_f32 v112, v104, v105
    v_mfma_f32_16x16x32_bf16 v[164:167], v[48:51], v[204:207], v[164:167]
    s_waitcnt lgkmcnt(10)
    v_mfma_f32_16x16x32_bf16 v[128:131], v[20:23], v[176:179], v[128:131]
    ds_read_b64 v[200:201], v212 offset:12288
    v_mfma_f32_16x16x32_bf16 v[140:143], v[28:31], v[176:179], v[140:143]
    ds_read_b64 v[202:203], v213 offset:12288
    v_mfma_f32_16x16x32_bf16 v[152:155], v[36:39], v[176:179], v[152:155]
    v_mfma_f32_16x16x32_bf16 v[164:167], v[44:47], v[176:179], v[164:167]
    s_waitcnt lgkmcnt(10)
    v_mfma_f32_16x16x32_bf16 v[128:131], v[16:19], v[180:183], v[128:131]
    ds_read_b64 v[204:205], v214 offset:12288
    v_add_f32_e64 v117, v117, v122
    v_mfma_f32_16x16x32_bf16 v[140:143], v[24:27], v[180:183], v[140:143]
    ds_read_b64 v[206:207], v215 offset:12288
    v_add_f32_e64 v118, v118, v123
    v_mfma_f32_16x16x32_bf16 v[152:155], v[32:35], v[180:183], v[152:155]
    v_add_f32 v119, v119, v124
    v_add_f32 v116, v116, v125
    v_mfma_f32_16x16x32_bf16 v[164:167], v[40:43], v[180:183], v[164:167]
    v_cvt_pk_bf16_f32 v115, v118, v119
    s_waitcnt lgkmcnt(10)
    v_mfma_f32_16x16x32_bf16 v[140:143], v[20:23], v[184:187], v[140:143]
    v_cvt_pk_bf16_f32 v114, v116, v117
    buffer_store_dwordx4 v[112:115], v2, s[44:47], s66 offen offset:1024 sc1
    v_mfma_f32_16x16x32_bf16 v[152:155], v[28:31], v[184:187], v[152:155]
    v_mfma_f32_16x16x32_bf16 v[164:167], v[36:39], v[184:187], v[164:167]
    s_waitcnt lgkmcnt(8)
    v_mfma_f32_16x16x32_bf16 v[140:143], v[16:19], v[188:191], v[140:143]
    v_add_f32 v129, v129, v134
    v_add_f32 v130, v130, v135
    v_mfma_f32_16x16x32_bf16 v[152:155], v[24:27], v[188:191], v[152:155]
    v_add_f32 v131, v131, v136
    v_add_f32 v128, v128, v137
    v_mfma_f32_16x16x32_bf16 v[164:167], v[32:35], v[188:191], v[164:167]
    v_cvt_pk_bf16_f32 v137, v130, v131
    s_waitcnt lgkmcnt(6)
    v_mfma_f32_16x16x32_bf16 v[152:155], v[20:23], v[192:195], v[152:155]
    v_cvt_pk_bf16_f32 v136, v128, v129
    v_mfma_f32_16x16x32_bf16 v[164:167], v[28:31], v[192:195], v[164:167]
    s_waitcnt lgkmcnt(4)
    v_mfma_f32_16x16x32_bf16 v[152:155], v[16:19], v[196:199], v[152:155]
    v_add_f32 v141, v141, v146
    v_add_f32 v142, v142, v147
    v_mfma_f32_16x16x32_bf16 v[164:167], v[24:27], v[196:199], v[164:167]
    v_add_f32 v143, v143, v148
    s_waitcnt lgkmcnt(2)
    v_mfma_f32_16x16x32_bf16 v[164:167], v[20:23], v[200:203], v[164:167]
    v_add_f32 v140, v140, v149
    s_waitcnt lgkmcnt(0)
    v_mfma_f32_16x16x32_bf16 v[164:167], v[16:19], v[204:207], v[164:167]
    v_cvt_pk_bf16_f32 v139, v142, v143
    v_cvt_pk_bf16_f32 v138, v140, v141
    buffer_store_dwordx4 v[136:139], v2, s[44:47], s66 offen offset:2048 sc1
    v_add_f32 v153, v153, v158
    v_add_f32 v154, v154, v159
    v_add_f32 v155, v155, v160
    v_add_f32 v152, v152, v161
    v_cvt_pk_bf16_f32 v161, v154, v155
    v_cvt_pk_bf16_f32 v160, v152, v153
    v_add_f32 v165, v165, v170
    v_add_f32 v166, v166, v171
    v_add_f32 v167, v167, v172
    v_add_f32 v164, v164, v173
    v_cvt_pk_bf16_f32 v163, v166, v167
    v_cvt_pk_bf16_f32 v162, v164, v165
    buffer_store_dwordx4 v[160:163], v2, s[44:47], s66 offen offset:3072 sc1
    s_branch L_convdone
L_out1:
    ds_write_b128 v2, v[82:85] offset:36864
    ds_write_b128 v2, v[94:97] offset:37888
    ds_write_b128 v2, v[106:109] offset:38912
    ds_write_b128 v2, v[118:121] offset:39936
    ds_write_b128 v2, v[130:133] offset:40960
    ds_write_b128 v2, v[142:145] offset:41984
    ds_write_b128 v2, v[154:157] offset:43008
    ds_write_b128 v2, v[166:169] offset:44032
    s_branch L_sent
L_out2:
    ds_write_b128 v2, v[88:91] offset:45056
    ds_write_b128 v2, v[100:103] offset:46080
    ds_write_b128 v2, v[112:115] offset:47104
    ds_write_b128 v2, v[124:127] offset:48128
    ds_write_b128 v2, v[136:139] offset:49152
    ds_write_b128 v2, v[148:151] offset:50176
    ds_write_b128 v2, v[160:163] offset:51200
    ds_write_b128 v2, v[172:175] offset:52224
    s_branch L_sent
L_out3:
    ds_write_b128 v2, v[86:89] offset:53248
    ds_write_b128 v2, v[98:101] offset:54272
    ds_write_b128 v2, v[110:113] offset:55296
    ds_write_b128 v2, v[122:125] offset:56320
    ds_write_b128 v2, v[134:137] offset:57344
    ds_write_b128 v2, v[146:149] offset:58368
    ds_write_b128 v2, v[158:161] offset:59392
    ds_write_b128 v2, v[170:173] offset:60416
L_sent:
    v_mov_b32 v9, 1
    s_mov_b64 exec, 1
    ds_add_u32 v6, v9
    s_mov_b64 exec, -1
    s_mov_b32 s60, s22
    s_and_b32 s61, s23, 0xffff
    s_mov_b32 s62, 0xc8000
    s_mov_b32 s63, 0x20000
    s_lshr_b32 s4, s43, 2
    s_mul_i32 s4, s4, 160
    v_add_u32_e64 v13, 0, v1
    v_mul_u32_u24 v14, 6554, v13
    v_lshrrev_b32_e64 v14, 16, v14
    v_mul_u32_u24 v14, 1120, v14
    v_lshl_add_u32 v14, v13, 4, v14
    v_add_u32 v8, s4, v14
    v_add_u32 v13, 64, v1
    v_mul_u32_u24 v14, 6554, v13
    v_lshrrev_b32_e64 v14, 16, v14
    v_mul_u32_u24 v14, 1120, v14
    v_lshl_add_u32 v14, v13, 4, v14
    v_add_u32_e64 v9, s4, v14
    v_add_u32 v13, 128, v1
    v_mul_u32_u24 v14, 6554, v13
    v_lshrrev_b32_e64 v14, 16, v14
    v_mul_u32_u24 v14, 1120, v14
    v_lshl_add_u32 v14, v13, 4, v14
    v_add_u32_e64 v10, s4, v14
    v_add_u32 v13, 192, v1
    v_mul_u32_u24 v14, 6554, v13
    v_lshrrev_b32_e64 v14, 16, v14
    v_mul_u32_u24 v14, 1120, v14
    v_lshl_add_u32 v14, v13, 4, v14
    v_add_u32_e64 v11, s4, v14
    v_add_u32 v13, 256, v1
    v_mul_u32_u24 v14, 6554, v13
    v_lshrrev_b32_e64 v14, 16, v14
    v_mul_u32_u24 v14, 1120, v14
    v_lshl_add_u32 v14, v13, 4, v14
    v_add_u32 v12, s4, v14
Ls36:
    s_sleep 1
    ds_read_b32 v4, v6
    s_waitcnt lgkmcnt(0)
    v_cmp_gt_u32 vcc, 3, v4
    s_cmp_eq_u32 s91, 0
    s_cbranch_scc1 Le37
    s_sub_u32 s91, s91, 1
    s_nop 1
    s_cbranch_vccnz Ls36
Le37:
    s_mov_b32 s4, s3
    s_mov_b32 s5, 20
Lwo38:
    s_cmp_ge_u32 s4, s5
    s_cbranch_scc1 Lwx39
    s_and_b32 s6, s43, 3
    s_mul_i32 s6, s6, 5
    s_add_u32 s6, s6, s4
    s_sub_u32 s7, s6, 20
    s_cselect_b32 s6, s6, s7
    s_mul_i32 s7, s6, 40960
    s_mul_i32 s6, s6, 5120
    s_add_u32 m0, s6, 61440
    s_nop 0
    buffer_load_dwordx4 v8, s[60:63], s7 offen lds
    s_add_u32 m0, s6, 62464
    s_nop 0
    buffer_load_dwordx4 v9, s[60:63], s7 offen lds
    s_add_u32 m0, s6, 63488
    s_nop 0
    buffer_load_dwordx4 v10, s[60:63], s7 offen lds
    s_add_u32 m0, s6, 64512
    s_nop 0
    buffer_load_dwordx4 v11, s[60:63], s7 offen lds
    s_add_u32 m0, s6, 65536
    s_nop 0
    buffer_load_dwordx4 v12, s[60:63], s7 offen lds
    s_add_u32 s4, s4, 3
    s_branch Lwo38
Lwx39:
    s_waitcnt vmcnt(0) lgkmcnt(0)
    s_branch L_convdone
L_in2:
    s_bfe_u32 s6, s2, 0x20005
    s_mul_i32 s6, s6, 320
    buffer_load_dwordx4 v[216:219], v234, s[52:55], s6 offen nt
    buffer_load_dwordx4 v[220:223], v235, s[52:55], s6 offen nt
    buffer_load_dwordx4 v[224:227], v236, s[52:55], s6 offen nt
    v_xor_b32 v208, 64, v208
    ds_read_b64 v[176:177], v208 offset:0
    v_xor_b32_e64 v209, 64, v209
    ds_read_b64 v[178:179], v209 offset:0
    v_xor_b32_e64 v214, 64, v214
    ds_read_b64 v[180:181], v214 offset:12288
    v_xor_b32_e64 v215, 64, v215
    ds_read_b64 v[182:183], v215 offset:12288
    v_xor_b32_e64 v210, 64, v210
    ds_read_b64 v[184:185], v210 offset:0
    v_xor_b32_e64 v211, 64, v211
    ds_read_b64 v[186:187], v211 offset:0
    v_xor_b32_e64 v212, 64, v212
    ds_read_b64 v[188:189], v212 offset:12288
    v_xor_b32_e64 v213, 64, v213
    ds_read_b64 v[190:191], v213 offset:12288
    ds_read_b64 v[192:193], v212 offset:0
    ds_read_b64 v[194:195], v213 offset:0
    ds_read_b64 v[196:197], v210 offset:12288
    ds_read_b64 v[198:199], v211 offset:12288
    s_waitcnt lgkmcnt(0)
    s_branch L_s1
L_in3:
    s_bfe_u32 s6, s2, 0x20005
    s_mul_i32 s6, s6, 320
    buffer_load_dwordx4 v[216:219], v234, s[52:55], s6 offen nt
    buffer_load_dwordx4 v[220:223], v235, s[52:55], s6 offen nt
    buffer_load_dwordx4 v[224:227], v236, s[52:55], s6 offen nt
    v_xor_b32 v208, 128, v208
    ds_read_b64 v[176:177], v208 offset:0
    v_xor_b32 v209, 128, v209
    ds_read_b64 v[178:179], v209 offset:0
    v_xor_b32 v214, 128, v214
    ds_read_b64 v[180:181], v214 offset:12288
    v_xor_b32 v215, 128, v215
    ds_read_b64 v[182:183], v215 offset:12288
    v_xor_b32 v210, 128, v210
    ds_read_b64 v[184:185], v210 offset:0
    v_xor_b32 v211, 128, v211
    ds_read_b64 v[186:187], v211 offset:0
    v_xor_b32 v212, 128, v212
    ds_read_b64 v[188:189], v212 offset:12288
    v_xor_b32 v213, 128, v213
    ds_read_b64 v[190:191], v213 offset:12288
    ds_read_b64 v[192:193], v212 offset:0
    ds_read_b64 v[194:195], v213 offset:0
    ds_read_b64 v[196:197], v210 offset:12288
    ds_read_b64 v[198:199], v211 offset:12288
    s_waitcnt lgkmcnt(0)
    s_branch L_s2
L_in4:
    s_mov_b32 s60, s22
    s_and_b32 s61, s23, 0xffff
    s_mov_b32 s62, 0xc8000
    s_mov_b32 s63, 0x20000
    s_sub_u32 s4, s43, 0x10
    s_lshl_b32 s4, s4, 6
    v_add_u32 v4, s4, v1
    v_mul_u32_u24 v5, 13108, v4
    v_lshrrev_b32_e64 v5, 16, v5
    v_mul_u32_u24 v5, 640, v5
    v_lshl_add_u32 v4, v4, 7, v5
    buffer_load_dword v255, v4, s[60:63], 0 offen
    s_sub_u32 s4, s43, 0x0
    s_lshl_b32 s4, s4, 6
    v_add_u32_e64 v4, s4, v1
    v_mul_u32_u24 v5, 13108, v4
    v_lshrrev_b32_e64 v5, 16, v5
    v_mul_u32_u24 v5, 640, v5
    v_lshl_add_u32 v4, v4, 7, v5
    buffer_load_dword v255, v4, s[60:63], 0 offen
    s_sub_u32 s4, s43, 0xfffffff0
    s_lshl_b32 s4, s4, 6
    v_add_u32_e64 v4, s4, v1
    v_mul_u32_u24 v5, 13108, v4
    v_lshrrev_b32_e64 v5, 16, v5
    v_mul_u32_u24 v5, 640, v5
    v_lshl_add_u32 v4, v4, 7, v5
    buffer_load_dword v255, v4, s[60:63], 0 offen
    s_sub_u32 s4, s43, 0xffffffe0
    s_lshl_b32 s4, s4, 6
    v_add_u32 v4, s4, v1
    v_mul_u32_u24 v5, 13108, v4
    v_lshrrev_b32_e64 v5, 16, v5
    v_mul_u32_u24 v5, 640, v5
    v_lshl_add_u32 v4, v4, 7, v5
    buffer_load_dword v255, v4, s[60:63], 0 offen
    s_bfe_u32 s6, s2, 0x20005
    s_mul_i32 s6, s6, 320
    buffer_load_dwordx4 v[216:219], v234, s[52:55], s6 offen nt
    buffer_load_dwordx4 v[220:223], v235, s[52:55], s6 offen nt
    buffer_load_dwordx4 v[224:227], v236, s[52:55], s6 offen nt
Ls40:
    s_sleep 2
    ds_read_b32 v9, v6
    s_waitcnt lgkmcnt(0)
    v_cmp_ne_u32 vcc, 3, v9
    s_cmp_eq_u32 s91, 0
    s_cbranch_scc1 Le41
    s_sub_u32 s91, s91, 1
    s_nop 1
    s_cbranch_vccnz Ls40
Le41:
    ds_read_b128 v[82:85], v2 offset:36864
    ds_read_b128 v[176:179], v2 offset:45056
    ds_read_b128 v[86:89], v2 offset:53248
    ds_read_b128 v[94:97], v2 offset:37888
    ds_read_b128 v[180:183], v2 offset:46080
    ds_read_b128 v[98:101], v2 offset:54272
    ds_read_b128 v[106:109], v2 offset:38912
    ds_read_b128 v[184:187], v2 offset:47104
    ds_read_b128 v[110:113], v2 offset:55296
    ds_read_b128 v[118:121], v2 offset:39936
    ds_read_b128 v[188:191], v2 offset:48128
    ds_read_b128 v[122:125], v2 offset:56320
    ds_read_b128 v[130:133], v2 offset:40960
    ds_read_b128 v[192:195], v2 offset:49152
    ds_read_b128 v[134:137], v2 offset:57344
    ds_read_b128 v[142:145], v2 offset:41984
    ds_read_b128 v[196:199], v2 offset:50176
    ds_read_b128 v[146:149], v2 offset:58368
    ds_read_b128 v[154:157], v2 offset:43008
    ds_read_b128 v[200:203], v2 offset:51200
    ds_read_b128 v[158:161], v2 offset:59392
    ds_read_b128 v[166:169], v2 offset:44032
    ds_read_b128 v[204:207], v2 offset:52224
    ds_read_b128 v[170:173], v2 offset:60416
    v_cmp_eq_u32 vcc, 63, v1
    s_waitcnt lgkmcnt(0)
    v_add_f32 v88, v88, v176
    v_add_f32 v89, v89, v177
    v_mov_b32 v90, v178
    v_mov_b32 v91, v179
    v_add_f32 v100, v100, v180
    v_add_f32 v101, v101, v181
    v_mov_b32 v102, v182
    v_mov_b32 v103, v183
    v_add_f32 v112, v112, v184
    v_add_f32 v113, v113, v185
    v_mov_b32 v114, v186
    v_mov_b32 v115, v187
    v_add_f32 v124, v124, v188
    v_add_f32 v125, v125, v189
    v_mov_b32 v126, v190
    v_mov_b32 v127, v191
    v_add_f32 v136, v136, v192
    v_add_f32 v137, v137, v193
    v_mov_b32 v138, v194
    v_mov_b32 v139, v195
    v_add_f32 v148, v148, v196
    v_add_f32 v149, v149, v197
    v_mov_b32 v150, v198
    v_mov_b32 v151, v199
    v_add_f32 v160, v160, v200
    v_add_f32 v161, v161, v201
    v_mov_b32 v162, v202
    v_mov_b32 v163, v203
    v_add_f32 v172, v172, v204
    v_add_f32 v173, v173, v205
    v_mov_b32 v174, v206
    v_mov_b32 v175, v207
    v_add_f32 v85, v85, v90
    v_cndmask_b32 v237, v91, v6, vcc
    v_cndmask_b32_e64 v81, v85, v6, vcc
    ds_bpermute_b32 v237, v248, v237
    ds_bpermute_b32 v81, v248, v81
    v_add_f32 v97, v97, v102
    v_cndmask_b32 v238, v103, v91, vcc
    v_cndmask_b32_e64 v93, v97, v85, vcc
    ds_bpermute_b32 v238, v248, v238
    ds_bpermute_b32 v93, v248, v93
    v_add_f32 v109, v109, v114
    v_cndmask_b32 v239, v115, v103, vcc
    v_cndmask_b32_e64 v105, v109, v97, vcc
    ds_bpermute_b32 v239, v248, v239
    ds_bpermute_b32 v105, v248, v105
    v_add_f32 v121, v121, v126
    v_cndmask_b32 v240, v127, v115, vcc
    v_cndmask_b32_e64 v117, v121, v109, vcc
    ds_bpermute_b32 v240, v248, v240
    ds_bpermute_b32 v117, v248, v117
    v_add_f32 v133, v133, v138
    v_cndmask_b32 v241, v139, v127, vcc
    v_cndmask_b32_e64 v129, v133, v121, vcc
    ds_bpermute_b32 v241, v248, v241
    ds_bpermute_b32 v129, v248, v129
    v_add_f32 v145, v145, v150
    v_cndmask_b32 v242, v151, v139, vcc
    v_cndmask_b32_e64 v141, v145, v133, vcc
    ds_bpermute_b32 v242, v248, v242
    ds_bpermute_b32 v141, v248, v141
    v_add_f32 v157, v157, v162
    v_cndmask_b32 v243, v163, v151, vcc
    v_cndmask_b32_e64 v153, v157, v145, vcc
    ds_bpermute_b32 v243, v248, v243
    ds_bpermute_b32 v153, v248, v153
    v_add_f32 v169, v169, v174
    v_cndmask_b32 v244, v175, v163, vcc
    v_cndmask_b32_e64 v165, v169, v157, vcc
    ds_bpermute_b32 v244, v248, v244
    ds_bpermute_b32 v165, v248, v165
    s_waitcnt lgkmcnt(14)
    v_add_f32 v82, v82, v237
    s_waitcnt lgkmcnt(12)
    v_add_f32 v94, v94, v238
    s_waitcnt lgkmcnt(10)
    v_add_f32 v106, v106, v239
    s_waitcnt lgkmcnt(8)
    v_add_f32 v118, v118, v240
    s_waitcnt lgkmcnt(6)
    v_add_f32 v130, v130, v241
    s_waitcnt lgkmcnt(4)
    v_add_f32 v142, v142, v242
    s_waitcnt lgkmcnt(2)
    v_add_f32 v154, v154, v243
    s_waitcnt lgkmcnt(0)
    v_add_f32 v166, v166, v244
    v_xor_b32_e64 v208, 64, v208
    ds_read_b64 v[176:177], v208 offset:0
    v_xor_b32_e64 v209, 64, v209
    ds_read_b64 v[178:179], v209 offset:0
    v_xor_b32_e64 v210, 64, v210
    ds_read_b64 v[180:181], v210 offset:0
    v_xor_b32_e64 v211, 64, v211
    ds_read_b64 v[182:183], v211 offset:0
    v_xor_b32_e64 v212, 64, v212
    ds_read_b64 v[184:185], v212 offset:0
    v_xor_b32_e64 v213, 64, v213
    ds_read_b64 v[186:187], v213 offset:0
    v_xor_b32_e64 v214, 64, v214
    ds_read_b64 v[188:189], v214 offset:0
    v_xor_b32_e64 v215, 64, v215
    ds_read_b64 v[190:191], v215 offset:0
    ds_read_b64 v[192:193], v208 offset:4096
    ds_read_b64 v[194:195], v209 offset:4096
    ds_read_b64 v[196:197], v210 offset:4096
    ds_read_b64 v[198:199], v211 offset:4096
    s_waitcnt lgkmcnt(0)
    s_branch L_s3
L_convdone:
    s_mov_b32 s52, s36
    s_and_b32 s53, s37, 0xffff
    s_mov_b32 s54, 0x500000
    s_mov_b32 s55, 0x20000
    v_lshrrev_b32 v2, 3, v1
    v_and_b32_e64 v3, 7, v1
    v_bfe_u32 v4, v2, 1, 1
    v_lshlrev_b32 v4, 2, v4
    v_xor_b32 v3, v3, v4
    v_lshlrev_b32_e64 v3, 4, v3
    v_lshl_add_u32 v244, v2, 12, v3
    s_bfe_u32 s64, s2, 0x20005
    s_lshl_b32 s14, s64, 3
    s_add_u32 s14, s14, s3
    s_mul_i32 s14, s14, 81920
    s_and_b32 s5, s2, 31
    s_lshl_b32 s5, s5, 7
    s_add_u32 s14, s14, s5
    s_add_u32 s14, s14, 0x940000
    v_bfe_u32 v4, v1, 2, 2
    v_lshrrev_b32 v5, 4, v1
    v_and_b32_e64 v6, 3, v1
    v_lshl_add_u32 v5, v5, 2, v6
    v_lshrrev_b32 v6, 1, v4
    v_lshlrev_b32 v6, 3, v6
    v_xor_b32 v5, v5, v6
    v_lshlrev_b32 v5, 3, v5
    v_lshl_add_u32 v5, v4, 7, v5
    s_mul_i32 s68, s3, 2560
    v_add_u32_e64 v245, s68, v5
    v_mul_u32_u24 v6, 336, v1
    s_mul_i32 s4, s3, 40
    s_add_u32 s4, s4, 20480
    v_add_u32 v246, s4, v6
    s_mul_i32 s66, s64, 320
    s_add_u32 s66, s66, 1280
    s_mov_b32 s67, 0xffff0000
    s_lshl3_add_u32 s13, s64, s42
    s_lshl_b32 s13, s13, 1
    s_add_u32 s13, s13, 320
    s_mov_b32 s90, s9
    s_mov_b32 s52, s36
    s_and_b32 s53, s37, 0xffff
    s_mov_b32 s54, 0x500000
    s_mov_b32 s55, 0x20000
    s_lshl_b32 s64, s42, 2
    s_and_b32 s4, s43, 3
    s_add_u32 s64, s64, s4
    s_lshr_b32 s65, s43, 2
    s_and_b32 s8, s3, 3
    s_lshr_b32 s9, s3, 2
    s_lshl_b32 s4, s64, 2
    s_add_u32 s4, s4, s8
    s_mul_i32 s12, s4, 40960
    s_mul_i32 s6, s65, 160
    s_add_u32 s12, s12, s6
    s_lshr_b32 s10, s4, 1
    s_lshl_b32 s10, s10, 10
    s_and_b32 s6, s4, 1
    s_lshl_b32 s6, s6, 8
    s_add_u32 s10, s10, s6
    s_lshl_b32 s6, s9, 20
    s_add_u32 s10, s10, s6
    s_add_u32 s10, s10, 0x280000
    s_lshl_b32 s11, s4, 7
    s_lshl_b32 s7, s9, 18
    s_add_u32 s11, s11, s7
    s_add_u32 s11, s11, 0x480000
    v_and_b32 v2, 15, v1
    v_lshrrev_b32 v3, 4, v1
    v_lshrrev_b32 v4, 5, v1
    v_and_b32 v5, 1, v3
    v_lshlrev_b32 v6, 4, v2
    v_lshl_add_u32 v6, v5, 9, v6
    v_lshl_add_u32 v6, v4, 16, v6
    v_lshlrev_b32_e64 v7, 3, v2
    v_lshl_add_u32 v7, v3, 14, v7
    v_bfe_u32 v8, v1, 2, 2
    v_and_b32_e64 v9, 3, v1
    s_mul_i32 s7, s9, 51200
    s_add_u32 s7, s7, 61440
    v_lshl_add_u32 v9, v9, 3, s7
    v_mul_u32_u24_e64 v11, 20, v3
    v_add3_u32 v11, v11, v8, 16
    v_mul_u32_u24 v11, 160, v11
    v_add_u32 v11, v11, v9
    s_lshl_b32 s4, s8, 12
    s_add_u32 s4, s4, 41984
    v_lshl_add_u32 v8, v1, 4, s4
    s_mul_i32 s4, s8, 2560
    v_lshl_add_u32 v236, v1, 4, s4
    s_add_u32 s4, s4, 10240
    v_mul_u32_u24 v9, 160, v2
    v_lshl_add_u32 v9, v3, 3, v9
    v_add_u32 v9, s4, v9
    v_add_u32 v10, 0, v1
    v_mul_u32_u24 v13, 6554, v10
    v_lshrrev_b32_e64 v13, 16, v13
    v_mul_u32_u24 v12, 2400, v13
    v_lshl_add_u32 v240, v10, 4, v12
    v_add_u32_e64 v10, 64, v1
    v_mul_u32_u24 v13, 6554, v10
    v_lshrrev_b32_e64 v13, 16, v13
    v_mul_u32_u24 v12, 2400, v13
    v_lshl_add_u32 v241, v10, 4, v12
    v_add_u32 v10, 128, v1
    v_mul_u32_u24 v13, 6554, v10
    v_lshrrev_b32_e64 v13, 16, v13
    v_mul_u32_u24 v12, 2400, v13
    v_lshl_add_u32 v242, v10, 4, v12
    v_cmp_gt_u32_e64 vcc, 32, v1
    v_mov_b32 v10, 0x80000000
    s_nop 0
    v_cndmask_b32 v242, v10, v242, vcc
    s_waitcnt vmcnt(0)
    s_barrier
    s_and_b32 s4, s3, 3
    s_cmp_lg_u32 s4, 0
    s_cbranch_scc1 L_y2
    s_cmp_eq_u32 s3, 0
    s_cselect_b32 s7, 1, 4
    s_mul_i32 s15, s90, 205
    s_lshr_b32 s15, s15, 13
    s_lshl_b32 s15, s15, 4
    s_and_b32 s5, s43, 1
    s_add_u32 s15, s15, s5
    s_add_u32 s15, s15, 320
    s_lshl_b32 s4, s15, 8
    s_add_u32 s4, s4, 0xbc0000
    s_add_u32 s96, s40, s4
    s_addc_u32 s97, s41, 0
    s_mov_b32 s100, s7
    s_nop 0
    s_atomic_add s100, s[96:97], 0
    s_atomic_add s100, s[96:97], 512
    s_atomic_add s100, s[96:97], 1024
    s_atomic_add s100, s[96:97], 1536
    s_atomic_add s100, s[96:97], 2048
    s_atomic_add s100, s[96:97], 2560
    s_atomic_add s100, s[96:97], 3072
    s_atomic_add s100, s[96:97], 3584
L_y2:
    s_branch L_a3pre3
L_a3pre2:
    s_mov_b32 s13, 0
    v_bfrev_b32 v228, 1
    v_bfrev_b32 v229, 1
    v_bfrev_b32 v230, 1
    v_bfrev_b32 v244, 1
L_a3pre3:
    s_lshr_b32 s9, s3, 2
    s_lshr_b32 s65, s43, 2
    v_lshrrev_b32_e64 v13, 5, v1
    v_bfe_u32 v14, v1, 4, 1
    v_bfe_u32 v15, v1, 2, 2
    v_and_b32_e64 v4, 3, v1
    s_mul_i32 s7, s9, 51200
    s_add_u32 s7, s7, 61440
    v_lshl_add_u32 v4, v4, 3, s7
    v_mul_u32_u24_e64 v10, 20, v13
    v_lshl_add_u32 v10, v14, 2, v10
    v_add_u32_e64 v10, v10, v15
    v_mul_u32_u24 v10, 160, v10
    v_add_u32 v10, v10, v4
    s_add_u32 s4, s65, 0
    s_and_b32 s4, s4, 7
    s_mul_i32 s4, s4, 6400
    v_add_u32 v12, s4, v10
    ds_read_b64_tr_b16 v[76:77], v12 offset:0
    ds_read_b64_tr_b16 v[78:79], v12 offset:1280
    ds_read_b64_tr_b16 v[80:81], v12 offset:32
    ds_read_b64_tr_b16 v[82:83], v12 offset:1312
    ds_read_b64_tr_b16 v[84:85], v12 offset:64
    ds_read_b64_tr_b16 v[86:87], v12 offset:1344
    ds_read_b64_tr_b16 v[88:89], v12 offset:96
    ds_read_b64_tr_b16 v[90:91], v12 offset:1376
    ds_read_b64_tr_b16 v[92:93], v12 offset:128
    ds_read_b64_tr_b16 v[94:95], v12 offset:1408
    s_add_u32 s4, s65, 1
    s_and_b32 s4, s4, 7
    s_mul_i32 s4, s4, 6400
    v_add_u32_e64 v12, s4, v10
    ds_read_b64_tr_b16 v[96:97], v12 offset:0
    ds_read_b64_tr_b16 v[98:99], v12 offset:1280
    ds_read_b64_tr_b16 v[100:101], v12 offset:32
    ds_read_b64_tr_b16 v[102:103], v12 offset:1312
    ds_read_b64_tr_b16 v[104:105], v12 offset:64
    ds_read_b64_tr_b16 v[106:107], v12 offset:1344
    ds_read_b64_tr_b16 v[108:109], v12 offset:96
    ds_read_b64_tr_b16 v[110:111], v12 offset:1376
    ds_read_b64_tr_b16 v[112:113], v12 offset:128
    ds_read_b64_tr_b16 v[114:115], v12 offset:1408
    s_add_u32 s4, s65, 2
    s_and_b32 s4, s4, 7
    s_mul_i32 s4, s4, 6400
    v_add_u32_e64 v12, s4, v10
    ds_read_b64_tr_b16 v[116:117], v12 offset:0
    ds_read_b64_tr_b16 v[118:119], v12 offset:1280
    ds_read_b64_tr_b16 v[120:121], v12 offset:32
    ds_read_b64_tr_b16 v[122:123], v12 offset:1312
    ds_read_b64_tr_b16 v[124:125], v12 offset:64
    ds_read_b64_tr_b16 v[126:127], v12 offset:1344
    ds_read_b64_tr_b16 v[128:129], v12 offset:96
    ds_read_b64_tr_b16 v[130:131], v12 offset:1376
    ds_read_b64_tr_b16 v[132:133], v12 offset:128
    ds_read_b64_tr_b16 v[134:135], v12 offset:1408
    s_add_u32 s4, s65, 3
    s_and_b32 s4, s4, 7
    s_mul_i32 s4, s4, 6400
    v_add_u32_e64 v12, s4, v10
    ds_read_b64_tr_b16 v[136:137], v12 offset:0
    ds_read_b64_tr_b16 v[138:139], v12 offset:1280
    ds_read_b64_tr_b16 v[140:141], v12 offset:32
    ds_read_b64_tr_b16 v[142:143], v12 offset:1312
    ds_read_b64_tr_b16 v[144:145], v12 offset:64
    ds_read_b64_tr_b16 v[146:147], v12 offset:1344
    ds_read_b64_tr_b16 v[148:149], v12 offset:96
    ds_read_b64_tr_b16 v[150:151], v12 offset:1376
    ds_read_b64_tr_b16 v[152:153], v12 offset:128
    ds_read_b64_tr_b16 v[154:155], v12 offset:1408
    s_add_u32 s4, s65, 4
    s_and_b32 s4, s4, 7
    s_mul_i32 s4, s4, 6400
    v_add_u32_e64 v12, s4, v10
    ds_read_b64_tr_b16 v[156:157], v12 offset:0
    ds_read_b64_tr_b16 v[158:159], v12 offset:1280
    ds_read_b64_tr_b16 v[160:161], v12 offset:32
    ds_read_b64_tr_b16 v[162:163], v12 offset:1312
    ds_read_b64_tr_b16 v[164:165], v12 offset:64
    ds_read_b64_tr_b16 v[166:167], v12 offset:1344
    ds_read_b64_tr_b16 v[168:169], v12 offset:96
    ds_read_b64_tr_b16 v[170:171], v12 offset:1376
    ds_read_b64_tr_b16 v[172:173], v12 offset:128
    ds_read_b64_tr_b16 v[174:175], v12 offset:1408
    s_add_u32 s4, s65, 5
    s_and_b32 s4, s4, 7
    s_mul_i32 s4, s4, 6400
    v_add_u32_e64 v12, s4, v10
    ds_read_b64_tr_b16 v[176:177], v12 offset:0
    ds_read_b64_tr_b16 v[178:179], v12 offset:1280
    ds_read_b64_tr_b16 v[180:181], v12 offset:32
    ds_read_b64_tr_b16 v[182:183], v12 offset:1312
    ds_read_b64_tr_b16 v[184:185], v12 offset:64
    ds_read_b64_tr_b16 v[186:187], v12 offset:1344
    ds_read_b64_tr_b16 v[188:189], v12 offset:96
    ds_read_b64_tr_b16 v[190:191], v12 offset:1376
    ds_read_b64_tr_b16 v[192:193], v12 offset:128
    ds_read_b64_tr_b16 v[194:195], v12 offset:1408
    s_add_u32 s4, s65, 6
    s_and_b32 s4, s4, 7
    s_mul_i32 s4, s4, 6400
    v_add_u32_e64 v12, s4, v10
    ds_read_b64_tr_b16 v[196:197], v12 offset:0
    ds_read_b64_tr_b16 v[198:199], v12 offset:1280
    ds_read_b64_tr_b16 v[200:201], v12 offset:32
    ds_read_b64_tr_b16 v[202:203], v12 offset:1312
    ds_read_b64_tr_b16 v[204:205], v12 offset:64
    ds_read_b64_tr_b16 v[206:207], v12 offset:1344
    ds_read_b64_tr_b16 v[208:209], v12 offset:96
    ds_read_b64_tr_b16 v[210:211], v12 offset:1376
    ds_read_b64_tr_b16 v[212:213], v12 offset:128
    ds_read_b64_tr_b16 v[214:215], v12 offset:1408
    s_add_u32 s4, s65, 7
    s_and_b32 s4, s4, 7
    s_mul_i32 s4, s4, 6400
    v_add_u32 v243, s4, v10
    s_lshl_b32 s15, s42, 1
    s_bfe_u32 s4, s43, 0x10001
    s_add_u32 s15, s15, s4
    s_lshl_b32 s15, s15, 2
    s_bfe_u32 s4, s43, 0x20002
    s_add_u32 s15, s15, s4
    s_lshl_b32 s15, s15, 1
    s_add_u32 s15, s15, 192
    s_lshl_b32 s4, s15, 8
    s_add_u32 s4, s4, 0xbc0000
    s_add_u32 s92, s40, s4
    s_addc_u32 s93, s41, 0
    s_waitcnt lgkmcnt(0)
    s_mov_b32 s15, s13
    s_lshl_b32 s4, s15, 8
    s_add_u32 s4, s4, 0xbc0000
    s_add_u32 s96, s40, s4
    s_addc_u32 s97, s41, 0
    v_mov_b32 v5, 61424
    s_cmp_eq_u32 s69, 0
    s_cselect_b32 s13, 2, 3
    s_cmp_eq_u32 s69, 0
    s_cselect_b32 s64, 0, 1
    s_mov_b64 s[98:99], 0
    s_mov_b64 s[94:95], 0
L_t0:
    s_cmp_lg_u32 s3, s64
    s_cbranch_scc1 L_t2
    s_mov_b32 s101, 0
    s_branch L_t6
L_t1:
    s_mov_b64 s[98:99], 0
    s_mov_b64 s[94:95], 0
    s_bitcmp1_b32 s13, 0
    s_cbranch_scc0 Lt42
    s_mov_b32 s98, 0
    s_mov_b32 s99, 0
    s_atomic_add s98, s[96:97], 0 glc
    s_atomic_add s99, s[96:97], 256 glc
Lt42:
    s_bitcmp1_b32 s13, 1
    s_cbranch_scc0 Lt43
    s_mov_b32 s94, 0
    s_mov_b32 s95, 0
    s_atomic_add s94, s[92:93], 0 glc
    s_atomic_add s95, s[92:93], 256 glc
Lt43:
    s_add_u32 s101, s101, 1
L_t6:
    s_waitcnt lgkmcnt(0)
    s_add_u32 s4, s98, s99
    s_cmp_eq_u32 s4, 160
    s_cselect_b32 s4, 1, 0
    s_add_u32 s5, s94, s95
    s_cmp_eq_u32 s5, 32
    s_cselect_b32 s5, 2, 0
    s_or_b32 s4, s4, s5
    s_cbranch_scc1 L_t3
    s_cmp_lt_u32 s101, 400000
    s_cbranch_scc1 L_t1
    s_mov_b32 s4, s13
L_t3:
    v_mov_b32 v4, s4
    ds_write_b32 v5, v4
L_t2:
    s_waitcnt lgkmcnt(0)
    s_barrier
    ds_read_b32 v4, v5
    s_waitcnt lgkmcnt(0)
    v_readfirstlane_b32 s15, v4
    s_nop 0
    s_andn2_b32 s13, s13, s15
    s_bitcmp1_b32 s15, 0
    s_cbranch_scc0 L_p1
    s_add_u32 m0, s68, 0
    s_nop 0
    buffer_load_dwordx4 v244, s[44:47], s14 offen sc1 lds
    s_add_u32 s14, s14, 0x8000
    s_add_u32 m0, s68, 1024
    s_nop 0
    buffer_load_dwordx4 v244, s[44:47], s14 offen sc1 lds
    s_add_u32 s14, s14, 0x8000
    s_add_u32 m0, s68, 2048
    s_mov_b32 exec_hi, 0
    buffer_load_dwordx4 v244, s[44:47], s14 offen sc1 lds
    s_add_u32 s14, s14, 0x8000
    s_mov_b64 exec, -1
L_p1:
    s_bitcmp1_b32 s15, 1
    s_cbranch_scc0 L_p2
    s_add_u32 s4, s65, 0
    s_and_b32 s4, s4, 7
    s_lshl_b32 s4, s4, 17
    s_add_u32 s4, s4, s10
    buffer_load_dwordx4 v[16:19], v6, s[44:47], s4 offen sc1
    s_add_u32 s4, s65, 1
    s_and_b32 s4, s4, 7
    s_lshl_b32 s4, s4, 17
    s_add_u32 s4, s4, s10
    buffer_load_dwordx4 v[20:23], v6, s[44:47], s4 offen sc1
    s_add_u32 s4, s65, 2
    s_and_b32 s4, s4, 7
    s_lshl_b32 s4, s4, 17
    s_add_u32 s4, s4, s10
    buffer_load_dwordx4 v[24:27], v6, s[44:47], s4 offen sc1
    s_add_u32 s4, s65, 3
    s_and_b32 s4, s4, 7
    s_lshl_b32 s4, s4, 17
    s_add_u32 s4, s4, s10
    buffer_load_dwordx4 v[28:31], v6, s[44:47], s4 offen sc1
    s_add_u32 s4, s65, 4
    s_and_b32 s4, s4, 7
    s_lshl_b32 s4, s4, 17
    s_add_u32 s4, s4, s10
    buffer_load_dwordx4 v[32:35], v6, s[44:47], s4 offen sc1
    s_add_u32 s4, s65, 5
    s_and_b32 s4, s4, 7
    s_lshl_b32 s4, s4, 17
    s_add_u32 s4, s4, s10
    buffer_load_dwordx4 v[36:39], v6, s[44:47], s4 offen sc1
    s_add_u32 s4, s65, 6
    s_and_b32 s4, s4, 7
    s_lshl_b32 s4, s4, 17
    s_add_u32 s4, s4, s10
    buffer_load_dwordx4 v[40:43], v6, s[44:47], s4 offen sc1
    s_add_u32 s4, s65, 7
    s_and_b32 s4, s4, 7
    s_lshl_b32 s4, s4, 17
    s_add_u32 s4, s4, s10
    s_nop 0
    buffer_load_dwordx4 v[44:47], v6, s[44:47], s4 offen sc1
    buffer_load_dwordx2 v[48:49], v7, s[44:47], s11 offen sc1
    s_add_u32 s11, s11, 0x10000
    buffer_load_dwordx2 v[50:51], v7, s[44:47], s11 offen sc1
    s_add_u32 s11, s11, 0x10000
    buffer_load_dwordx2 v[52:53], v7, s[44:47], s11 offen sc1
    s_add_u32 s11, s11, 0x10000
    buffer_load_dwordx2 v[54:55], v7, s[44:47], s11 offen sc1
    s_add_u32 s11, s11, 0x10000
    s_waitcnt vmcnt(12)
    s_branch L_p3
L_p2:
    s_waitcnt vmcnt(0)
L_p3:
    s_bitcmp1_b32 s15, 0
    s_cbranch_scc0 L_p4
    s_nop 0
    ds_read_b64_tr_b16 v[56:57], v245 offset:0
    ds_read_b64_tr_b16 v[58:59], v245 offset:512
    ds_read_b64_tr_b16 v[60:61], v245 offset:1024
    ds_read_b64_tr_b16 v[62:63], v245 offset:1536
    ds_read_b64_tr_b16 v[64:65], v245 offset:2048
    s_waitcnt lgkmcnt(4)
    ds_write_b64 v246, v[56:57] offset:0
    s_waitcnt lgkmcnt(4)
    ds_write_b64 v246, v[58:59] offset:8
    s_waitcnt lgkmcnt(4)
    ds_write_b64 v246, v[60:61] offset:16
    s_waitcnt lgkmcnt(4)
    ds_write_b64 v246, v[62:63] offset:24
    s_waitcnt lgkmcnt(4)
    ds_write_b64 v246, v[64:65] offset:32
L_p4:
    s_waitcnt lgkmcnt(0)
    s_bitcmp1_b32 s15, 1
    s_cbranch_scc0 L_p5
    s_waitcnt vmcnt(11)
    v_mfma_f32_16x16x32_bf16 v[56:59], v[76:79], v[16:19], 0
    v_mfma_f32_16x16x32_bf16 v[60:63], v[80:83], v[16:19], 0
    v_mfma_f32_16x16x32_bf16 v[64:67], v[84:87], v[16:19], 0
    v_mfma_f32_16x16x32_bf16 v[68:71], v[88:91], v[16:19], 0
    v_mfma_f32_16x16x32_bf16 v[72:75], v[92:95], v[16:19], 0
    s_waitcnt vmcnt(10)
    v_mfma_f32_16x16x32_bf16 v[56:59], v[96:99], v[20:23], v[56:59]
    v_mfma_f32_16x16x32_bf16 v[60:63], v[100:103], v[20:23], v[60:63]
    v_mfma_f32_16x16x32_bf16 v[64:67], v[104:107], v[20:23], v[64:67]
    v_mfma_f32_16x16x32_bf16 v[68:71], v[108:111], v[20:23], v[68:71]
    v_mfma_f32_16x16x32_bf16 v[72:75], v[112:115], v[20:23], v[72:75]
    ds_read_b64_tr_b16 v[76:77], v243 offset:0
    ds_read_b64_tr_b16 v[78:79], v243 offset:1280
    ds_read_b64_tr_b16 v[80:81], v243 offset:32
    ds_read_b64_tr_b16 v[82:83], v243 offset:1312
    ds_read_b64_tr_b16 v[84:85], v243 offset:64
    ds_read_b64_tr_b16 v[86:87], v243 offset:1344
    ds_read_b64_tr_b16 v[88:89], v243 offset:96
    ds_read_b64_tr_b16 v[90:91], v243 offset:1376
    ds_read_b64_tr_b16 v[92:93], v243 offset:128
    ds_read_b64_tr_b16 v[94:95], v243 offset:1408
    s_waitcnt vmcnt(9)
    v_mfma_f32_16x16x32_bf16 v[56:59], v[116:119], v[24:27], v[56:59]
    v_mfma_f32_16x16x32_bf16 v[60:63], v[120:123], v[24:27], v[60:63]
    v_mfma_f32_16x16x32_bf16 v[64:67], v[124:127], v[24:27], v[64:67]
    v_mfma_f32_16x16x32_bf16 v[68:71], v[128:131], v[24:27], v[68:71]
    v_mfma_f32_16x16x32_bf16 v[72:75], v[132:135], v[24:27], v[72:75]
    ds_read_b64_tr_b16 v[96:97], v11 offset:0
    ds_read_b64_tr_b16 v[98:99], v11 offset:12800
    ds_read_b64_tr_b16 v[100:101], v11 offset:32
    ds_read_b64_tr_b16 v[102:103], v11 offset:12832
    ds_read_b64_tr_b16 v[104:105], v11 offset:64
    ds_read_b64_tr_b16 v[106:107], v11 offset:12864
    ds_read_b64_tr_b16 v[108:109], v11 offset:96
    ds_read_b64_tr_b16 v[110:111], v11 offset:12896
    ds_read_b64_tr_b16 v[112:113], v11 offset:128
    ds_read_b64_tr_b16 v[114:115], v11 offset:12928
    s_waitcnt vmcnt(8)
    v_mfma_f32_16x16x32_bf16 v[56:59], v[136:139], v[28:31], v[56:59]
    v_mfma_f32_16x16x32_bf16 v[60:63], v[140:143], v[28:31], v[60:63]
    v_mfma_f32_16x16x32_bf16 v[64:67], v[144:147], v[28:31], v[64:67]
    v_mfma_f32_16x16x32_bf16 v[68:71], v[148:151], v[28:31], v[68:71]
    v_mfma_f32_16x16x32_bf16 v[72:75], v[152:155], v[28:31], v[72:75]
    ds_read_b64_tr_b16 v[116:117], v11 offset:25600
    ds_read_b64_tr_b16 v[118:119], v11 offset:38400
    ds_read_b64_tr_b16 v[120:121], v11 offset:25632
    ds_read_b64_tr_b16 v[122:123], v11 offset:38432
    ds_read_b64_tr_b16 v[124:125], v11 offset:25664
    ds_read_b64_tr_b16 v[126:127], v11 offset:38464
    ds_read_b64_tr_b16 v[128:129], v11 offset:25696
    ds_read_b64_tr_b16 v[130:131], v11 offset:38496
    ds_read_b64_tr_b16 v[132:133], v11 offset:25728
    ds_read_b64_tr_b16 v[134:135], v11 offset:38528
    s_waitcnt vmcnt(7)
    v_mfma_f32_16x16x32_bf16 v[56:59], v[156:159], v[32:35], v[56:59]
    v_mfma_f32_16x16x32_bf16 v[60:63], v[160:163], v[32:35], v[60:63]
    v_mfma_f32_16x16x32_bf16 v[64:67], v[164:167], v[32:35], v[64:67]
    v_mfma_f32_16x16x32_bf16 v[68:71], v[168:171], v[32:35], v[68:71]
    v_mfma_f32_16x16x32_bf16 v[72:75], v[172:175], v[32:35], v[72:75]
    s_waitcnt vmcnt(6)
    v_mfma_f32_16x16x32_bf16 v[56:59], v[176:179], v[36:39], v[56:59]
    v_mfma_f32_16x16x32_bf16 v[60:63], v[180:183], v[36:39], v[60:63]
    v_mfma_f32_16x16x32_bf16 v[64:67], v[184:187], v[36:39], v[64:67]
    v_mfma_f32_16x16x32_bf16 v[68:71], v[188:191], v[36:39], v[68:71]
    v_mfma_f32_16x16x32_bf16 v[72:75], v[192:195], v[36:39], v[72:75]
    s_waitcnt vmcnt(5)
    v_mfma_f32_16x16x32_bf16 v[56:59], v[196:199], v[40:43], v[56:59]
    v_mfma_f32_16x16x32_bf16 v[60:63], v[200:203], v[40:43], v[60:63]
    v_mfma_f32_16x16x32_bf16 v[64:67], v[204:207], v[40:43], v[64:67]
    v_mfma_f32_16x16x32_bf16 v[68:71], v[208:211], v[40:43], v[68:71]
    v_mfma_f32_16x16x32_bf16 v[72:75], v[212:215], v[40:43], v[72:75]
    s_waitcnt vmcnt(4)
    s_waitcnt lgkmcnt(15)
    v_mfma_f32_16x16x32_bf16 v[56:59], v[76:79], v[44:47], v[56:59]
    v_mfma_f32_16x16x32_bf16 v[60:63], v[80:83], v[44:47], v[60:63]
    v_mfma_f32_16x16x32_bf16 v[64:67], v[84:87], v[44:47], v[64:67]
    v_mfma_f32_16x16x32_bf16 v[68:71], v[88:91], v[44:47], v[68:71]
    v_mfma_f32_16x16x32_bf16 v[72:75], v[92:95], v[44:47], v[72:75]
    s_waitcnt vmcnt(2)
    v_mfma_f32_16x16x32_bf16 v[56:59], v[96:99], v[48:51], v[56:59]
    v_mfma_f32_16x16x32_bf16 v[60:63], v[100:103], v[48:51], v[60:63]
    s_waitcnt lgkmcnt(14)
    v_mfma_f32_16x16x32_bf16 v[64:67], v[104:107], v[48:51], v[64:67]
    s_waitcnt lgkmcnt(12)
    v_mfma_f32_16x16x32_bf16 v[68:71], v[108:111], v[48:51], v[68:71]
    s_waitcnt lgkmcnt(10)
    v_mfma_f32_16x16x32_bf16 v[72:75], v[112:115], v[48:51], v[72:75]
    s_waitcnt vmcnt(0)
    s_waitcnt lgkmcnt(8)
    v_mfma_f32_16x16x32_bf16 v[56:59], v[116:119], v[52:55], v[56:59]
    s_waitcnt lgkmcnt(6)
    v_mfma_f32_16x16x32_bf16 v[60:63], v[120:123], v[52:55], v[60:63]
    s_waitcnt lgkmcnt(4)
    v_mfma_f32_16x16x32_bf16 v[64:67], v[124:127], v[52:55], v[64:67]
    s_waitcnt lgkmcnt(2)
    v_mfma_f32_16x16x32_bf16 v[68:71], v[128:131], v[52:55], v[68:71]
    s_waitcnt lgkmcnt(0)
    v_mfma_f32_16x16x32_bf16 v[72:75], v[132:135], v[52:55], v[72:75]
    s_cmp_eq_u32 s9, 1
    s_cbranch_scc1 L_p5
    ds_write_b128 v8, v[56:59] offset:0
    ds_write_b128 v8, v[60:63] offset:1024
    ds_write_b128 v8, v[64:67] offset:2048
    s_nop 0
    ds_write_b128 v8, v[68:71] offset:3072
    s_nop 0
    ds_write_b128 v236, v[72:75]
    s_waitcnt lgkmcnt(0)
L_p5:
    s_barrier
    s_cmp_lg_u32 s3, s64
    s_cbranch_scc1 L_p8
    s_mov_b64 s[98:99], 0
    s_mov_b64 s[94:95], 0
    s_bitcmp1_b32 s13, 0
    s_cbranch_scc0 Lt44
    s_mov_b32 s98, 0
    s_mov_b32 s99, 0
    s_atomic_add s98, s[96:97], 0 glc
    s_atomic_add s99, s[96:97], 256 glc
Lt44:
    s_bitcmp1_b32 s13, 1
    s_cbranch_scc0 Lt45
    s_mov_b32 s94, 0
    s_mov_b32 s95, 0
    s_atomic_add s94, s[92:93], 0 glc
    s_atomic_add s95, s[92:93], 256 glc
Lt45:
L_p8:
    s_lshr_b32 s4, s15, 1
    s_and_b32 s4, s4, s9
    s_cbranch_scc0 L_p6
    ds_read_b128 v[76:79], v8 offset:0
    ds_read_b128 v[80:83], v8 offset:1024
    ds_read_b128 v[84:87], v8 offset:2048
    ds_read_b128 v[88:91], v8 offset:3072
    ds_read_b128 v[92:95], v236
    s_waitcnt lgkmcnt(4)
    s_nop 0
    v_pk_add_f32 v[56:57], v[56:57], v[76:77]
    v_pk_add_f32 v[58:59], v[58:59], v[78:79]
    v_cvt_pk_bf16_f32 v96, v56, v57
    v_cvt_pk_bf16_f32 v97, v58, v59
    ds_write_b64 v9, v[96:97] offset:0
    s_waitcnt lgkmcnt(4)
    s_nop 0
    v_pk_add_f32 v[60:61], v[60:61], v[80:81]
    v_pk_add_f32 v[62:63], v[62:63], v[82:83]
    v_cvt_pk_bf16_f32 v98, v60, v61
    v_cvt_pk_bf16_f32 v99, v62, v63
    ds_write_b64 v9, v[98:99] offset:32
    s_waitcnt lgkmcnt(4)
    s_nop 0
    v_pk_add_f32 v[64:65], v[64:65], v[84:85]
    v_pk_add_f32 v[66:67], v[66:67], v[86:87]
    v_cvt_pk_bf16_f32 v100, v64, v65
    v_cvt_pk_bf16_f32 v101, v66, v67
    ds_write_b64 v9, v[100:101] offset:64
    s_waitcnt lgkmcnt(4)
    s_nop 0
    v_pk_add_f32 v[68:69], v[68:69], v[88:89]
    v_pk_add_f32 v[70:71], v[70:71], v[90:91]
    v_cvt_pk_bf16_f32 v102, v68, v69
    v_cvt_pk_bf16_f32 v103, v70, v71
    ds_write_b64 v9, v[102:103] offset:96
    s_waitcnt lgkmcnt(4)
    s_nop 0
    v_pk_add_f32 v[72:73], v[72:73], v[92:93]
    v_pk_add_f32 v[74:75], v[74:75], v[94:95]
    v_cvt_pk_bf16_f32 v104, v72, v73
    v_cvt_pk_bf16_f32 v105, v74, v75
    ds_write_b64 v9, v[104:105] offset:128
    ds_read_b128 v[108:111], v236 offset:10240
    ds_read_b128 v[112:115], v236 offset:11264
    ds_read_b128 v[116:119], v236 offset:12288
    s_waitcnt lgkmcnt(2)
    buffer_store_dwordx4 v[108:111], v240, s[52:55], s12 offen
    s_waitcnt lgkmcnt(1)
    buffer_store_dwordx4 v[112:115], v241, s[52:55], s12 offen
    s_waitcnt lgkmcnt(0)
    buffer_store_dwordx4 v[116:119], v242, s[52:55], s12 offen
L_p6:
    s_bitcmp1_b32 s15, 0
    s_cbranch_scc0 L_p7
    ds_read_b128 v[16:19], v231
    ds_read_b128 v[20:23], v232
    ds_read_b128 v[24:27], v233
    v_lshlrev_b32 v28, 16, v216
    v_and_b32 v29, s67, v216
    v_lshlrev_b32 v32, 16, v217
    v_and_b32 v33, s67, v217
    v_lshlrev_b32 v36, 16, v218
    v_and_b32 v37, s67, v218
    v_lshlrev_b32 v40, 16, v219
    v_and_b32 v41, s67, v219
    s_waitcnt lgkmcnt(2)
    v_lshlrev_b32 v30, 16, v16
    v_and_b32 v31, s67, v16
    v_lshlrev_b32 v34, 16, v17
    v_and_b32 v35, s67, v17
    v_lshlrev_b32 v38, 16, v18
    v_and_b32 v39, s67, v18
    v_lshlrev_b32 v42, 16, v19
    v_and_b32 v43, s67, v19
    v_pk_mul_f32 v[28:29], v[28:29], v[30:31]
    v_pk_mul_f32 v[32:33], v[32:33], v[34:35]
    v_pk_mul_f32 v[36:37], v[36:37], v[38:39]
    v_pk_mul_f32 v[40:41], v[40:41], v[42:43]
    v_cvt_pk_bf16_f32 v216, v28, v29
    v_cvt_pk_bf16_f32 v217, v32, v33
    v_cvt_pk_bf16_f32 v218, v36, v37
    v_cvt_pk_bf16_f32 v219, v40, v41
    buffer_store_dwordx4 v[216:219], v228, s[52:55], s66 offen
    v_lshlrev_b32 v28, 16, v220
    v_and_b32 v29, s67, v220
    v_lshlrev_b32 v32, 16, v221
    v_and_b32 v33, s67, v221
    v_lshlrev_b32 v36, 16, v222
    v_and_b32 v37, s67, v222
    v_lshlrev_b32 v40, 16, v223
    v_and_b32 v41, s67, v223
    s_waitcnt lgkmcnt(1)
    v_lshlrev_b32 v30, 16, v20
    v_and_b32 v31, s67, v20
    v_lshlrev_b32 v34, 16, v21
    v_and_b32 v35, s67, v21
    v_lshlrev_b32 v38, 16, v22
    v_and_b32 v39, s67, v22
    v_lshlrev_b32 v42, 16, v23
    v_and_b32_e64 v43, s67, v23
    v_pk_mul_f32 v[28:29], v[28:29], v[30:31]
    v_pk_mul_f32 v[32:33], v[32:33], v[34:35]
    v_pk_mul_f32 v[36:37], v[36:37], v[38:39]
    v_pk_mul_f32 v[40:41], v[40:41], v[42:43]
    v_cvt_pk_bf16_f32 v220, v28, v29
    v_cvt_pk_bf16_f32 v221, v32, v33
    v_cvt_pk_bf16_f32 v222, v36, v37
    v_cvt_pk_bf16_f32 v223, v40, v41
    buffer_store_dwordx4 v[220:223], v229, s[52:55], s66 offen
    s_cmp_eq_u32 s9, 1
    s_cbranch_scc1 L_p7
    v_lshlrev_b32 v28, 16, v224
    v_and_b32 v29, s67, v224
    v_lshlrev_b32 v32, 16, v225
    v_and_b32 v33, s67, v225
    v_lshlrev_b32 v36, 16, v226
    v_and_b32 v37, s67, v226
    v_lshlrev_b32 v40, 16, v227
    v_and_b32 v41, s67, v227
    s_waitcnt lgkmcnt(0)
    v_lshlrev_b32 v30, 16, v24
    v_and_b32 v31, s67, v24
    v_lshlrev_b32 v34, 16, v25
    v_and_b32 v35, s67, v25
    v_lshlrev_b32 v38, 16, v26
    v_and_b32 v39, s67, v26
    v_lshlrev_b32 v42, 16, v27
    v_and_b32_e64 v43, s67, v27
    v_pk_mul_f32 v[28:29], v[28:29], v[30:31]
    v_pk_mul_f32 v[32:33], v[32:33], v[34:35]
    v_pk_mul_f32 v[36:37], v[36:37], v[38:39]
    v_pk_mul_f32 v[40:41], v[40:41], v[42:43]
    v_cvt_pk_bf16_f32 v224, v28, v29
    v_cvt_pk_bf16_f32 v225, v32, v33
    v_cvt_pk_bf16_f32 v226, v36, v37
    v_cvt_pk_bf16_f32 v227, v40, v41
    buffer_store_dwordx4 v[224:227], v230, s[52:55], s66 offen
L_p7:
    s_cmp_lg_u32 s13, 0
    s_cbranch_scc1 L_t0
L_exit:
    s_endpgm
.fill 3000, 4, 0xbf800000
    s_endpgm
.section .rodata,"a"
.p2align 6
.amdhsa_kernel concat_heads__linear_kernel_hedgehog__ssm_conv_h3__prompt_kernel
  .amdhsa_next_free_vgpr 256
  .amdhsa_next_free_sgpr 102
  .amdhsa_accum_offset 256
  .amdhsa_group_segment_fixed_size 0
  .amdhsa_kernarg_size 104
  .amdhsa_user_sgpr_count 2
  .amdhsa_user_sgpr_kernarg_segment_ptr 1
  .amdhsa_system_sgpr_workgroup_id_x 1
.end_amdhsa_kernel
```
